```python
import torch

def _softmax(x, axis=-1):
    return torch.softmax(x, dim=axis)
def _gelu(x):
    return torch.nn.functional.gelu(x, approximate="tanh")
def _silu(x):
    return torch.nn.functional.silu(x)
def _sigmoid(x):
    return torch.sigmoid(x)
def _layernorm(x, axis=-1, eps=1e-5):
    m = x.mean(dim=axis, keepdim=True)
    v = x.var(dim=axis, keepdim=True, unbiased=False)
    return (x - m) / torch.sqrt(v + eps)
def _scatter_add(tgt, idx, src, axis=0):
    return tgt.clone().index_add_(axis, idx, src)
def _segment_sum(src, seg, n):
    out = torch.zeros((n,) + src.shape[1:], dtype=src.dtype)
    return out.index_add_(0, seg, src)
def _pad(x, pw):
    flat = tuple(v for pair in reversed(pw) for v in pair)
    return torch.nn.functional.pad(x, flat)

kernel_name = 'standalone__modern_conv_block_replknet__vision'

def setup_inputs():

    _w = (lambda a: (lambda t: t.to(torch.bfloat16) if t.is_floating_point() else t)(torch.as_tensor(a)))
    H = W = 256
    C = 384
    K = 1
    return {
        "x": _w((lambda *s: torch.randn(*s, dtype=torch.bfloat16) * 0.05)(1, H, W, C)),
        "dw_large": _w((lambda *s: torch.randn(*s, dtype=torch.bfloat16) * 0.4)(K, K, C) * (1.0 / K)),
        "dw_small": _w((lambda *s: torch.randn(*s, dtype=torch.bfloat16) * 0.4)(5, 5, C) * 0.2),
        "w1": _w((lambda *s: torch.randn(*s, dtype=torch.bfloat16) * 0.4)(C, 4 * C) * (C ** -0.5)),
        "w2": _w((lambda *s: torch.randn(*s, dtype=torch.bfloat16) * 0.1)(4 * C, C) * ((4 * C) ** -0.5)),
    }

def reference(x, dw_large, dw_small, w1, w2):
    B, H, W, C = x.shape
    Kl = dw_large.shape[0]
    pl = (Kl - 1) // 2
    xpl = _pad(x, ((0,0),(pl,pl),(pl,pl),(0,0)))
    out = torch.zeros_like(x)
    for i in range(Kl):
        for j in range(Kl):
            out = out + xpl[:, i:i+H, j:j+W, :] * dw_large[i, j][None, None, None, :]
    Ks = dw_small.shape[0]
    ps = (Ks - 1) // 2
    xps = _pad(x, ((0,0),(ps,ps),(ps,ps),(0,0)))
    for i in range(Ks):
        for j in range(Ks):
            out = out + xps[:, i:i+H, j:j+W, :] * dw_small[i, j][None, None, None, :]
    h = _layernorm(out, axis=-1)
    h = _gelu(torch.einsum('bhwc,ce->bhwe', h, w1))
    h = torch.einsum('bhwe,ec->bhwc', h, w2)
    return x + h
```

```asm
; @launch grid=(256,1,1) block=(256,1,1) lds=163840
.amdgcn_target "amdgcn-amd-amdhsa--gfx950"
.text
.globl standalone__modern_conv_block_replknet__vision_kernel
.p2align 8
.type standalone__modern_conv_block_replknet__vision_kernel,@function
standalone__modern_conv_block_replknet__vision_kernel:
s_cmp_ge_u32 s2, 256
s_cbranch_scc1 L_end
s_load_dwordx16 s[76:91], s[0:1], 0
v_lshrrev_b32 v1, 6, v0
v_and_b32 v2, 63, v0
s_nop 0
v_readfirstlane_b32 s29, v1
s_and_b32 s46, s2, 7
s_lshr_b32 s47, s2, 3
s_lshr_b32 s48, s46, 2
s_lshl_b32 s48, s48, 3
s_and_b32 s46, s46, 3
s_lshl_b32 s46, s46, 2
s_and_b32 s49, s47, 3
s_add_u32 s49, s49, s46
s_lshr_b32 s47, s47, 2
s_add_u32 s46, s47, s48
s_mov_b32 s47, s49
s_lshl_b32 s38, s47, 4
s_mov_b32 s32, 0
s_lshl_b32 s37, s46, 3
s_mul_i32 s72, s29, 3
s_add_u32 s72, s72, s37
s_sub_u32 s72, s72, 2
s_mul_i32 s74, s38, 768
s_mul_i32 s73, s72, 196608
s_cmp_lt_u32 s72, 256
s_cselect_b32 s73, s73, 0x40000000
s_mov_b32 s66, s73
s_add_u32 s60, s73, s74
s_add_u32 s61, s60, 6144
s_add_u32 s72, s72, 1
s_mul_i32 s73, s72, 196608
s_cmp_lt_u32 s72, 256
s_cselect_b32 s73, s73, 0x40000000
s_add_u32 s62, s73, s74
s_add_u32 s63, s62, 6144
s_add_u32 s72, s72, 1
s_mul_i32 s73, s72, 196608
s_cmp_lt_u32 s72, 256
s_cselect_b32 s73, s73, 0x40000000
s_mov_b32 s67, s73
s_add_u32 s64, s73, s74
s_add_u32 s65, s64, 6144
s_lshr_b32 s30, s29, 1
s_and_b32 s31, s29, 1
v_lshrrev_b32 v3, 3, v2
v_and_b32 v4, 7, v2
v_lshlrev_b32 v4, 4, v4
v_mul_u32_u24 v5, 768, v3
v_add_u32 v254, v5, v4
v_and_b32 v5, 1, v3
v_bfe_u32 v6, v3, 1, 1
v_mul_u32_u24 v6, 18, v6
v_add_u32 v5, v5, v6
s_sub_u32 s49, s38, 2
v_add_u32 v5, s49, v5
v_lshrrev_b32 v6, 2, v3
v_lshl_add_u32 v6, v6, 8, v5
v_mul_u32_u24 v6, 768, v6
v_add_u32 v6, v6, v4
v_mov_b32 v8, 0x40000000
v_cmp_gt_u32 vcc, 256, v5
s_nop 1
v_cndmask_b32 v255, v8, v6, vcc
s_mul_i32 s26, s29, 6144
v_lshlrev_b32 v7, 4, v2
v_add_u32 v252, s26, v7
s_waitcnt lgkmcnt(0)
s_mov_b32 s16, s76
s_mov_b32 s17, s77
s_mov_b32 s18, 0x3000000
s_mov_b32 s19, 0x20000
s_mov_b32 s8, s90
s_mov_b32 s9, s91
s_mov_b32 s10, 0x24a400
s_mov_b32 s11, 0x20000
s_mov_b32 s44, s78
s_mov_b32 s45, s79
s_mov_b32 s46, 0x300
s_mov_b32 s47, 0x20000
s_mov_b32 s48, s80
s_mov_b32 s49, s81
s_mov_b32 s50, 0x4b00
s_mov_b32 s51, 0x20000
s_mov_b32 s68, s88
s_mov_b32 s69, s89
s_mov_b32 s70, 0x100
s_mov_b32 s71, 0x20000
s_mov_b32 s20, s86
s_mov_b32 s21, s87
s_mov_b32 s22, 0x3000000
s_mov_b32 s23, 0x20000
s_mov_b32 s4, s82
s_mov_b32 s5, s83
s_mov_b32 s6, 0x120000
s_mov_b32 s7, 0x20000
s_mov_b32 s14, 1179648
s_mov_b32 s15, 0x20000
s_mov_b32 s42, s90
s_mov_b32 s43, s91
v_lshlrev_b32 v100, 2, v0
buffer_load_dword v101, v100, s[44:47], 0 offen offset:0
v_add_u32 v103, 9216, v100
buffer_load_dword v102, v103, s[48:51], 0 offen
buffer_load_dwordx4 a[0:3], v254, s[16:19], s60 offen offset:0
buffer_load_dwordx4 a[4:7], v254, s[16:19], s61 offen offset:0
buffer_load_dwordx4 a[8:11], v254, s[16:19], s62 offen offset:0
buffer_load_dwordx4 a[12:15], v254, s[16:19], s63 offen offset:0
buffer_load_dwordx4 a[16:19], v254, s[16:19], s64 offen offset:0
buffer_load_dwordx4 a[20:23], v254, s[16:19], s65 offen offset:0
buffer_load_dwordx4 a[24:27], v255, s[16:19], s66 offen offset:0
buffer_load_dwordx4 a[28:31], v255, s[16:19], s67 offen offset:0
v_and_b32 v128, 15, v2
v_lshrrev_b32 v129, 4, v2
v_mul_u32_u24 v168, 24576, v129
v_lshl_add_u32 v168, v128, 1, v168
v_mul_u32_u24 v169, 3072, v129
v_lshrrev_b32 v129, 2, v128
v_lshlrev_b32 v129, 4, v129
v_add_u32 v169, v169, v129
v_and_b32 v129, 3, v128
v_lshl_add_u32 v169, v129, 1, v169
v_mov_b32 v171, v7
s_mov_b32 s92, 3072
s_mov_b32 s93, 768
s_mov_b32 s94, 9984
s_add_u32 s91, s29, 0
s_min_u32 s91, s91, 8
s_mul_i32 s72, s2, 9
s_add_u32 s91, s91, s72
s_mul_i32 s52, s91, 43691
s_lshr_b32 s52, s52, 20
s_mul_i32 s53, s52, 24
s_sub_u32 s53, s91, s53
s_lshl_b32 s88, s91, 10
s_sub_u32 s57, s52, 2
s_and_b32 s58, s57, 3
s_lshr_b32 s54, s58, 1
s_and_b32 s56, s58, 1
s_lshr_b32 s55, s57, 2
s_xor_b32 s58, s54, 1
s_add_u32 s55, s55, s58
s_cmp_lt_u32 s52, 2
s_cselect_b32 s54, 0, s54
s_cselect_b32 s55, 0, s55
s_cselect_b32 s56, s52, s56
s_and_b32 s58, s52, 1
s_cmp_ge_u32 s52, 94
s_cselect_b32 s54, 1, s54
s_cselect_b32 s55, 23, s55
s_cselect_b32 s56, s58, s56
s_cmp_ge_u32 s53, 12
s_cselect_b32 s57, 1, 0
s_mul_i32 s58, s57, 12
s_sub_u32 s53, s53, s58
s_mul_i32 s59, s53, 98304
s_lshl_b32 s58, s55, 7
s_add_u32 s59, s59, s58
s_lshl_b32 s58, s57, 6
s_add_u32 s59, s59, s58
s_lshl_b32 s58, s56, 5
s_add_u32 s59, s59, s58
s_lshl_b32 s72, s55, 6
s_and_b32 s58, s53, 1
s_lshl_b32 s58, s58, 5
s_add_u32 s72, s72, s58
s_mul_i32 s72, s72, 768
s_mul_i32 s58, s57, 384
s_add_u32 s72, s72, s58
s_lshr_b32 s73, s53, 1
s_mul_i32 s58, s56, 6
s_add_u32 s73, s73, s58
s_lshr_b32 s58, s73, 1
s_lshl_b32 s58, s58, 6
s_add_u32 s72, s72, s58
s_and_b32 s58, s73, 1
s_lshl_b32 s58, s58, 3
s_add_u32 s72, s72, s58
s_cmp_eq_u32 s54, 0
s_cselect_b32 s59, s59, s72
s_cselect_b32 s12, s4, s84
s_cselect_b32 s13, s5, s85
s_cselect_b64 s[72:73], -1, 0
s_cselect_b32 s74, s92, s93
s_cselect_b32 s75, s92, s94
v_cndmask_b32 v170, v169, v168, s[72:73]
buffer_load_ushort v128, v170, s[12:15], s59 offen
s_add_u32 s59, s59, s74
buffer_load_ushort v129, v170, s[12:15], s59 offen
s_add_u32 s59, s59, s74
buffer_load_ushort v130, v170, s[12:15], s59 offen
s_add_u32 s59, s59, s74
buffer_load_ushort v131, v170, s[12:15], s59 offen
s_add_u32 s59, s59, s75
buffer_load_ushort v132, v170, s[12:15], s59 offen
s_add_u32 s59, s59, s74
buffer_load_ushort v133, v170, s[12:15], s59 offen
s_add_u32 s59, s59, s74
buffer_load_ushort v134, v170, s[12:15], s59 offen
s_add_u32 s59, s59, s74
buffer_load_ushort v135, v170, s[12:15], s59 offen
s_add_u32 s91, s29, 4
s_min_u32 s91, s91, 8
s_mul_i32 s72, s2, 9
s_add_u32 s91, s91, s72
s_mul_i32 s52, s91, 43691
s_lshr_b32 s52, s52, 20
s_mul_i32 s53, s52, 24
s_sub_u32 s53, s91, s53
s_lshl_b32 s89, s91, 10
s_sub_u32 s57, s52, 2
s_and_b32 s58, s57, 3
s_lshr_b32 s54, s58, 1
s_and_b32 s56, s58, 1
s_lshr_b32 s55, s57, 2
s_xor_b32 s58, s54, 1
s_add_u32 s55, s55, s58
s_cmp_lt_u32 s52, 2
s_cselect_b32 s54, 0, s54
s_cselect_b32 s55, 0, s55
s_cselect_b32 s56, s52, s56
s_and_b32 s58, s52, 1
s_cmp_ge_u32 s52, 94
s_cselect_b32 s54, 1, s54
s_cselect_b32 s55, 23, s55
s_cselect_b32 s56, s58, s56
s_cmp_ge_u32 s53, 12
s_cselect_b32 s57, 1, 0
s_mul_i32 s58, s57, 12
s_sub_u32 s53, s53, s58
s_mul_i32 s59, s53, 98304
s_lshl_b32 s58, s55, 7
s_add_u32 s59, s59, s58
s_lshl_b32 s58, s57, 6
s_add_u32 s59, s59, s58
s_lshl_b32 s58, s56, 5
s_add_u32 s59, s59, s58
s_lshl_b32 s72, s55, 6
s_and_b32 s58, s53, 1
s_lshl_b32 s58, s58, 5
s_add_u32 s72, s72, s58
s_mul_i32 s72, s72, 768
s_mul_i32 s58, s57, 384
s_add_u32 s72, s72, s58
s_lshr_b32 s73, s53, 1
s_mul_i32 s58, s56, 6
s_add_u32 s73, s73, s58
s_lshr_b32 s58, s73, 1
s_lshl_b32 s58, s58, 6
s_add_u32 s72, s72, s58
s_and_b32 s58, s73, 1
s_lshl_b32 s58, s58, 3
s_add_u32 s72, s72, s58
s_cmp_eq_u32 s54, 0
s_cselect_b32 s59, s59, s72
s_cselect_b32 s12, s4, s84
s_cselect_b32 s13, s5, s85
s_cselect_b64 s[72:73], -1, 0
s_cselect_b32 s74, s92, s93
s_cselect_b32 s75, s92, s94
v_cndmask_b32 v170, v169, v168, s[72:73]
buffer_load_ushort v136, v170, s[12:15], s59 offen
s_add_u32 s59, s59, s74
buffer_load_ushort v137, v170, s[12:15], s59 offen
s_add_u32 s59, s59, s74
buffer_load_ushort v138, v170, s[12:15], s59 offen
s_add_u32 s59, s59, s74
buffer_load_ushort v139, v170, s[12:15], s59 offen
s_add_u32 s59, s59, s75
buffer_load_ushort v140, v170, s[12:15], s59 offen
s_add_u32 s59, s59, s74
buffer_load_ushort v141, v170, s[12:15], s59 offen
s_add_u32 s59, s59, s74
buffer_load_ushort v142, v170, s[12:15], s59 offen
s_add_u32 s59, s59, s74
buffer_load_ushort v143, v170, s[12:15], s59 offen
s_add_u32 s91, s29, 8
s_min_u32 s91, s91, 8
s_mul_i32 s72, s2, 9
s_add_u32 s91, s91, s72
s_mul_i32 s52, s91, 43691
s_lshr_b32 s52, s52, 20
s_mul_i32 s53, s52, 24
s_sub_u32 s53, s91, s53
s_lshl_b32 s90, s91, 10
s_sub_u32 s57, s52, 2
s_and_b32 s58, s57, 3
s_lshr_b32 s54, s58, 1
s_and_b32 s56, s58, 1
s_lshr_b32 s55, s57, 2
s_xor_b32 s58, s54, 1
s_add_u32 s55, s55, s58
s_cmp_lt_u32 s52, 2
s_cselect_b32 s54, 0, s54
s_cselect_b32 s55, 0, s55
s_cselect_b32 s56, s52, s56
s_and_b32 s58, s52, 1
s_cmp_ge_u32 s52, 94
s_cselect_b32 s54, 1, s54
s_cselect_b32 s55, 23, s55
s_cselect_b32 s56, s58, s56
s_cmp_ge_u32 s53, 12
s_cselect_b32 s57, 1, 0
s_mul_i32 s58, s57, 12
s_sub_u32 s53, s53, s58
s_mul_i32 s59, s53, 98304
s_lshl_b32 s58, s55, 7
s_add_u32 s59, s59, s58
s_lshl_b32 s58, s57, 6
s_add_u32 s59, s59, s58
s_lshl_b32 s58, s56, 5
s_add_u32 s59, s59, s58
s_lshl_b32 s72, s55, 6
s_and_b32 s58, s53, 1
s_lshl_b32 s58, s58, 5
s_add_u32 s72, s72, s58
s_mul_i32 s72, s72, 768
s_mul_i32 s58, s57, 384
s_add_u32 s72, s72, s58
s_lshr_b32 s73, s53, 1
s_mul_i32 s58, s56, 6
s_add_u32 s73, s73, s58
s_lshr_b32 s58, s73, 1
s_lshl_b32 s58, s58, 6
s_add_u32 s72, s72, s58
s_and_b32 s58, s73, 1
s_lshl_b32 s58, s58, 3
s_add_u32 s72, s72, s58
s_cmp_eq_u32 s54, 0
s_cselect_b32 s59, s59, s72
s_cselect_b32 s12, s4, s84
s_cselect_b32 s13, s5, s85
s_cselect_b64 s[72:73], -1, 0
s_cselect_b32 s74, s92, s93
s_cselect_b32 s75, s92, s94
v_cndmask_b32 v170, v169, v168, s[72:73]
buffer_load_ushort v160, v170, s[12:15], s59 offen
s_add_u32 s59, s59, s74
buffer_load_ushort v161, v170, s[12:15], s59 offen
s_add_u32 s59, s59, s74
buffer_load_ushort v162, v170, s[12:15], s59 offen
s_add_u32 s59, s59, s74
buffer_load_ushort v163, v170, s[12:15], s59 offen
s_add_u32 s59, s59, s75
buffer_load_ushort v164, v170, s[12:15], s59 offen
s_add_u32 s59, s59, s74
buffer_load_ushort v165, v170, s[12:15], s59 offen
s_add_u32 s59, s59, s74
buffer_load_ushort v166, v170, s[12:15], s59 offen
s_add_u32 s59, s59, s74
buffer_load_ushort v167, v170, s[12:15], s59 offen
buffer_load_dwordx4 a[32:35], v254, s[16:19], s60 offen offset:128
buffer_load_dwordx4 a[36:39], v254, s[16:19], s61 offen offset:128
buffer_load_dwordx4 a[40:43], v254, s[16:19], s62 offen offset:128
buffer_load_dwordx4 a[44:47], v254, s[16:19], s63 offen offset:128
buffer_load_dwordx4 a[48:51], v254, s[16:19], s64 offen offset:128
buffer_load_dwordx4 a[52:55], v254, s[16:19], s65 offen offset:128
buffer_load_dwordx4 a[56:59], v255, s[16:19], s66 offen offset:128
buffer_load_dwordx4 a[60:63], v255, s[16:19], s67 offen offset:128
v_and_b32 v3, 3, v2
v_lshrrev_b32 v4, 4, v2
v_bfe_u32 v5, v2, 2, 2
v_lshlrev_b32 v4, 1, v4
v_sub_u32 v4, v4, v5
v_add_u32 v5, 1, v4
v_mov_b32 v10, 0x0c0c0c0c
v_mov_b32 v11, 0x0c0c0100
v_mov_b32 v12, 0x01000c0c
v_mov_b32 v13, 0x0c0c0504
v_mov_b32 v14, 0x05040c0c
v_and_b32 v15, 1, v2
v_cmp_eq_u32 vcc, 1, v15
s_nop 1
v_cndmask_b32 v11, v11, v12, vcc
v_cndmask_b32 v13, v13, v14, vcc
v_cmp_gt_u32 vcc, 5, v4
s_nop 1
v_cndmask_b32 v11, v10, v11, vcc
v_cndmask_b32 v4, 0, v4, vcc
v_cmp_gt_u32 vcc, 5, v5
s_nop 1
v_cndmask_b32 v13, v10, v13, vcc
v_cndmask_b32 v5, 0, v5, vcc
v_cmp_gt_u32 vcc, 2, v3
s_nop 1
v_cndmask_b32 v20, v10, v11, vcc
v_cndmask_b32 v21, v11, v10, vcc
v_cndmask_b32 v22, v10, v13, vcc
v_cndmask_b32 v23, v13, v10, vcc
s_lshl_b32 s72, s29, 1
s_add_u32 s72, s72, 0
v_add_u32 v16, s72, v4
v_and_b32 v16, 7, v16
v_lshlrev_b32 v16, 4, v16
v_lshl_add_u32 v16, v4, 7, v16
v_lshl_add_u32 v16, v3, 1, v16
v_add_u32 v36, 111360, v16
s_lshl_b32 s72, s29, 1
s_add_u32 s72, s72, 1
v_add_u32 v16, s72, v4
v_and_b32 v16, 7, v16
v_lshlrev_b32 v16, 4, v16
v_lshl_add_u32 v16, v4, 7, v16
v_lshl_add_u32 v16, v3, 1, v16
v_add_u32 v37, 111360, v16
s_lshl_b32 s72, s29, 1
s_add_u32 s72, s72, 0
v_add_u32 v16, s72, v5
v_and_b32 v16, 7, v16
v_lshlrev_b32 v16, 4, v16
v_lshl_add_u32 v16, v5, 7, v16
v_lshl_add_u32 v16, v3, 1, v16
v_add_u32 v38, 111360, v16
s_lshl_b32 s72, s29, 1
s_add_u32 s72, s72, 1
v_add_u32 v16, s72, v5
v_and_b32 v16, 7, v16
v_lshlrev_b32 v16, 4, v16
v_lshl_add_u32 v16, v5, 7, v16
v_lshl_add_u32 v16, v3, 1, v16
v_add_u32 v39, 111360, v16
v_lshrrev_b32 v16, 3, v2
s_lshl_b32 s72, s29, 3
v_add_u32 v16, s72, v16
v_mul_u32_u24 v17, 52, v16
v_lshrrev_b32 v17, 8, v17
v_mul_u32_u24 v17, 5, v17
v_sub_u32 v17, v16, v17
v_and_b32 v18, 7, v2
v_sub_u32 v18, v18, v17
v_and_b32 v18, 7, v18
v_lshlrev_b32 v18, 4, v18
v_mul_u32_u24 v17, 768, v16
v_add_u32 v18, v18, v17
v_mov_b32 v17, 0x40000000
v_cmp_gt_u32 vcc, 25, v16
s_nop 1
v_cndmask_b32 v34, v17, v18, vcc
v_mov_b32 v35, 0
v_bfe_u32 v10, v2, 2, 2
v_bfe_u32 v11, v2, 3, 1
v_xor_b32 v10, v10, v11
v_mul_u32_u24 v10, 320, v10
v_lshl_add_u32 v10, v3, 5, v10
v_lshrrev_b32 v11, 4, v2
s_mul_i32 s72, s29, 7744
s_add_u32 s72, s72, 49152
s_lshl_b32 s73, s30, 4
s_add_u32 s72, s72, s73
v_lshl_add_u32 v24, v11, 4, v10
v_add_u32 v24, s72, v24
v_mul_u32_u24 v12, 3872, v11
v_add_u32 v12, v10, v12
s_mul_i32 s72, s30, 160
s_add_u32 s72, s72, 49488
v_add_u32 v33, s72, v12
v_and_b32 v12, 7, v2
v_lshrrev_b32 v13, 2, v12
v_mul_u32_u24 v12, 3872, v12
v_lshl_add_u32 v12, v13, 4, v12
s_mul_i32 s72, s29, 480
s_add_u32 s72, s72, 49152
v_add_u32 v12, s72, v12
v_lshrrev_b32 v13, 3, v2
v_lshl_add_u32 v25, v13, 3, v12
v_add_u32 v25, 16, v25
v_lshrrev_b32 v14, 2, v13
v_mul_u32_u24 v14, 160, v14
v_add_u32 v12, v12, v14
v_and_b32 v14, 1, v13
v_lshl_add_u32 v12, v14, 3, v12
v_bfe_u32 v14, v13, 1, 1
v_mul_u32_u24 v14, 144, v14
v_add_u32 v26, v12, v14
v_and_b32 v12, 7, v2
v_lshlrev_b32 v12, 4, v12
v_bfe_u32 v13, v2, 3, 2
v_mul_u32_u24 v13, 3072, v13
v_add_u32 v12, v12, v13
v_lshrrev_b32 v13, 5, v2
v_mul_u32_u24 v13, 393216, v13
v_add_u32 v32, v12, v13
v_sub_u32 v13, 1179648, v13
v_add_u32 v27, v12, v13
s_lshl_b32 s72, s29, 12
s_add_u32 s72, s72, 80384
v_lshrrev_b32 v12, 4, v2
v_and_b32 v13, 15, v2
v_lshlrev_b32 v14, 1, v12
v_xor_b32 v13, v13, v14
v_lshl_add_u32 v13, v12, 4, v13
v_lshlrev_b32 v13, 4, v13
v_add_u32 v28, s72, v13
v_xor_b32 v29, 128, v28
v_and_b32 v12, 7, v2
v_lshrrev_b32 v13, 3, v2
v_lshlrev_b32 v14, 1, v12
v_xor_b32 v13, v13, v14
v_lshl_add_u32 v13, v12, 4, v13
v_lshlrev_b32 v13, 4, v13
v_add_u32 v30, s72, v13
v_xor_b32 v31, 128, v30
v_mov_b32 v240, v20
v_mov_b32 v244, v24
v_mov_b32 v236, v28
v_mov_b32 v212, v36
v_mov_b32 v241, v21
v_mov_b32 v245, v25
v_mov_b32 v237, v29
v_mov_b32 v213, v37
v_mov_b32 v242, v22
v_mov_b32 v246, v26
v_mov_b32 v238, v30
v_mov_b32 v214, v38
v_mov_b32 v243, v23
v_mov_b32 v247, v27
v_mov_b32 v239, v31
v_mov_b32 v215, v39
v_mov_b32 v253, v32
v_mov_b32 v251, v33
v_mov_b32 v216, v34
s_mov_b64 s[98:99], -1
s_cmp_eq_u32 s29, 1
s_cselect_b32 s99, 0xffffff00, -1
s_lshl_b32 s73, s29, 10
s_add_u32 m0, s73, 147456
s_mov_b32 s72, 0
s_mov_b64 exec, s[98:99]
buffer_load_dwordx4 v216, s[48:51], s72 offen lds
s_mov_b64 exec, -1
s_add_u32 m0, s73, 151552
s_mov_b32 s72, 128
s_mov_b64 exec, s[98:99]
buffer_load_dwordx4 v216, s[48:51], s72 offen lds
s_mov_b64 exec, -1
s_add_u32 m0, s73, 155648
s_mov_b32 s72, 256
s_mov_b64 exec, s[98:99]
buffer_load_dwordx4 v216, s[48:51], s72 offen lds
s_mov_b64 exec, -1
s_add_u32 m0, s73, 159744
s_mov_b32 s72, 384
s_mov_b64 exec, s[98:99]
buffer_load_dwordx4 v216, s[48:51], s72 offen lds
s_mov_b64 exec, -1
s_add_u32 m0, s73, 111360
s_mov_b32 s72, 512
s_mov_b64 exec, s[98:99]
buffer_load_dwordx4 v216, s[48:51], s72 offen lds
s_mov_b64 exec, -1
s_add_u32 m0, s73, 115456
s_mov_b32 s72, 640
s_mov_b64 exec, s[98:99]
buffer_load_dwordx4 v216, s[48:51], s72 offen lds
s_mov_b64 exec, -1
buffer_load_dwordx4 a[64:67], v254, s[16:19], s60 offen offset:256
buffer_load_dwordx4 a[68:71], v254, s[16:19], s61 offen offset:256
buffer_load_dwordx4 a[72:75], v254, s[16:19], s62 offen offset:256
buffer_load_dwordx4 a[76:79], v254, s[16:19], s63 offen offset:256
buffer_load_dwordx4 a[80:83], v254, s[16:19], s64 offen offset:256
buffer_load_dwordx4 a[84:87], v254, s[16:19], s65 offen offset:256
buffer_load_dwordx4 a[88:91], v255, s[16:19], s66 offen offset:256
buffer_load_dwordx4 a[92:95], v255, s[16:19], s67 offen offset:256
s_add_u32 s72, s26, 2376704
buffer_store_dwordx4 v[20:23], v7, s[8:11], s72 offen offset:0
buffer_store_dwordx4 v[24:27], v7, s[8:11], s72 offen offset:1024
buffer_store_dwordx4 v[28:31], v7, s[8:11], s72 offen offset:2048
buffer_store_dwordx4 v[32:35], v7, s[8:11], s72 offen offset:3072
s_add_u32 s72, s72, 4096
buffer_store_dwordx4 v[36:39], v7, s[8:11], s72 offen
s_mov_b32 s27, 0x409d30fc
s_mov_b32 s35, 0x3eeff558
s_mul_i32 s72, s31, 12288
v_add_u32 v248, s72, v7
v_add_u32 v249, 73728, v248
v_bfe_u32 v3, v2, 2, 2
v_lshrrev_b32 v4, 4, v2
v_cmp_eq_u32 vcc, v3, v4
v_and_b32 v5, 1, v2
v_lshlrev_b32 v5, 4, v5
v_mov_b32 v6, 0x3f80
v_lshlrev_b32 v6, v5, v6
v_cndmask_b32 v6, 0, v6, vcc
v_bfe_u32 v5, v2, 1, 1
v_cmp_eq_u32 vcc, 0, v5
s_nop 1
v_cndmask_b32 v8, 0, v6, vcc
v_cndmask_b32 v9, v6, 0, vcc
v_mov_b32 v10, 0
v_accvgpr_write_b32 a248, v8
v_accvgpr_write_b32 a249, v9
v_accvgpr_write_b32 a250, v10
v_accvgpr_write_b32 a251, v10
v_accvgpr_write_b32 a252, v10
v_accvgpr_write_b32 a253, v10
v_accvgpr_write_b32 a254, v8
v_accvgpr_write_b32 a255, v9
v_lshrrev_b32 v104, 5, v0
v_lshlrev_b32 v105, 12, v104
v_add_u32 v105, 148992, v105
v_mov_b32 v106, -52480
v_cmp_lt_u32 vcc, 3, v104
s_nop 1
v_cndmask_b32 v106, 0, v106, vcc
v_add_u32 v105, v105, v106
v_bfe_u32 v106, v0, 2, 3
v_add_u32 v106, 2, v106
v_and_b32 v106, 7, v106
v_lshl_add_u32 v105, v106, 4, v105
v_and_b32 v106, 3, v0
v_lshl_add_u32 v105, v106, 2, v105
s_waitcnt vmcnt(59)
v_lshlrev_b32 v106, 16, v101
v_and_b32 v107, 0xffff0000, v101
v_lshlrev_b32 v108, 16, v102
v_and_b32 v109, 0xffff0000, v102
v_add_f32 v106, v106, v108
v_add_f32 v107, v107, v109
v_cvt_pk_bf16_f32 v106, v106, v107
s_cmp_eq_u32 s29, 3
s_cbranch_scc1 L_nomerge
v_add_u32 v100, 2375680, v100
ds_write_b32 v105, v106
buffer_store_dword v106, v100, s[8:11], 0 offen
L_nomerge:
s_waitcnt vmcnt(27)
v_lshl_or_b32 v128, v129, 16, v128
v_lshl_or_b32 v129, v131, 16, v130
v_lshl_or_b32 v130, v133, 16, v132
v_lshl_or_b32 v131, v135, 16, v134
buffer_store_dwordx4 v[128:131], v171, s[8:11], s88 offen sc1
v_lshl_or_b32 v136, v137, 16, v136
v_lshl_or_b32 v137, v139, 16, v138
v_lshl_or_b32 v138, v141, 16, v140
v_lshl_or_b32 v139, v143, 16, v142
buffer_store_dwordx4 v[136:139], v171, s[8:11], s89 offen sc1
v_lshl_or_b32 v160, v161, 16, v160
v_lshl_or_b32 v161, v163, 16, v162
v_lshl_or_b32 v162, v165, 16, v164
v_lshl_or_b32 v163, v167, 16, v166
buffer_store_dwordx4 v[160:163], v171, s[8:11], s90 offen sc1
s_waitcnt vmcnt(16)
ds_write_b64 v245, a[0:1] offset:0
ds_write_b64 v245, a[2:3] offset:1936
ds_write_b64 v245, a[4:5] offset:64
ds_write_b64 v245, a[6:7] offset:2000
ds_write_b64 v245, a[8:9] offset:160
ds_write_b64 v245, a[10:11] offset:2096
ds_write_b64 v245, a[12:13] offset:224
ds_write_b64 v245, a[14:15] offset:2160
ds_write_b64 v245, a[16:17] offset:320
ds_write_b64 v245, a[18:19] offset:2256
ds_write_b64 v245, a[20:21] offset:384
ds_write_b64 v245, a[22:23] offset:2320
ds_write_b64 v246, a[24:25] offset:0
ds_write_b64 v246, a[26:27] offset:1936
s_mov_b64 exec, 0xffffffff
ds_write_b64 v246, a[28:29] offset:320
s_mov_b64 exec, -1
s_mov_b64 exec, 0xffffffff
ds_write_b64 v246, a[30:31] offset:2256
s_mov_b64 exec, -1
s_waitcnt lgkmcnt(0)
s_barrier
ds_read_u16 v192, v212 offset:36096
ds_read_u16 v193, v214 offset:36096
ds_read_u16 v194, v212 offset:36736
ds_read_u16 v195, v214 offset:36736
ds_read_u16 v196, v212 offset:37376
ds_read_u16 v197, v214 offset:37376
ds_read_u16 v198, v212 offset:38016
ds_read_u16 v199, v214 offset:38016
ds_read_u16 v200, v212 offset:38656
ds_read_u16 v201, v214 offset:38656
ds_read_b128 a[192:195], v244 offset:0
ds_read_b128 a[196:199], v244 offset:160
ds_read_b128 a[200:203], v244 offset:320
ds_read_b128 a[204:207], v244 offset:480
ds_read_b128 a[208:211], v244 offset:640
ds_read_b128 a[212:215], v244 offset:800
s_waitcnt lgkmcnt(14)
v_perm_b32 v232, v193, v192, v240
v_perm_b32 v233, v193, v192, v241
v_perm_b32 v234, v193, v192, v242
v_perm_b32 v235, v193, v192, v243
s_nop 1
s_waitcnt lgkmcnt(0)
v_mfma_f32_16x16x32_bf16 v[16:19], v[232:235], a[192:195], 0
ds_read_u16 v202, v212 offset:36104
ds_read_u16 v203, v214 offset:36104
v_perm_b32 v236, v195, v194, v240
v_perm_b32 v237, v195, v194, v241
v_perm_b32 v238, v195, v194, v242
v_perm_b32 v239, v195, v194, v243
v_mfma_f32_16x16x32_bf16 v[20:23], v[232:235], a[196:199], 0
ds_read_b128 a[216:219], v244 offset:1936
ds_read_b128 a[220:223], v244 offset:2096
ds_read_b128 a[224:227], v244 offset:2256
v_mfma_f32_16x16x32_bf16 v[16:19], v[236:239], a[196:199], v[16:19]
ds_read_b128 a[228:231], v244 offset:2416
v_perm_b32 v232, v197, v196, v240
v_perm_b32 v233, v197, v196, v241
v_perm_b32 v234, v197, v196, v242
v_perm_b32 v235, v197, v196, v243
v_mfma_f32_16x16x32_bf16 v[20:23], v[236:239], a[200:203], v[20:23]
buffer_load_dwordx4 a[96:99], v254, s[16:19], s60 offen offset:384
ds_read_b128 a[232:235], v244 offset:2576
ds_read_b128 a[236:239], v244 offset:2736
ds_read_u16 v204, v212 offset:36744
v_mfma_f32_16x16x32_bf16 v[16:19], v[232:235], a[200:203], v[16:19]
ds_read_u16 v205, v214 offset:36744
v_perm_b32 v236, v199, v198, v240
v_perm_b32 v237, v199, v198, v241
v_perm_b32 v238, v199, v198, v242
v_perm_b32 v239, v199, v198, v243
v_mfma_f32_16x16x32_bf16 v[20:23], v[232:235], a[204:207], v[20:23]
buffer_load_dwordx4 a[100:103], v254, s[16:19], s61 offen offset:384
ds_read_u16 v206, v212 offset:37384
ds_read_u16 v207, v214 offset:37384
ds_write_b64 v245, a[32:33] offset:30992
v_mfma_f32_16x16x32_bf16 v[16:19], v[236:239], a[204:207], v[16:19]
ds_read_u16 v208, v212 offset:38024
v_perm_b32 v232, v201, v200, v240
v_perm_b32 v233, v201, v200, v241
v_perm_b32 v234, v201, v200, v242
v_perm_b32 v235, v201, v200, v243
v_mfma_f32_16x16x32_bf16 v[20:23], v[236:239], a[208:211], v[20:23]
buffer_load_dwordx4 a[104:107], v254, s[16:19], s62 offen offset:384
ds_read_u16 v209, v214 offset:38024
ds_read_u16 v210, v212 offset:38664
ds_read_u16 v211, v214 offset:38664
ds_write_b64 v245, a[34:35] offset:32928
v_mfma_f32_16x16x32_bf16 v[16:19], v[232:235], a[208:211], v[16:19]
s_waitcnt lgkmcnt(15)
ds_write_b64 v245, a[36:37] offset:31056
v_perm_b32 v236, v203, v202, v240
v_perm_b32 v237, v203, v202, v241
v_perm_b32 v238, v203, v202, v242
v_perm_b32 v239, v203, v202, v243
v_mfma_f32_16x16x32_bf16 v[20:23], v[232:235], a[212:215], v[20:23]
buffer_load_dwordx4 a[108:111], v254, s[16:19], s63 offen offset:384
ds_write_b64 v245, a[38:39] offset:32992
ds_write_b64 v245, a[40:41] offset:31152
ds_write_b64 v245, a[42:43] offset:33088
s_waitcnt lgkmcnt(14)
v_mfma_f32_16x16x32_bf16 v[24:27], v[236:239], a[216:219], 0
s_waitcnt lgkmcnt(12)
ds_read_u16 v192, v213 offset:36096
ds_read_u16 v193, v215 offset:36096
v_perm_b32 v232, v205, v204, v240
v_perm_b32 v233, v205, v204, v241
v_perm_b32 v234, v205, v204, v242
v_perm_b32 v235, v205, v204, v243
v_mfma_f32_16x16x32_bf16 v[28:31], v[236:239], a[220:223], 0
ds_read_b128 a[192:195], v244 offset:3872
ds_read_b128 a[196:199], v244 offset:4032
ds_read_b128 a[200:203], v244 offset:4192
s_cmp_eq_u32 s31, 0
s_cbranch_scc0 L_noresf0
ds_read_b128 a[0:3], v251 offset:0
ds_read_b128 a[4:7], v251 offset:16
ds_read_b128 a[8:11], v251 offset:1936
ds_read_b128 a[12:15], v251 offset:1952
ds_read_b128 a[16:19], v251 offset:15504
ds_read_b128 a[20:23], v251 offset:15520
ds_read_b128 a[24:27], v251 offset:17440
ds_read_b128 a[28:31], v251 offset:17456
L_noresf0:
v_mfma_f32_16x16x32_bf16 v[24:27], v[232:235], a[220:223], v[24:27]
s_waitcnt lgkmcnt(15)
ds_read_b128 a[204:207], v244 offset:4352
v_perm_b32 v236, v207, v206, v240
v_perm_b32 v237, v207, v206, v241
v_perm_b32 v238, v207, v206, v242
v_perm_b32 v239, v207, v206, v243
v_mfma_f32_16x16x32_bf16 v[28:31], v[232:235], a[224:227], v[28:31]
buffer_load_dwordx4 a[112:115], v254, s[16:19], s64 offen offset:384
ds_read_b128 a[208:211], v244 offset:4512
ds_read_b128 a[212:215], v244 offset:4672
ds_read_u16 v194, v213 offset:36736
v_mfma_f32_16x16x32_bf16 v[24:27], v[236:239], a[224:227], v[24:27]
s_waitcnt lgkmcnt(15)
ds_read_u16 v195, v215 offset:36736
v_perm_b32 v232, v209, v208, v240
v_perm_b32 v233, v209, v208, v241
v_perm_b32 v234, v209, v208, v242
v_perm_b32 v235, v209, v208, v243
v_mfma_f32_16x16x32_bf16 v[28:31], v[236:239], a[228:231], v[28:31]
buffer_load_dwordx4 a[116:119], v254, s[16:19], s65 offen offset:384
ds_read_u16 v196, v213 offset:37376
ds_read_u16 v197, v215 offset:37376
ds_write_b64 v245, a[44:45] offset:31216
v_mfma_f32_16x16x32_bf16 v[24:27], v[232:235], a[228:231], v[24:27]
s_waitcnt lgkmcnt(15)
ds_read_u16 v198, v213 offset:38016
v_perm_b32 v236, v211, v210, v240
v_perm_b32 v237, v211, v210, v241
v_perm_b32 v238, v211, v210, v242
v_perm_b32 v239, v211, v210, v243
v_mfma_f32_16x16x32_bf16 v[28:31], v[232:235], a[232:235], v[28:31]
buffer_load_dwordx4 a[120:123], v255, s[16:19], s66 offen offset:384
ds_read_u16 v199, v215 offset:38016
ds_read_u16 v200, v213 offset:38656
ds_read_u16 v201, v215 offset:38656
ds_write_b64 v245, a[46:47] offset:33152
v_mfma_f32_16x16x32_bf16 v[24:27], v[236:239], a[232:235], v[24:27]
s_waitcnt lgkmcnt(15)
ds_write_b64 v245, a[48:49] offset:31312
v_perm_b32 v232, v193, v192, v240
v_perm_b32 v233, v193, v192, v241
v_perm_b32 v234, v193, v192, v242
v_perm_b32 v235, v193, v192, v243
v_mfma_f32_16x16x32_bf16 v[28:31], v[236:239], a[236:239], v[28:31]
buffer_load_dwordx4 a[124:127], v255, s[16:19], s67 offen offset:384
ds_write_b64 v245, a[50:51] offset:33248
ds_write_b64 v245, a[52:53] offset:31376
s_waitcnt lgkmcnt(13)
v_mfma_f32_16x16x32_bf16 v[48:51], v[232:235], a[192:195], 0
s_waitcnt lgkmcnt(11)
ds_read_u16 v202, v213 offset:36104
ds_read_u16 v203, v215 offset:36104
v_perm_b32 v236, v195, v194, v240
v_perm_b32 v237, v195, v194, v241
v_perm_b32 v238, v195, v194, v242
v_perm_b32 v239, v195, v194, v243
v_mfma_f32_16x16x32_bf16 v[52:55], v[232:235], a[196:199], 0
ds_read_b128 a[216:219], v244 offset:5808
ds_read_b128 a[220:223], v244 offset:5968
ds_read_b128 a[224:227], v244 offset:6128
v_mfma_f32_16x16x32_bf16 v[48:51], v[236:239], a[196:199], v[48:51]
s_waitcnt lgkmcnt(14)
ds_read_b128 a[228:231], v244 offset:6288
v_perm_b32 v232, v197, v196, v240
v_perm_b32 v233, v197, v196, v241
v_perm_b32 v234, v197, v196, v242
v_perm_b32 v235, v197, v196, v243
v_mfma_f32_16x16x32_bf16 v[52:55], v[236:239], a[200:203], v[52:55]
ds_read_b128 a[232:235], v244 offset:6448
ds_read_b128 a[236:239], v244 offset:6608
ds_read_u16 v204, v213 offset:36744
v_mfma_f32_16x16x32_bf16 v[48:51], v[232:235], a[200:203], v[48:51]
s_waitcnt lgkmcnt(15)
ds_read_u16 v205, v215 offset:36744
v_perm_b32 v236, v199, v198, v240
v_perm_b32 v237, v199, v198, v241
v_perm_b32 v238, v199, v198, v242
v_perm_b32 v239, v199, v198, v243
v_mfma_f32_16x16x32_bf16 v[52:55], v[232:235], a[204:207], v[52:55]
ds_read_u16 v206, v213 offset:37384
ds_read_u16 v207, v215 offset:37384
ds_write_b64 v245, a[54:55] offset:33312
v_mfma_f32_16x16x32_bf16 v[48:51], v[236:239], a[204:207], v[48:51]
s_waitcnt lgkmcnt(15)
ds_read_u16 v208, v213 offset:38024
v_perm_b32 v232, v201, v200, v240
v_perm_b32 v233, v201, v200, v241
v_perm_b32 v234, v201, v200, v242
v_perm_b32 v235, v201, v200, v243
v_mfma_f32_16x16x32_bf16 v[52:55], v[236:239], a[208:211], v[52:55]
ds_read_u16 v209, v215 offset:38024
ds_read_u16 v210, v213 offset:38664
ds_read_u16 v211, v215 offset:38664
ds_write_b64 v246, a[56:57] offset:30992
v_mfma_f32_16x16x32_bf16 v[48:51], v[232:235], a[208:211], v[48:51]
s_waitcnt lgkmcnt(15)
ds_write_b64 v246, a[58:59] offset:32928
v_perm_b32 v236, v203, v202, v240
v_perm_b32 v237, v203, v202, v241
v_perm_b32 v238, v203, v202, v242
v_perm_b32 v239, v203, v202, v243
v_mfma_f32_16x16x32_bf16 v[52:55], v[232:235], a[212:215], v[52:55]
s_mov_b64 exec, 0xffffffff
ds_write_b64 v246, a[60:61] offset:31312
s_mov_b64 exec, -1
s_mov_b64 exec, 0xffffffff
ds_write_b64 v246, a[62:63] offset:33248
s_mov_b64 exec, -1
s_waitcnt vmcnt(8) lgkmcnt(0)
s_barrier
s_cmp_eq_u32 s29, 0
s_cbranch_scc0 L_noWadd
v_mov_b32 v218, 1
v_mov_b32 v219, s2
s_mov_b64 exec, 1
buffer_store_byte v218, v219, s[68:71], 0 offen sc1
s_mov_b64 exec, -1
L_noWadd:
v_mfma_f32_16x16x32_bf16 v[56:59], v[236:239], a[216:219], 0
ds_read_u16 v192, v212 offset:40192
ds_read_u16 v193, v214 offset:40192
v_perm_b32 v232, v205, v204, v240
v_perm_b32 v233, v205, v204, v241
v_perm_b32 v234, v205, v204, v242
v_perm_b32 v235, v205, v204, v243
v_mfma_f32_16x16x32_bf16 v[60:63], v[236:239], a[220:223], 0
ds_read_b128 a[192:195], v244 offset:30992
ds_read_b128 a[196:199], v244 offset:31152
ds_read_b128 a[200:203], v244 offset:31312
v_mfma_f32_16x16x32_bf16 v[56:59], v[232:235], a[220:223], v[56:59]
ds_read_b128 a[204:207], v244 offset:31472
v_perm_b32 v236, v207, v206, v240
v_perm_b32 v237, v207, v206, v241
v_perm_b32 v238, v207, v206, v242
v_perm_b32 v239, v207, v206, v243
v_mfma_f32_16x16x32_bf16 v[60:63], v[232:235], a[224:227], v[60:63]
ds_read_b128 a[208:211], v244 offset:31632
ds_read_b128 a[212:215], v244 offset:31792
ds_read_u16 v194, v212 offset:40832
v_mfma_f32_16x16x32_bf16 v[56:59], v[236:239], a[224:227], v[56:59]
ds_read_u16 v195, v214 offset:40832
v_perm_b32 v232, v209, v208, v240
v_perm_b32 v233, v209, v208, v241
v_perm_b32 v234, v209, v208, v242
v_perm_b32 v235, v209, v208, v243
v_mfma_f32_16x16x32_bf16 v[60:63], v[236:239], a[228:231], v[60:63]
ds_read_u16 v196, v212 offset:41472
ds_read_u16 v197, v214 offset:41472
v_mfma_f32_16x16x32_bf16 v[56:59], v[232:235], a[228:231], v[56:59]
ds_read_u16 v198, v212 offset:42112
v_perm_b32 v236, v211, v210, v240
v_perm_b32 v237, v211, v210, v241
v_perm_b32 v238, v211, v210, v242
v_perm_b32 v239, v211, v210, v243
v_mfma_f32_16x16x32_bf16 v[60:63], v[232:235], a[232:235], v[60:63]
ds_read_u16 v199, v214 offset:42112
ds_read_u16 v200, v212 offset:42752
ds_read_u16 v201, v214 offset:42752
v_mfma_f32_16x16x32_bf16 v[56:59], v[236:239], a[232:235], v[56:59]
s_waitcnt lgkmcnt(14)
v_perm_b32 v232, v193, v192, v240
v_perm_b32 v233, v193, v192, v241
v_perm_b32 v234, v193, v192, v242
v_perm_b32 v235, v193, v192, v243
v_mfma_f32_16x16x32_bf16 v[60:63], v[236:239], a[236:239], v[60:63]
s_nop 0
s_waitcnt lgkmcnt(8)
v_mfma_f32_16x16x32_bf16 v[80:83], v[232:235], a[192:195], 0
s_waitcnt lgkmcnt(6)
ds_read_u16 v202, v212 offset:40200
ds_read_u16 v203, v214 offset:40200
v_perm_b32 v236, v195, v194, v240
v_perm_b32 v237, v195, v194, v241
v_perm_b32 v238, v195, v194, v242
v_perm_b32 v239, v195, v194, v243
v_mfma_f32_16x16x32_bf16 v[84:87], v[232:235], a[196:199], 0
ds_read_b128 a[216:219], v244 offset:32928
ds_read_b128 a[220:223], v244 offset:33088
ds_read_b128 a[224:227], v244 offset:33248
v_mfma_f32_16x16x32_bf16 v[80:83], v[236:239], a[196:199], v[80:83]
s_waitcnt lgkmcnt(9)
ds_read_b128 a[228:231], v244 offset:33408
v_perm_b32 v232, v197, v196, v240
v_perm_b32 v233, v197, v196, v241
v_perm_b32 v234, v197, v196, v242
v_perm_b32 v235, v197, v196, v243
v_mfma_f32_16x16x32_bf16 v[84:87], v[236:239], a[200:203], v[84:87]
buffer_load_dwordx4 a[128:131], v254, s[16:19], s60 offen offset:512
ds_read_b128 a[232:235], v244 offset:33568
ds_read_b128 a[236:239], v244 offset:33728
ds_read_u16 v204, v212 offset:40840
v_mfma_f32_16x16x32_bf16 v[80:83], v[232:235], a[200:203], v[80:83]
s_waitcnt lgkmcnt(11)
ds_read_u16 v205, v214 offset:40840
v_perm_b32 v236, v199, v198, v240
v_perm_b32 v237, v199, v198, v241
v_perm_b32 v238, v199, v198, v242
v_perm_b32 v239, v199, v198, v243
v_mfma_f32_16x16x32_bf16 v[84:87], v[232:235], a[204:207], v[84:87]
buffer_load_dwordx4 a[132:135], v254, s[16:19], s61 offen offset:512
ds_read_u16 v206, v212 offset:41480
ds_read_u16 v207, v214 offset:41480
ds_write_b64 v245, a[64:65] offset:0
v_mfma_f32_16x16x32_bf16 v[80:83], v[236:239], a[204:207], v[80:83]
s_waitcnt lgkmcnt(13)
ds_read_u16 v208, v212 offset:42120
v_perm_b32 v232, v201, v200, v240
v_perm_b32 v233, v201, v200, v241
v_perm_b32 v234, v201, v200, v242
v_perm_b32 v235, v201, v200, v243
v_mfma_f32_16x16x32_bf16 v[84:87], v[236:239], a[208:211], v[84:87]
buffer_load_dwordx4 a[136:139], v254, s[16:19], s62 offen offset:512
ds_read_u16 v209, v214 offset:42120
ds_read_u16 v210, v212 offset:42760
ds_read_u16 v211, v214 offset:42760
ds_write_b64 v245, a[66:67] offset:1936
v_mfma_f32_16x16x32_bf16 v[80:83], v[232:235], a[208:211], v[80:83]
s_waitcnt lgkmcnt(15)
ds_write_b64 v245, a[68:69] offset:64
v_perm_b32 v236, v203, v202, v240
v_perm_b32 v237, v203, v202, v241
v_perm_b32 v238, v203, v202, v242
v_perm_b32 v239, v203, v202, v243
v_mfma_f32_16x16x32_bf16 v[84:87], v[232:235], a[212:215], v[84:87]
buffer_load_dwordx4 a[140:143], v254, s[16:19], s63 offen offset:512
ds_write_b64 v245, a[70:71] offset:2000
ds_write_b64 v245, a[72:73] offset:160
ds_write_b64 v245, a[74:75] offset:2096
s_waitcnt lgkmcnt(14)
v_mfma_f32_16x16x32_bf16 v[88:91], v[236:239], a[216:219], 0
s_waitcnt lgkmcnt(12)
ds_read_u16 v192, v213 offset:40192
ds_read_u16 v193, v215 offset:40192
v_perm_b32 v232, v205, v204, v240
v_perm_b32 v233, v205, v204, v241
v_perm_b32 v234, v205, v204, v242
v_perm_b32 v235, v205, v204, v243
v_mfma_f32_16x16x32_bf16 v[92:95], v[236:239], a[220:223], 0
ds_read_b128 a[192:195], v244 offset:34864
ds_read_b128 a[196:199], v244 offset:35024
ds_read_b128 a[200:203], v244 offset:35184
s_cmp_eq_u32 s31, 0
s_cbranch_scc0 L_noresf1
ds_read_b128 a[32:35], v251 offset:30992
ds_read_b128 a[36:39], v251 offset:31008
ds_read_b128 a[40:43], v251 offset:32928
ds_read_b128 a[44:47], v251 offset:32944
ds_read_b128 a[48:51], v251 offset:46496
ds_read_b128 a[52:55], v251 offset:46512
ds_read_b128 a[56:59], v251 offset:48432
ds_read_b128 a[60:63], v251 offset:48448
L_noresf1:
v_mfma_f32_16x16x32_bf16 v[88:91], v[232:235], a[220:223], v[88:91]
s_waitcnt lgkmcnt(15)
ds_read_b128 a[204:207], v244 offset:35344
v_perm_b32 v236, v207, v206, v240
v_perm_b32 v237, v207, v206, v241
v_perm_b32 v238, v207, v206, v242
v_perm_b32 v239, v207, v206, v243
v_mfma_f32_16x16x32_bf16 v[92:95], v[232:235], a[224:227], v[92:95]
buffer_load_dwordx4 a[144:147], v254, s[16:19], s64 offen offset:512
ds_read_b128 a[208:211], v244 offset:35504
ds_read_b128 a[212:215], v244 offset:35664
ds_read_u16 v194, v213 offset:40832
v_mfma_f32_16x16x32_bf16 v[88:91], v[236:239], a[224:227], v[88:91]
s_waitcnt lgkmcnt(15)
ds_read_u16 v195, v215 offset:40832
v_perm_b32 v232, v209, v208, v240
v_perm_b32 v233, v209, v208, v241
v_perm_b32 v234, v209, v208, v242
v_perm_b32 v235, v209, v208, v243
v_mfma_f32_16x16x32_bf16 v[92:95], v[236:239], a[228:231], v[92:95]
buffer_load_dwordx4 a[148:151], v254, s[16:19], s65 offen offset:512
ds_read_u16 v196, v213 offset:41472
ds_read_u16 v197, v215 offset:41472
ds_write_b64 v245, a[76:77] offset:224
v_mfma_f32_16x16x32_bf16 v[88:91], v[232:235], a[228:231], v[88:91]
s_waitcnt lgkmcnt(15)
ds_read_u16 v198, v213 offset:42112
v_perm_b32 v236, v211, v210, v240
v_perm_b32 v237, v211, v210, v241
v_perm_b32 v238, v211, v210, v242
v_perm_b32 v239, v211, v210, v243
v_mfma_f32_16x16x32_bf16 v[92:95], v[232:235], a[232:235], v[92:95]
buffer_load_dwordx4 a[152:155], v255, s[16:19], s66 offen offset:512
ds_read_u16 v199, v215 offset:42112
ds_read_u16 v200, v213 offset:42752
ds_read_u16 v201, v215 offset:42752
ds_write_b64 v245, a[78:79] offset:2160
v_mfma_f32_16x16x32_bf16 v[88:91], v[236:239], a[232:235], v[88:91]
s_waitcnt lgkmcnt(15)
ds_write_b64 v245, a[80:81] offset:320
v_perm_b32 v232, v193, v192, v240
v_perm_b32 v233, v193, v192, v241
v_perm_b32 v234, v193, v192, v242
v_perm_b32 v235, v193, v192, v243
v_mfma_f32_16x16x32_bf16 v[92:95], v[236:239], a[236:239], v[92:95]
buffer_load_dwordx4 a[156:159], v255, s[16:19], s67 offen offset:512
ds_write_b64 v245, a[82:83] offset:2256
ds_write_b64 v245, a[84:85] offset:384
s_waitcnt lgkmcnt(13)
v_mfma_f32_16x16x32_bf16 v[112:115], v[232:235], a[192:195], 0
s_waitcnt lgkmcnt(11)
ds_read_u16 v202, v213 offset:40200
ds_read_u16 v203, v215 offset:40200
v_perm_b32 v236, v195, v194, v240
v_perm_b32 v237, v195, v194, v241
v_perm_b32 v238, v195, v194, v242
v_perm_b32 v239, v195, v194, v243
v_mfma_f32_16x16x32_bf16 v[116:119], v[232:235], a[196:199], 0
ds_read_b128 a[216:219], v244 offset:36800
ds_read_b128 a[220:223], v244 offset:36960
ds_read_b128 a[224:227], v244 offset:37120
v_mfma_f32_16x16x32_bf16 v[112:115], v[236:239], a[196:199], v[112:115]
s_waitcnt lgkmcnt(14)
ds_read_b128 a[228:231], v244 offset:37280
v_perm_b32 v232, v197, v196, v240
v_perm_b32 v233, v197, v196, v241
v_perm_b32 v234, v197, v196, v242
v_perm_b32 v235, v197, v196, v243
v_mfma_f32_16x16x32_bf16 v[116:119], v[236:239], a[200:203], v[116:119]
ds_read_b128 a[232:235], v244 offset:37440
ds_read_b128 a[236:239], v244 offset:37600
ds_read_u16 v204, v213 offset:40840
v_mfma_f32_16x16x32_bf16 v[112:115], v[232:235], a[200:203], v[112:115]
s_waitcnt lgkmcnt(15)
ds_read_u16 v205, v215 offset:40840
v_perm_b32 v236, v199, v198, v240
v_perm_b32 v237, v199, v198, v241
v_perm_b32 v238, v199, v198, v242
v_perm_b32 v239, v199, v198, v243
v_mfma_f32_16x16x32_bf16 v[116:119], v[232:235], a[204:207], v[116:119]
ds_read_u16 v206, v213 offset:41480
ds_read_u16 v207, v215 offset:41480
ds_write_b64 v245, a[86:87] offset:2320
v_mfma_f32_16x16x32_bf16 v[112:115], v[236:239], a[204:207], v[112:115]
s_waitcnt lgkmcnt(15)
ds_read_u16 v208, v213 offset:42120
v_perm_b32 v232, v201, v200, v240
v_perm_b32 v233, v201, v200, v241
v_perm_b32 v234, v201, v200, v242
v_perm_b32 v235, v201, v200, v243
v_mfma_f32_16x16x32_bf16 v[116:119], v[236:239], a[208:211], v[116:119]
ds_read_u16 v209, v215 offset:42120
ds_read_u16 v210, v213 offset:42760
ds_read_u16 v211, v215 offset:42760
ds_write_b64 v246, a[88:89] offset:0
v_mfma_f32_16x16x32_bf16 v[112:115], v[232:235], a[208:211], v[112:115]
s_waitcnt lgkmcnt(15)
ds_write_b64 v246, a[90:91] offset:1936
v_perm_b32 v236, v203, v202, v240
v_perm_b32 v237, v203, v202, v241
v_perm_b32 v238, v203, v202, v242
v_perm_b32 v239, v203, v202, v243
v_mfma_f32_16x16x32_bf16 v[116:119], v[232:235], a[212:215], v[116:119]
s_mov_b64 exec, 0xffffffff
ds_write_b64 v246, a[92:93] offset:320
s_mov_b64 exec, -1
s_mov_b64 exec, 0xffffffff
ds_write_b64 v246, a[94:95] offset:2256
s_mov_b64 exec, -1
s_waitcnt lgkmcnt(0)
s_barrier
v_mfma_f32_16x16x32_bf16 v[120:123], v[236:239], a[216:219], 0
ds_read_u16 v192, v212 offset:44288
ds_read_u16 v193, v214 offset:44288
v_perm_b32 v232, v205, v204, v240
v_perm_b32 v233, v205, v204, v241
v_perm_b32 v234, v205, v204, v242
v_perm_b32 v235, v205, v204, v243
v_mfma_f32_16x16x32_bf16 v[124:127], v[236:239], a[220:223], 0
ds_read_b128 a[192:195], v244 offset:0
ds_read_b128 a[196:199], v244 offset:160
ds_read_b128 a[200:203], v244 offset:320
v_mfma_f32_16x16x32_bf16 v[120:123], v[232:235], a[220:223], v[120:123]
ds_read_b128 a[204:207], v244 offset:480
v_perm_b32 v236, v207, v206, v240
v_perm_b32 v237, v207, v206, v241
v_perm_b32 v238, v207, v206, v242
v_perm_b32 v239, v207, v206, v243
v_mfma_f32_16x16x32_bf16 v[124:127], v[232:235], a[224:227], v[124:127]
ds_read_b128 a[208:211], v244 offset:640
ds_read_b128 a[212:215], v244 offset:800
ds_read_u16 v194, v212 offset:44928
v_mfma_f32_16x16x32_bf16 v[120:123], v[236:239], a[224:227], v[120:123]
ds_read_u16 v195, v214 offset:44928
v_perm_b32 v232, v209, v208, v240
v_perm_b32 v233, v209, v208, v241
v_perm_b32 v234, v209, v208, v242
v_perm_b32 v235, v209, v208, v243
v_mfma_f32_16x16x32_bf16 v[124:127], v[236:239], a[228:231], v[124:127]
ds_read_u16 v196, v212 offset:45568
ds_read_u16 v197, v214 offset:45568
v_mfma_f32_16x16x32_bf16 v[120:123], v[232:235], a[228:231], v[120:123]
ds_read_u16 v198, v212 offset:46208
v_perm_b32 v236, v211, v210, v240
v_perm_b32 v237, v211, v210, v241
v_perm_b32 v238, v211, v210, v242
v_perm_b32 v239, v211, v210, v243
v_mfma_f32_16x16x32_bf16 v[124:127], v[232:235], a[232:235], v[124:127]
ds_read_u16 v199, v214 offset:46208
ds_read_u16 v200, v212 offset:46848
ds_read_u16 v201, v214 offset:46848
v_mfma_f32_16x16x32_bf16 v[120:123], v[236:239], a[232:235], v[120:123]
s_waitcnt lgkmcnt(14)
v_perm_b32 v232, v193, v192, v240
v_perm_b32 v233, v193, v192, v241
v_perm_b32 v234, v193, v192, v242
v_perm_b32 v235, v193, v192, v243
v_mfma_f32_16x16x32_bf16 v[124:127], v[236:239], a[236:239], v[124:127]
s_nop 0
s_waitcnt lgkmcnt(8)
v_mfma_f32_16x16x32_bf16 v[144:147], v[232:235], a[192:195], 0
s_waitcnt lgkmcnt(6)
s_waitcnt vmcnt(8)
ds_read_u16 v202, v212 offset:44296
ds_read_u16 v203, v214 offset:44296
v_perm_b32 v236, v195, v194, v240
v_perm_b32 v237, v195, v194, v241
v_perm_b32 v238, v195, v194, v242
v_perm_b32 v239, v195, v194, v243
v_mfma_f32_16x16x32_bf16 v[148:151], v[232:235], a[196:199], 0
ds_read_b128 a[216:219], v244 offset:1936
ds_read_b128 a[220:223], v244 offset:2096
ds_read_b128 a[224:227], v244 offset:2256
v_mfma_f32_16x16x32_bf16 v[144:147], v[236:239], a[196:199], v[144:147]
s_waitcnt lgkmcnt(9)
ds_read_b128 a[228:231], v244 offset:2416
v_perm_b32 v232, v197, v196, v240
v_perm_b32 v233, v197, v196, v241
v_perm_b32 v234, v197, v196, v242
v_perm_b32 v235, v197, v196, v243
v_mfma_f32_16x16x32_bf16 v[148:151], v[236:239], a[200:203], v[148:151]
buffer_load_dwordx4 a[160:163], v254, s[16:19], s60 offen offset:640
ds_read_b128 a[232:235], v244 offset:2576
ds_read_b128 a[236:239], v244 offset:2736
ds_read_u16 v204, v212 offset:44936
v_mfma_f32_16x16x32_bf16 v[144:147], v[232:235], a[200:203], v[144:147]
s_waitcnt lgkmcnt(11)
ds_read_u16 v205, v214 offset:44936
v_perm_b32 v236, v199, v198, v240
v_perm_b32 v237, v199, v198, v241
v_perm_b32 v238, v199, v198, v242
v_perm_b32 v239, v199, v198, v243
v_mfma_f32_16x16x32_bf16 v[148:151], v[232:235], a[204:207], v[148:151]
buffer_load_dwordx4 a[164:167], v254, s[16:19], s61 offen offset:640
ds_read_u16 v206, v212 offset:45576
ds_read_u16 v207, v214 offset:45576
ds_write_b64 v245, a[96:97] offset:30992
v_mfma_f32_16x16x32_bf16 v[144:147], v[236:239], a[204:207], v[144:147]
s_waitcnt lgkmcnt(13)
ds_read_u16 v208, v212 offset:46216
v_perm_b32 v232, v201, v200, v240
v_perm_b32 v233, v201, v200, v241
v_perm_b32 v234, v201, v200, v242
v_perm_b32 v235, v201, v200, v243
v_mfma_f32_16x16x32_bf16 v[148:151], v[236:239], a[208:211], v[148:151]
buffer_load_dwordx4 a[168:171], v254, s[16:19], s62 offen offset:640
ds_read_u16 v209, v214 offset:46216
ds_read_u16 v210, v212 offset:46856
ds_read_u16 v211, v214 offset:46856
ds_write_b64 v245, a[98:99] offset:32928
v_mfma_f32_16x16x32_bf16 v[144:147], v[232:235], a[208:211], v[144:147]
s_waitcnt lgkmcnt(15)
ds_write_b64 v245, a[100:101] offset:31056
v_perm_b32 v236, v203, v202, v240
v_perm_b32 v237, v203, v202, v241
v_perm_b32 v238, v203, v202, v242
v_perm_b32 v239, v203, v202, v243
v_mfma_f32_16x16x32_bf16 v[148:151], v[232:235], a[212:215], v[148:151]
buffer_load_dwordx4 a[172:175], v254, s[16:19], s63 offen offset:640
ds_write_b64 v245, a[102:103] offset:32992
ds_write_b64 v245, a[104:105] offset:31152
ds_write_b64 v245, a[106:107] offset:33088
s_waitcnt lgkmcnt(14)
v_mfma_f32_16x16x32_bf16 v[152:155], v[236:239], a[216:219], 0
s_waitcnt lgkmcnt(12)
ds_read_u16 v192, v213 offset:44288
ds_read_u16 v193, v215 offset:44288
v_perm_b32 v232, v205, v204, v240
v_perm_b32 v233, v205, v204, v241
v_perm_b32 v234, v205, v204, v242
v_perm_b32 v235, v205, v204, v243
v_mfma_f32_16x16x32_bf16 v[156:159], v[236:239], a[220:223], 0
ds_read_b128 a[192:195], v244 offset:3872
ds_read_b128 a[196:199], v244 offset:4032
ds_read_b128 a[200:203], v244 offset:4192
s_cmp_eq_u32 s31, 0
s_cbranch_scc0 L_noresf2
ds_read_b128 a[64:67], v251 offset:0
ds_read_b128 a[68:71], v251 offset:16
ds_read_b128 a[72:75], v251 offset:1936
ds_read_b128 a[76:79], v251 offset:1952
ds_read_b128 a[80:83], v251 offset:15504
ds_read_b128 a[84:87], v251 offset:15520
ds_read_b128 a[88:91], v251 offset:17440
ds_read_b128 a[92:95], v251 offset:17456
L_noresf2:
v_mfma_f32_16x16x32_bf16 v[152:155], v[232:235], a[220:223], v[152:155]
s_waitcnt lgkmcnt(15)
ds_read_b128 a[204:207], v244 offset:4352
v_perm_b32 v236, v207, v206, v240
v_perm_b32 v237, v207, v206, v241
v_perm_b32 v238, v207, v206, v242
v_perm_b32 v239, v207, v206, v243
v_mfma_f32_16x16x32_bf16 v[156:159], v[232:235], a[224:227], v[156:159]
buffer_load_dwordx4 a[176:179], v254, s[16:19], s64 offen offset:640
ds_read_b128 a[208:211], v244 offset:4512
ds_read_b128 a[212:215], v244 offset:4672
ds_read_u16 v194, v213 offset:44928
v_mfma_f32_16x16x32_bf16 v[152:155], v[236:239], a[224:227], v[152:155]
s_waitcnt lgkmcnt(15)
ds_read_u16 v195, v215 offset:44928
v_perm_b32 v232, v209, v208, v240
v_perm_b32 v233, v209, v208, v241
v_perm_b32 v234, v209, v208, v242
v_perm_b32 v235, v209, v208, v243
v_mfma_f32_16x16x32_bf16 v[156:159], v[236:239], a[228:231], v[156:159]
buffer_load_dwordx4 a[180:183], v254, s[16:19], s65 offen offset:640
ds_read_u16 v196, v213 offset:45568
ds_read_u16 v197, v215 offset:45568
ds_write_b64 v245, a[108:109] offset:31216
v_mfma_f32_16x16x32_bf16 v[152:155], v[232:235], a[228:231], v[152:155]
s_waitcnt lgkmcnt(15)
ds_read_u16 v198, v213 offset:46208
v_perm_b32 v236, v211, v210, v240
v_perm_b32 v237, v211, v210, v241
v_perm_b32 v238, v211, v210, v242
v_perm_b32 v239, v211, v210, v243
v_mfma_f32_16x16x32_bf16 v[156:159], v[232:235], a[232:235], v[156:159]
buffer_load_dwordx4 a[184:187], v255, s[16:19], s66 offen offset:640
ds_read_u16 v199, v215 offset:46208
ds_read_u16 v200, v213 offset:46848
ds_read_u16 v201, v215 offset:46848
ds_write_b64 v245, a[110:111] offset:33152
v_mfma_f32_16x16x32_bf16 v[152:155], v[236:239], a[232:235], v[152:155]
s_waitcnt lgkmcnt(15)
ds_write_b64 v245, a[112:113] offset:31312
v_perm_b32 v232, v193, v192, v240
v_perm_b32 v233, v193, v192, v241
v_perm_b32 v234, v193, v192, v242
v_perm_b32 v235, v193, v192, v243
v_mfma_f32_16x16x32_bf16 v[156:159], v[236:239], a[236:239], v[156:159]
buffer_load_dwordx4 a[188:191], v255, s[16:19], s67 offen offset:640
ds_write_b64 v245, a[114:115] offset:33248
ds_write_b64 v245, a[116:117] offset:31376
s_waitcnt lgkmcnt(13)
v_mfma_f32_16x16x32_bf16 v[176:179], v[232:235], a[192:195], 0
s_waitcnt lgkmcnt(11)
ds_read_u16 v202, v213 offset:44296
ds_read_u16 v203, v215 offset:44296
v_perm_b32 v236, v195, v194, v240
v_perm_b32 v237, v195, v194, v241
v_perm_b32 v238, v195, v194, v242
v_perm_b32 v239, v195, v194, v243
v_mfma_f32_16x16x32_bf16 v[180:183], v[232:235], a[196:199], 0
ds_read_b128 a[216:219], v244 offset:5808
ds_read_b128 a[220:223], v244 offset:5968
ds_read_b128 a[224:227], v244 offset:6128
v_mfma_f32_16x16x32_bf16 v[176:179], v[236:239], a[196:199], v[176:179]
s_waitcnt lgkmcnt(14)
ds_read_b128 a[228:231], v244 offset:6288
v_perm_b32 v232, v197, v196, v240
v_perm_b32 v233, v197, v196, v241
v_perm_b32 v234, v197, v196, v242
v_perm_b32 v235, v197, v196, v243
v_mfma_f32_16x16x32_bf16 v[180:183], v[236:239], a[200:203], v[180:183]
ds_read_b128 a[232:235], v244 offset:6448
ds_read_b128 a[236:239], v244 offset:6608
ds_read_u16 v204, v213 offset:44936
v_mfma_f32_16x16x32_bf16 v[176:179], v[232:235], a[200:203], v[176:179]
s_waitcnt lgkmcnt(15)
ds_read_u16 v205, v215 offset:44936
v_perm_b32 v236, v199, v198, v240
v_perm_b32 v237, v199, v198, v241
v_perm_b32 v238, v199, v198, v242
v_perm_b32 v239, v199, v198, v243
v_mfma_f32_16x16x32_bf16 v[180:183], v[232:235], a[204:207], v[180:183]
ds_read_u16 v206, v213 offset:45576
ds_read_u16 v207, v215 offset:45576
ds_write_b64 v245, a[118:119] offset:33312
v_mfma_f32_16x16x32_bf16 v[176:179], v[236:239], a[204:207], v[176:179]
s_waitcnt lgkmcnt(15)
ds_read_u16 v208, v213 offset:46216
v_perm_b32 v232, v201, v200, v240
v_perm_b32 v233, v201, v200, v241
v_perm_b32 v234, v201, v200, v242
v_perm_b32 v235, v201, v200, v243
v_mfma_f32_16x16x32_bf16 v[180:183], v[236:239], a[208:211], v[180:183]
ds_read_u16 v209, v215 offset:46216
ds_read_u16 v210, v213 offset:46856
ds_read_u16 v211, v215 offset:46856
ds_write_b64 v246, a[120:121] offset:30992
v_mfma_f32_16x16x32_bf16 v[176:179], v[232:235], a[208:211], v[176:179]
s_waitcnt lgkmcnt(15)
ds_write_b64 v246, a[122:123] offset:32928
v_perm_b32 v236, v203, v202, v240
v_perm_b32 v237, v203, v202, v241
v_perm_b32 v238, v203, v202, v242
v_perm_b32 v239, v203, v202, v243
v_mfma_f32_16x16x32_bf16 v[180:183], v[232:235], a[212:215], v[180:183]
s_mov_b64 exec, 0xffffffff
ds_write_b64 v246, a[124:125] offset:31312
s_mov_b64 exec, -1
s_mov_b64 exec, 0xffffffff
ds_write_b64 v246, a[126:127] offset:33248
s_mov_b64 exec, -1
s_waitcnt lgkmcnt(0)
s_barrier
v_mfma_f32_16x16x32_bf16 v[184:187], v[236:239], a[216:219], 0
ds_read_u16 v192, v212 offset:48384
ds_read_u16 v193, v214 offset:48384
v_perm_b32 v232, v205, v204, v240
v_perm_b32 v233, v205, v204, v241
v_perm_b32 v234, v205, v204, v242
v_perm_b32 v235, v205, v204, v243
v_mfma_f32_16x16x32_bf16 v[188:191], v[236:239], a[220:223], 0
ds_read_b128 a[192:195], v244 offset:30992
ds_read_b128 a[196:199], v244 offset:31152
ds_read_b128 a[200:203], v244 offset:31312
v_mfma_f32_16x16x32_bf16 v[184:187], v[232:235], a[220:223], v[184:187]
ds_read_b128 a[204:207], v244 offset:31472
v_perm_b32 v236, v207, v206, v240
v_perm_b32 v237, v207, v206, v241
v_perm_b32 v238, v207, v206, v242
v_perm_b32 v239, v207, v206, v243
v_mfma_f32_16x16x32_bf16 v[188:191], v[232:235], a[224:227], v[188:191]
ds_read_b128 a[208:211], v244 offset:31632
ds_read_b128 a[212:215], v244 offset:31792
ds_read_u16 v194, v212 offset:49024
v_mfma_f32_16x16x32_bf16 v[184:187], v[236:239], a[224:227], v[184:187]
ds_read_u16 v195, v214 offset:49024
v_perm_b32 v232, v209, v208, v240
v_perm_b32 v233, v209, v208, v241
v_perm_b32 v234, v209, v208, v242
v_perm_b32 v235, v209, v208, v243
v_mfma_f32_16x16x32_bf16 v[188:191], v[236:239], a[228:231], v[188:191]
ds_read_u16 v196, v212 offset:49664
ds_read_u16 v197, v214 offset:49664
v_mfma_f32_16x16x32_bf16 v[184:187], v[232:235], a[228:231], v[184:187]
ds_read_u16 v198, v212 offset:50304
v_perm_b32 v236, v211, v210, v240
v_perm_b32 v237, v211, v210, v241
v_perm_b32 v238, v211, v210, v242
v_perm_b32 v239, v211, v210, v243
v_mfma_f32_16x16x32_bf16 v[188:191], v[232:235], a[232:235], v[188:191]
ds_read_u16 v199, v214 offset:50304
ds_read_u16 v200, v212 offset:50944
ds_read_u16 v201, v214 offset:50944
v_mfma_f32_16x16x32_bf16 v[184:187], v[236:239], a[232:235], v[184:187]
s_waitcnt lgkmcnt(14)
v_perm_b32 v232, v193, v192, v240
v_perm_b32 v233, v193, v192, v241
v_perm_b32 v234, v193, v192, v242
v_perm_b32 v235, v193, v192, v243
v_mfma_f32_16x16x32_bf16 v[188:191], v[236:239], a[236:239], v[188:191]
s_nop 0
s_waitcnt lgkmcnt(8)
v_mfma_f32_16x16x32_bf16 v[0:3], v[232:235], a[192:195], 0
s_waitcnt lgkmcnt(6)
s_waitcnt vmcnt(8)
ds_read_u16 v202, v212 offset:48392
ds_read_u16 v203, v214 offset:48392
v_perm_b32 v236, v195, v194, v240
v_perm_b32 v237, v195, v194, v241
v_perm_b32 v238, v195, v194, v242
v_perm_b32 v239, v195, v194, v243
v_mfma_f32_16x16x32_bf16 v[4:7], v[232:235], a[196:199], 0
ds_read_b128 a[216:219], v244 offset:32928
ds_read_b128 a[220:223], v244 offset:33088
ds_read_b128 a[224:227], v244 offset:33248
v_mfma_f32_16x16x32_bf16 v[0:3], v[236:239], a[196:199], v[0:3]
s_waitcnt lgkmcnt(9)
ds_read_b128 a[228:231], v244 offset:33408
v_perm_b32 v232, v197, v196, v240
v_perm_b32 v233, v197, v196, v241
v_perm_b32 v234, v197, v196, v242
v_perm_b32 v235, v197, v196, v243
v_mfma_f32_16x16x32_bf16 v[4:7], v[236:239], a[200:203], v[4:7]
ds_read_b128 a[232:235], v244 offset:33568
ds_read_b128 a[236:239], v244 offset:33728
ds_read_u16 v204, v212 offset:49032
v_mfma_f32_16x16x32_bf16 v[0:3], v[232:235], a[200:203], v[0:3]
s_waitcnt lgkmcnt(11)
ds_read_u16 v205, v214 offset:49032
v_perm_b32 v236, v199, v198, v240
v_perm_b32 v237, v199, v198, v241
v_perm_b32 v238, v199, v198, v242
v_perm_b32 v239, v199, v198, v243
v_mfma_f32_16x16x32_bf16 v[4:7], v[232:235], a[204:207], v[4:7]
ds_read_u16 v206, v212 offset:49672
ds_read_u16 v207, v214 offset:49672
ds_write_b64 v245, a[128:129] offset:0
v_mfma_f32_16x16x32_bf16 v[0:3], v[236:239], a[204:207], v[0:3]
s_waitcnt lgkmcnt(13)
ds_read_u16 v208, v212 offset:50312
v_perm_b32 v232, v201, v200, v240
v_perm_b32 v233, v201, v200, v241
v_perm_b32 v234, v201, v200, v242
v_perm_b32 v235, v201, v200, v243
v_mfma_f32_16x16x32_bf16 v[4:7], v[236:239], a[208:211], v[4:7]
ds_read_u16 v209, v214 offset:50312
ds_read_u16 v210, v212 offset:50952
ds_read_u16 v211, v214 offset:50952
ds_write_b64 v245, a[130:131] offset:1936
v_mfma_f32_16x16x32_bf16 v[0:3], v[232:235], a[208:211], v[0:3]
s_waitcnt lgkmcnt(15)
ds_write_b64 v245, a[132:133] offset:64
v_perm_b32 v236, v203, v202, v240
v_perm_b32 v237, v203, v202, v241
v_perm_b32 v238, v203, v202, v242
v_perm_b32 v239, v203, v202, v243
v_mfma_f32_16x16x32_bf16 v[4:7], v[232:235], a[212:215], v[4:7]
ds_write_b64 v245, a[134:135] offset:2000
ds_write_b64 v245, a[136:137] offset:160
ds_write_b64 v245, a[138:139] offset:2096
s_waitcnt lgkmcnt(14)
v_mfma_f32_16x16x32_bf16 v[8:11], v[236:239], a[216:219], 0
s_waitcnt lgkmcnt(12)
ds_read_u16 v192, v213 offset:48384
ds_read_u16 v193, v215 offset:48384
v_perm_b32 v232, v205, v204, v240
v_perm_b32 v233, v205, v204, v241
v_perm_b32 v234, v205, v204, v242
v_perm_b32 v235, v205, v204, v243
v_mfma_f32_16x16x32_bf16 v[12:15], v[236:239], a[220:223], 0
ds_read_b128 a[192:195], v244 offset:34864
ds_read_b128 a[196:199], v244 offset:35024
ds_read_b128 a[200:203], v244 offset:35184
s_cmp_eq_u32 s31, 1
s_cbranch_scc0 L_noresf3
ds_read_b128 a[0:3], v251 offset:30992
ds_read_b128 a[4:7], v251 offset:31008
ds_read_b128 a[8:11], v251 offset:32928
ds_read_b128 a[12:15], v251 offset:32944
ds_read_b128 a[16:19], v251 offset:46496
ds_read_b128 a[20:23], v251 offset:46512
ds_read_b128 a[24:27], v251 offset:48432
ds_read_b128 a[28:31], v251 offset:48448
L_noresf3:
v_mfma_f32_16x16x32_bf16 v[8:11], v[232:235], a[220:223], v[8:11]
s_waitcnt lgkmcnt(15)
ds_read_b128 a[204:207], v244 offset:35344
v_perm_b32 v236, v207, v206, v240
v_perm_b32 v237, v207, v206, v241
v_perm_b32 v238, v207, v206, v242
v_perm_b32 v239, v207, v206, v243
v_mfma_f32_16x16x32_bf16 v[12:15], v[232:235], a[224:227], v[12:15]
ds_read_b128 a[208:211], v244 offset:35504
ds_read_b128 a[212:215], v244 offset:35664
ds_read_u16 v194, v213 offset:49024
v_mfma_f32_16x16x32_bf16 v[8:11], v[236:239], a[224:227], v[8:11]
s_waitcnt lgkmcnt(15)
ds_read_u16 v195, v215 offset:49024
v_perm_b32 v232, v209, v208, v240
v_perm_b32 v233, v209, v208, v241
v_perm_b32 v234, v209, v208, v242
v_perm_b32 v235, v209, v208, v243
v_mfma_f32_16x16x32_bf16 v[12:15], v[236:239], a[228:231], v[12:15]
ds_read_u16 v196, v213 offset:49664
ds_read_u16 v197, v215 offset:49664
ds_write_b64 v245, a[140:141] offset:224
v_mfma_f32_16x16x32_bf16 v[8:11], v[232:235], a[228:231], v[8:11]
s_waitcnt lgkmcnt(15)
ds_read_u16 v198, v213 offset:50304
v_perm_b32 v236, v211, v210, v240
v_perm_b32 v237, v211, v210, v241
v_perm_b32 v238, v211, v210, v242
v_perm_b32 v239, v211, v210, v243
v_mfma_f32_16x16x32_bf16 v[12:15], v[232:235], a[232:235], v[12:15]
ds_read_u16 v199, v215 offset:50304
ds_read_u16 v200, v213 offset:50944
ds_read_u16 v201, v215 offset:50944
ds_write_b64 v245, a[142:143] offset:2160
v_mfma_f32_16x16x32_bf16 v[8:11], v[236:239], a[232:235], v[8:11]
s_waitcnt lgkmcnt(15)
ds_write_b64 v245, a[144:145] offset:320
v_perm_b32 v232, v193, v192, v240
v_perm_b32 v233, v193, v192, v241
v_perm_b32 v234, v193, v192, v242
v_perm_b32 v235, v193, v192, v243
v_mfma_f32_16x16x32_bf16 v[12:15], v[236:239], a[236:239], v[12:15]
ds_write_b64 v245, a[146:147] offset:2256
ds_write_b64 v245, a[148:149] offset:384
s_waitcnt lgkmcnt(13)
v_mfma_f32_16x16x32_bf16 v[32:35], v[232:235], a[192:195], 0
s_waitcnt lgkmcnt(11)
ds_read_u16 v202, v213 offset:48392
ds_read_u16 v203, v215 offset:48392
v_perm_b32 v236, v195, v194, v240
v_perm_b32 v237, v195, v194, v241
v_perm_b32 v238, v195, v194, v242
v_perm_b32 v239, v195, v194, v243
v_mfma_f32_16x16x32_bf16 v[36:39], v[232:235], a[196:199], 0
ds_read_b128 a[216:219], v244 offset:36800
ds_read_b128 a[220:223], v244 offset:36960
ds_read_b128 a[224:227], v244 offset:37120
v_mfma_f32_16x16x32_bf16 v[32:35], v[236:239], a[196:199], v[32:35]
s_waitcnt lgkmcnt(14)
ds_read_b128 a[228:231], v244 offset:37280
v_perm_b32 v232, v197, v196, v240
v_perm_b32 v233, v197, v196, v241
v_perm_b32 v234, v197, v196, v242
v_perm_b32 v235, v197, v196, v243
v_mfma_f32_16x16x32_bf16 v[36:39], v[236:239], a[200:203], v[36:39]
ds_read_b128 a[232:235], v244 offset:37440
ds_read_b128 a[236:239], v244 offset:37600
ds_read_u16 v204, v213 offset:49032
v_mfma_f32_16x16x32_bf16 v[32:35], v[232:235], a[200:203], v[32:35]
s_waitcnt lgkmcnt(15)
ds_read_u16 v205, v215 offset:49032
v_perm_b32 v236, v199, v198, v240
v_perm_b32 v237, v199, v198, v241
v_perm_b32 v238, v199, v198, v242
v_perm_b32 v239, v199, v198, v243
v_mfma_f32_16x16x32_bf16 v[36:39], v[232:235], a[204:207], v[36:39]
ds_read_u16 v206, v213 offset:49672
ds_read_u16 v207, v215 offset:49672
ds_write_b64 v245, a[150:151] offset:2320
v_mfma_f32_16x16x32_bf16 v[32:35], v[236:239], a[204:207], v[32:35]
s_waitcnt lgkmcnt(15)
ds_read_u16 v208, v213 offset:50312
v_perm_b32 v232, v201, v200, v240
v_perm_b32 v233, v201, v200, v241
v_perm_b32 v234, v201, v200, v242
v_perm_b32 v235, v201, v200, v243
v_mfma_f32_16x16x32_bf16 v[36:39], v[236:239], a[208:211], v[36:39]
ds_read_u16 v209, v215 offset:50312
ds_read_u16 v210, v213 offset:50952
ds_read_u16 v211, v215 offset:50952
ds_write_b64 v246, a[152:153] offset:0
v_mfma_f32_16x16x32_bf16 v[32:35], v[232:235], a[208:211], v[32:35]
s_waitcnt lgkmcnt(15)
ds_write_b64 v246, a[154:155] offset:1936
v_perm_b32 v236, v203, v202, v240
v_perm_b32 v237, v203, v202, v241
v_perm_b32 v238, v203, v202, v242
v_perm_b32 v239, v203, v202, v243
v_mfma_f32_16x16x32_bf16 v[36:39], v[232:235], a[212:215], v[36:39]
s_mov_b64 exec, 0xffffffff
ds_write_b64 v246, a[156:157] offset:320
s_mov_b64 exec, -1
s_mov_b64 exec, 0xffffffff
ds_write_b64 v246, a[158:159] offset:2256
s_mov_b64 exec, -1
v_mbcnt_lo_u32_b32 v219, -1, 0
v_mbcnt_hi_u32_b32 v219, -1, v219
v_lshlrev_b32 v219, 2, v219
buffer_load_dword v217, v219, s[68:71], 0 offen sc1
s_waitcnt lgkmcnt(0)
s_barrier
v_mfma_f32_16x16x32_bf16 v[40:43], v[236:239], a[216:219], 0
ds_read_u16 v192, v212 offset:0
ds_read_u16 v193, v214 offset:0
v_perm_b32 v232, v205, v204, v240
v_perm_b32 v233, v205, v204, v241
v_perm_b32 v234, v205, v204, v242
v_perm_b32 v235, v205, v204, v243
v_mfma_f32_16x16x32_bf16 v[44:47], v[236:239], a[220:223], 0
ds_read_b128 a[192:195], v244 offset:0
ds_read_b128 a[196:199], v244 offset:160
ds_read_b128 a[200:203], v244 offset:320
v_mfma_f32_16x16x32_bf16 v[40:43], v[232:235], a[220:223], v[40:43]
ds_read_b128 a[204:207], v244 offset:480
v_perm_b32 v236, v207, v206, v240
v_perm_b32 v237, v207, v206, v241
v_perm_b32 v238, v207, v206, v242
v_perm_b32 v239, v207, v206, v243
v_mfma_f32_16x16x32_bf16 v[44:47], v[232:235], a[224:227], v[44:47]
ds_read_b128 a[208:211], v244 offset:640
ds_read_b128 a[212:215], v244 offset:800
ds_read_u16 v194, v212 offset:640
v_mfma_f32_16x16x32_bf16 v[40:43], v[236:239], a[224:227], v[40:43]
ds_read_u16 v195, v214 offset:640
v_perm_b32 v232, v209, v208, v240
v_perm_b32 v233, v209, v208, v241
v_perm_b32 v234, v209, v208, v242
v_perm_b32 v235, v209, v208, v243
v_mfma_f32_16x16x32_bf16 v[44:47], v[236:239], a[228:231], v[44:47]
ds_read_u16 v196, v212 offset:1280
ds_read_u16 v197, v214 offset:1280
v_mfma_f32_16x16x32_bf16 v[40:43], v[232:235], a[228:231], v[40:43]
ds_read_u16 v198, v212 offset:1920
v_perm_b32 v236, v211, v210, v240
v_perm_b32 v237, v211, v210, v241
v_perm_b32 v238, v211, v210, v242
v_perm_b32 v239, v211, v210, v243
v_mfma_f32_16x16x32_bf16 v[44:47], v[232:235], a[232:235], v[44:47]
ds_read_u16 v199, v214 offset:1920
ds_read_u16 v200, v212 offset:2560
ds_read_u16 v201, v214 offset:2560
v_mfma_f32_16x16x32_bf16 v[40:43], v[236:239], a[232:235], v[40:43]
s_waitcnt lgkmcnt(14)
v_perm_b32 v232, v193, v192, v240
v_perm_b32 v233, v193, v192, v241
v_perm_b32 v234, v193, v192, v242
v_perm_b32 v235, v193, v192, v243
v_mfma_f32_16x16x32_bf16 v[44:47], v[236:239], a[236:239], v[44:47]
s_nop 0
s_waitcnt lgkmcnt(8)
v_mfma_f32_16x16x32_bf16 v[64:67], v[232:235], a[192:195], 0
s_waitcnt lgkmcnt(6)
s_waitcnt vmcnt(1)
ds_read_u16 v202, v212 offset:8
ds_read_u16 v203, v214 offset:8
v_perm_b32 v236, v195, v194, v240
v_perm_b32 v237, v195, v194, v241
v_perm_b32 v238, v195, v194, v242
v_perm_b32 v239, v195, v194, v243
v_mfma_f32_16x16x32_bf16 v[68:71], v[232:235], a[196:199], 0
ds_read_b128 a[216:219], v244 offset:1936
ds_read_b128 a[220:223], v244 offset:2096
ds_read_b128 a[224:227], v244 offset:2256
v_mfma_f32_16x16x32_bf16 v[64:67], v[236:239], a[196:199], v[64:67]
s_waitcnt lgkmcnt(9)
ds_read_b128 a[228:231], v244 offset:2416
v_perm_b32 v232, v197, v196, v240
v_perm_b32 v233, v197, v196, v241
v_perm_b32 v234, v197, v196, v242
v_perm_b32 v235, v197, v196, v243
v_mfma_f32_16x16x32_bf16 v[68:71], v[236:239], a[200:203], v[68:71]
ds_read_b128 a[232:235], v244 offset:2576
ds_read_b128 a[236:239], v244 offset:2736
ds_read_u16 v204, v212 offset:648
v_mfma_f32_16x16x32_bf16 v[64:67], v[232:235], a[200:203], v[64:67]
s_waitcnt lgkmcnt(11)
ds_read_u16 v205, v214 offset:648
v_perm_b32 v236, v199, v198, v240
v_perm_b32 v237, v199, v198, v241
v_perm_b32 v238, v199, v198, v242
v_perm_b32 v239, v199, v198, v243
v_mfma_f32_16x16x32_bf16 v[68:71], v[232:235], a[204:207], v[68:71]
ds_read_u16 v206, v212 offset:1288
ds_read_u16 v207, v214 offset:1288
ds_write_b64 v245, a[160:161] offset:30992
v_mfma_f32_16x16x32_bf16 v[64:67], v[236:239], a[204:207], v[64:67]
s_waitcnt lgkmcnt(13)
ds_read_u16 v208, v212 offset:1928
v_perm_b32 v232, v201, v200, v240
v_perm_b32 v233, v201, v200, v241
v_perm_b32 v234, v201, v200, v242
v_perm_b32 v235, v201, v200, v243
v_mfma_f32_16x16x32_bf16 v[68:71], v[236:239], a[208:211], v[68:71]
ds_read_u16 v209, v214 offset:1928
ds_read_u16 v210, v212 offset:2568
ds_read_u16 v211, v214 offset:2568
ds_write_b64 v245, a[162:163] offset:32928
v_mfma_f32_16x16x32_bf16 v[64:67], v[232:235], a[208:211], v[64:67]
s_waitcnt lgkmcnt(15)
ds_write_b64 v245, a[164:165] offset:31056
v_perm_b32 v236, v203, v202, v240
v_perm_b32 v237, v203, v202, v241
v_perm_b32 v238, v203, v202, v242
v_perm_b32 v239, v203, v202, v243
v_mfma_f32_16x16x32_bf16 v[68:71], v[232:235], a[212:215], v[68:71]
ds_write_b64 v245, a[166:167] offset:32992
ds_write_b64 v245, a[168:169] offset:31152
ds_write_b64 v245, a[170:171] offset:33088
s_waitcnt lgkmcnt(14)
v_mfma_f32_16x16x32_bf16 v[72:75], v[236:239], a[216:219], 0
s_waitcnt lgkmcnt(12)
ds_read_u16 v192, v213 offset:0
ds_read_u16 v193, v215 offset:0
v_perm_b32 v232, v205, v204, v240
v_perm_b32 v233, v205, v204, v241
v_perm_b32 v234, v205, v204, v242
v_perm_b32 v235, v205, v204, v243
v_mfma_f32_16x16x32_bf16 v[76:79], v[236:239], a[220:223], 0
ds_read_b128 a[192:195], v244 offset:3872
ds_read_b128 a[196:199], v244 offset:4032
ds_read_b128 a[200:203], v244 offset:4192
s_cmp_eq_u32 s31, 1
s_cbranch_scc0 L_noresf4
ds_read_b128 a[32:35], v251 offset:0
ds_read_b128 a[36:39], v251 offset:16
ds_read_b128 a[40:43], v251 offset:1936
ds_read_b128 a[44:47], v251 offset:1952
ds_read_b128 a[48:51], v251 offset:15504
ds_read_b128 a[52:55], v251 offset:15520
ds_read_b128 a[56:59], v251 offset:17440
ds_read_b128 a[60:63], v251 offset:17456
L_noresf4:
v_mfma_f32_16x16x32_bf16 v[72:75], v[232:235], a[220:223], v[72:75]
s_waitcnt lgkmcnt(15)
s_waitcnt vmcnt(0)
v_cmp_ne_u32 vcc, 0x01010101, v217
s_nop 3
s_cmp_eq_u64 vcc, 0
s_cbranch_scc0 L_spinW
L_gotW:
s_cmp_eq_u32 s29, 0
s_cbranch_scc0 L_noinv
buffer_inv sc1
L_noinv:
ds_read_b128 a[204:207], v244 offset:4352
v_perm_b32 v236, v207, v206, v240
v_perm_b32 v237, v207, v206, v241
v_perm_b32 v238, v207, v206, v242
v_perm_b32 v239, v207, v206, v243
v_mfma_f32_16x16x32_bf16 v[76:79], v[232:235], a[224:227], v[76:79]
ds_read_b128 a[208:211], v244 offset:4512
ds_read_b128 a[212:215], v244 offset:4672
ds_read_u16 v194, v213 offset:640
v_mfma_f32_16x16x32_bf16 v[72:75], v[236:239], a[224:227], v[72:75]
s_waitcnt lgkmcnt(15)
ds_read_u16 v195, v215 offset:640
v_perm_b32 v232, v209, v208, v240
v_perm_b32 v233, v209, v208, v241
v_perm_b32 v234, v209, v208, v242
v_perm_b32 v235, v209, v208, v243
v_mfma_f32_16x16x32_bf16 v[76:79], v[236:239], a[228:231], v[76:79]
ds_read_u16 v196, v213 offset:1280
ds_read_u16 v197, v215 offset:1280
ds_write_b64 v245, a[172:173] offset:31216
v_mfma_f32_16x16x32_bf16 v[72:75], v[232:235], a[228:231], v[72:75]
s_waitcnt lgkmcnt(15)
ds_read_u16 v198, v213 offset:1920
v_perm_b32 v236, v211, v210, v240
v_perm_b32 v237, v211, v210, v241
v_perm_b32 v238, v211, v210, v242
v_perm_b32 v239, v211, v210, v243
v_mfma_f32_16x16x32_bf16 v[76:79], v[232:235], a[232:235], v[76:79]
ds_read_u16 v199, v215 offset:1920
ds_read_u16 v200, v213 offset:2560
ds_read_u16 v201, v215 offset:2560
ds_write_b64 v245, a[174:175] offset:33152
v_mfma_f32_16x16x32_bf16 v[72:75], v[236:239], a[232:235], v[72:75]
s_waitcnt lgkmcnt(15)
ds_write_b64 v245, a[176:177] offset:31312
v_perm_b32 v232, v193, v192, v240
v_perm_b32 v233, v193, v192, v241
v_perm_b32 v234, v193, v192, v242
v_perm_b32 v235, v193, v192, v243
v_mfma_f32_16x16x32_bf16 v[76:79], v[236:239], a[236:239], v[76:79]
ds_write_b64 v245, a[178:179] offset:33248
ds_write_b64 v245, a[180:181] offset:31376
s_waitcnt lgkmcnt(13)
v_mfma_f32_16x16x32_bf16 v[96:99], v[232:235], a[192:195], 0
s_waitcnt lgkmcnt(11)
ds_read_u16 v202, v213 offset:8
ds_read_u16 v203, v215 offset:8
v_perm_b32 v236, v195, v194, v240
v_perm_b32 v237, v195, v194, v241
v_perm_b32 v238, v195, v194, v242
v_perm_b32 v239, v195, v194, v243
v_mfma_f32_16x16x32_bf16 v[100:103], v[232:235], a[196:199], 0
ds_read_b128 a[216:219], v244 offset:5808
ds_read_b128 a[220:223], v244 offset:5968
ds_read_b128 a[224:227], v244 offset:6128
v_mfma_f32_16x16x32_bf16 v[96:99], v[236:239], a[196:199], v[96:99]
s_waitcnt lgkmcnt(14)
ds_read_b128 a[228:231], v244 offset:6288
v_perm_b32 v232, v197, v196, v240
v_perm_b32 v233, v197, v196, v241
v_perm_b32 v234, v197, v196, v242
v_perm_b32 v235, v197, v196, v243
v_mfma_f32_16x16x32_bf16 v[100:103], v[236:239], a[200:203], v[100:103]
ds_read_b128 a[232:235], v244 offset:6448
ds_read_b128 a[236:239], v244 offset:6608
ds_read_u16 v204, v213 offset:648
v_mfma_f32_16x16x32_bf16 v[96:99], v[232:235], a[200:203], v[96:99]
s_waitcnt lgkmcnt(15)
ds_read_u16 v205, v215 offset:648
v_perm_b32 v236, v199, v198, v240
v_perm_b32 v237, v199, v198, v241
v_perm_b32 v238, v199, v198, v242
v_perm_b32 v239, v199, v198, v243
v_mfma_f32_16x16x32_bf16 v[100:103], v[232:235], a[204:207], v[100:103]
ds_read_u16 v206, v213 offset:1288
ds_read_u16 v207, v215 offset:1288
ds_write_b64 v245, a[182:183] offset:33312
v_mfma_f32_16x16x32_bf16 v[96:99], v[236:239], a[204:207], v[96:99]
s_waitcnt lgkmcnt(15)
ds_read_u16 v208, v213 offset:1928
v_perm_b32 v232, v201, v200, v240
v_perm_b32 v233, v201, v200, v241
v_perm_b32 v234, v201, v200, v242
v_perm_b32 v235, v201, v200, v243
v_mfma_f32_16x16x32_bf16 v[100:103], v[236:239], a[208:211], v[100:103]
ds_read_u16 v209, v215 offset:1928
ds_read_u16 v210, v213 offset:2568
ds_read_u16 v211, v215 offset:2568
ds_write_b64 v246, a[184:185] offset:30992
v_mfma_f32_16x16x32_bf16 v[96:99], v[232:235], a[208:211], v[96:99]
s_waitcnt lgkmcnt(15)
ds_write_b64 v246, a[186:187] offset:32928
v_perm_b32 v236, v203, v202, v240
v_perm_b32 v237, v203, v202, v241
v_perm_b32 v238, v203, v202, v242
v_perm_b32 v239, v203, v202, v243
v_mfma_f32_16x16x32_bf16 v[100:103], v[232:235], a[212:215], v[100:103]
s_mov_b64 exec, 0xffffffff
ds_write_b64 v246, a[188:189] offset:31312
s_mov_b64 exec, -1
s_mov_b64 exec, 0xffffffff
ds_write_b64 v246, a[190:191] offset:33248
s_mov_b64 exec, -1
s_waitcnt lgkmcnt(0)
s_barrier
v_mfma_f32_16x16x32_bf16 v[104:107], v[236:239], a[216:219], 0
ds_read_u16 v192, v212 offset:4096
ds_read_u16 v193, v214 offset:4096
v_perm_b32 v232, v205, v204, v240
v_perm_b32 v233, v205, v204, v241
v_perm_b32 v234, v205, v204, v242
v_perm_b32 v235, v205, v204, v243
v_mfma_f32_16x16x32_bf16 v[108:111], v[236:239], a[220:223], 0
ds_read_b128 a[192:195], v244 offset:30992
ds_read_b128 a[196:199], v244 offset:31152
ds_read_b128 a[200:203], v244 offset:31312
v_mfma_f32_16x16x32_bf16 v[104:107], v[232:235], a[220:223], v[104:107]
ds_read_b128 a[204:207], v244 offset:31472
v_perm_b32 v236, v207, v206, v240
v_perm_b32 v237, v207, v206, v241
v_perm_b32 v238, v207, v206, v242
v_perm_b32 v239, v207, v206, v243
v_mfma_f32_16x16x32_bf16 v[108:111], v[232:235], a[224:227], v[108:111]
ds_read_b128 a[208:211], v244 offset:31632
ds_read_b128 a[212:215], v244 offset:31792
ds_read_u16 v194, v212 offset:4736
v_mfma_f32_16x16x32_bf16 v[104:107], v[236:239], a[224:227], v[104:107]
ds_read_u16 v195, v214 offset:4736
v_perm_b32 v232, v209, v208, v240
v_perm_b32 v233, v209, v208, v241
v_perm_b32 v234, v209, v208, v242
v_perm_b32 v235, v209, v208, v243
v_mfma_f32_16x16x32_bf16 v[108:111], v[236:239], a[228:231], v[108:111]
ds_read_u16 v196, v212 offset:5376
ds_read_u16 v197, v214 offset:5376
v_mfma_f32_16x16x32_bf16 v[104:107], v[232:235], a[228:231], v[104:107]
ds_read_u16 v198, v212 offset:6016
v_perm_b32 v236, v211, v210, v240
v_perm_b32 v237, v211, v210, v241
v_perm_b32 v238, v211, v210, v242
v_perm_b32 v239, v211, v210, v243
v_mfma_f32_16x16x32_bf16 v[108:111], v[232:235], a[232:235], v[108:111]
ds_read_u16 v199, v214 offset:6016
ds_read_u16 v200, v212 offset:6656
ds_read_u16 v201, v214 offset:6656
v_mfma_f32_16x16x32_bf16 v[104:107], v[236:239], a[232:235], v[104:107]
s_waitcnt lgkmcnt(14)
v_perm_b32 v232, v193, v192, v240
v_perm_b32 v233, v193, v192, v241
v_perm_b32 v234, v193, v192, v242
v_perm_b32 v235, v193, v192, v243
v_mfma_f32_16x16x32_bf16 v[108:111], v[236:239], a[236:239], v[108:111]
s_nop 0
s_waitcnt lgkmcnt(8)
v_mfma_f32_16x16x32_bf16 v[128:131], v[232:235], a[192:195], 0
s_waitcnt lgkmcnt(6)
ds_read_u16 v202, v212 offset:4104
ds_read_u16 v203, v214 offset:4104
v_perm_b32 v236, v195, v194, v240
v_perm_b32 v237, v195, v194, v241
v_perm_b32 v238, v195, v194, v242
v_perm_b32 v239, v195, v194, v243
v_mfma_f32_16x16x32_bf16 v[132:135], v[232:235], a[196:199], 0
ds_read_b128 a[216:219], v244 offset:32928
ds_read_b128 a[220:223], v244 offset:33088
ds_read_b128 a[224:227], v244 offset:33248
v_mfma_f32_16x16x32_bf16 v[128:131], v[236:239], a[196:199], v[128:131]
s_waitcnt lgkmcnt(9)
ds_read_b128 a[228:231], v244 offset:33408
v_perm_b32 v232, v197, v196, v240
v_perm_b32 v233, v197, v196, v241
v_perm_b32 v234, v197, v196, v242
v_perm_b32 v235, v197, v196, v243
v_mfma_f32_16x16x32_bf16 v[132:135], v[236:239], a[200:203], v[132:135]
ds_read_b128 a[232:235], v244 offset:33568
ds_read_b128 a[236:239], v244 offset:33728
ds_read_u16 v204, v212 offset:4744
v_mfma_f32_16x16x32_bf16 v[128:131], v[232:235], a[200:203], v[128:131]
s_waitcnt lgkmcnt(11)
ds_read_u16 v205, v214 offset:4744
v_perm_b32 v236, v199, v198, v240
v_perm_b32 v237, v199, v198, v241
v_perm_b32 v238, v199, v198, v242
v_perm_b32 v239, v199, v198, v243
v_mfma_f32_16x16x32_bf16 v[132:135], v[232:235], a[204:207], v[132:135]
ds_read_u16 v206, v212 offset:5384
ds_read_u16 v207, v214 offset:5384
v_mfma_f32_16x16x32_bf16 v[128:131], v[236:239], a[204:207], v[128:131]
s_waitcnt lgkmcnt(12)
ds_read_u16 v208, v212 offset:6024
v_perm_b32 v232, v201, v200, v240
v_perm_b32 v233, v201, v200, v241
v_perm_b32 v234, v201, v200, v242
v_perm_b32 v235, v201, v200, v243
v_mfma_f32_16x16x32_bf16 v[132:135], v[236:239], a[208:211], v[132:135]
ds_read_u16 v209, v214 offset:6024
ds_read_u16 v210, v212 offset:6664
ds_read_u16 v211, v214 offset:6664
v_mfma_f32_16x16x32_bf16 v[128:131], v[232:235], a[208:211], v[128:131]
s_waitcnt lgkmcnt(14)
v_perm_b32 v236, v203, v202, v240
v_perm_b32 v237, v203, v202, v241
v_perm_b32 v238, v203, v202, v242
v_perm_b32 v239, v203, v202, v243
v_mfma_f32_16x16x32_bf16 v[132:135], v[232:235], a[212:215], v[132:135]
s_nop 0
s_waitcnt lgkmcnt(8)
v_mfma_f32_16x16x32_bf16 v[136:139], v[236:239], a[216:219], 0
s_waitcnt lgkmcnt(6)
ds_read_u16 v192, v213 offset:4096
ds_read_u16 v193, v215 offset:4096
v_perm_b32 v232, v205, v204, v240
v_perm_b32 v233, v205, v204, v241
v_perm_b32 v234, v205, v204, v242
v_perm_b32 v235, v205, v204, v243
v_mfma_f32_16x16x32_bf16 v[140:143], v[236:239], a[220:223], 0
ds_read_b128 a[192:195], v244 offset:34864
ds_read_b128 a[196:199], v244 offset:35024
ds_read_b128 a[200:203], v244 offset:35184
s_cmp_eq_u32 s31, 1
s_cbranch_scc0 L_noresf5
ds_read_b128 a[64:67], v251 offset:30992
ds_read_b128 a[68:71], v251 offset:31008
ds_read_b128 a[72:75], v251 offset:32928
ds_read_b128 a[76:79], v251 offset:32944
ds_read_b128 a[80:83], v251 offset:46496
ds_read_b128 a[84:87], v251 offset:46512
ds_read_b128 a[88:91], v251 offset:48432
ds_read_b128 a[92:95], v251 offset:48448
L_noresf5:
v_mfma_f32_16x16x32_bf16 v[136:139], v[232:235], a[220:223], v[136:139]
s_waitcnt lgkmcnt(9)
ds_read_b128 a[204:207], v244 offset:35344
v_perm_b32 v236, v207, v206, v240
v_perm_b32 v237, v207, v206, v241
v_perm_b32 v238, v207, v206, v242
v_perm_b32 v239, v207, v206, v243
v_mfma_f32_16x16x32_bf16 v[140:143], v[232:235], a[224:227], v[140:143]
ds_read_b128 a[208:211], v244 offset:35504
ds_read_b128 a[212:215], v244 offset:35664
ds_read_u16 v194, v213 offset:4736
v_mfma_f32_16x16x32_bf16 v[136:139], v[236:239], a[224:227], v[136:139]
s_waitcnt lgkmcnt(11)
ds_read_u16 v195, v215 offset:4736
v_perm_b32 v232, v209, v208, v240
v_perm_b32 v233, v209, v208, v241
v_perm_b32 v234, v209, v208, v242
v_perm_b32 v235, v209, v208, v243
v_mfma_f32_16x16x32_bf16 v[140:143], v[236:239], a[228:231], v[140:143]
ds_read_u16 v196, v213 offset:5376
ds_read_u16 v197, v215 offset:5376
v_mfma_f32_16x16x32_bf16 v[136:139], v[232:235], a[228:231], v[136:139]
s_waitcnt lgkmcnt(12)
ds_read_u16 v198, v213 offset:6016
v_perm_b32 v236, v211, v210, v240
v_perm_b32 v237, v211, v210, v241
v_perm_b32 v238, v211, v210, v242
v_perm_b32 v239, v211, v210, v243
v_mfma_f32_16x16x32_bf16 v[140:143], v[232:235], a[232:235], v[140:143]
ds_read_u16 v199, v215 offset:6016
ds_read_u16 v200, v213 offset:6656
ds_read_u16 v201, v215 offset:6656
v_mfma_f32_16x16x32_bf16 v[136:139], v[236:239], a[232:235], v[136:139]
s_waitcnt lgkmcnt(14)
v_perm_b32 v232, v193, v192, v240
v_perm_b32 v233, v193, v192, v241
v_perm_b32 v234, v193, v192, v242
v_perm_b32 v235, v193, v192, v243
v_mfma_f32_16x16x32_bf16 v[140:143], v[236:239], a[236:239], v[140:143]
s_nop 0
s_waitcnt lgkmcnt(8)
v_mfma_f32_16x16x32_bf16 v[160:163], v[232:235], a[192:195], 0
s_waitcnt lgkmcnt(6)
ds_read_u16 v202, v213 offset:4104
ds_read_u16 v203, v215 offset:4104
v_perm_b32 v236, v195, v194, v240
v_perm_b32 v237, v195, v194, v241
v_perm_b32 v238, v195, v194, v242
v_perm_b32 v239, v195, v194, v243
v_mfma_f32_16x16x32_bf16 v[164:167], v[232:235], a[196:199], 0
ds_read_b128 a[216:219], v244 offset:36800
ds_read_b128 a[220:223], v244 offset:36960
ds_read_b128 a[224:227], v244 offset:37120
v_mfma_f32_16x16x32_bf16 v[160:163], v[236:239], a[196:199], v[160:163]
s_waitcnt lgkmcnt(9)
ds_read_b128 a[228:231], v244 offset:37280
v_perm_b32 v232, v197, v196, v240
v_perm_b32 v233, v197, v196, v241
v_perm_b32 v234, v197, v196, v242
v_perm_b32 v235, v197, v196, v243
v_mfma_f32_16x16x32_bf16 v[164:167], v[236:239], a[200:203], v[164:167]
ds_read_b128 a[232:235], v244 offset:37440
ds_read_b128 a[236:239], v244 offset:37600
ds_read_u16 v204, v213 offset:4744
v_mfma_f32_16x16x32_bf16 v[160:163], v[232:235], a[200:203], v[160:163]
s_waitcnt lgkmcnt(11)
ds_read_u16 v205, v215 offset:4744
v_perm_b32 v236, v199, v198, v240
v_perm_b32 v237, v199, v198, v241
v_perm_b32 v238, v199, v198, v242
v_perm_b32 v239, v199, v198, v243
v_mfma_f32_16x16x32_bf16 v[164:167], v[232:235], a[204:207], v[164:167]
ds_read_u16 v206, v213 offset:5384
ds_read_u16 v207, v215 offset:5384
v_mfma_f32_16x16x32_bf16 v[160:163], v[236:239], a[204:207], v[160:163]
s_waitcnt lgkmcnt(12)
ds_read_u16 v208, v213 offset:6024
v_perm_b32 v232, v201, v200, v240
v_perm_b32 v233, v201, v200, v241
v_perm_b32 v234, v201, v200, v242
v_perm_b32 v235, v201, v200, v243
v_mfma_f32_16x16x32_bf16 v[164:167], v[236:239], a[208:211], v[164:167]
ds_read_u16 v209, v215 offset:6024
ds_read_u16 v210, v213 offset:6664
ds_read_u16 v211, v215 offset:6664
v_mfma_f32_16x16x32_bf16 v[160:163], v[232:235], a[208:211], v[160:163]
s_waitcnt lgkmcnt(14)
v_perm_b32 v236, v203, v202, v240
v_perm_b32 v237, v203, v202, v241
v_perm_b32 v238, v203, v202, v242
v_perm_b32 v239, v203, v202, v243
v_mfma_f32_16x16x32_bf16 v[164:167], v[232:235], a[212:215], v[164:167]
s_nop 0
s_waitcnt lgkmcnt(0)
v_mfma_f32_16x16x32_bf16 v[168:171], v[236:239], a[216:219], 0
v_perm_b32 v232, v205, v204, v240
v_perm_b32 v233, v205, v204, v241
v_perm_b32 v234, v205, v204, v242
v_perm_b32 v235, v205, v204, v243
v_mfma_f32_16x16x32_bf16 v[172:175], v[236:239], a[220:223], 0
s_nop 0
v_mfma_f32_16x16x32_bf16 v[168:171], v[232:235], a[220:223], v[168:171]
v_perm_b32 v236, v207, v206, v240
v_perm_b32 v237, v207, v206, v241
v_perm_b32 v238, v207, v206, v242
v_perm_b32 v239, v207, v206, v243
v_mfma_f32_16x16x32_bf16 v[172:175], v[232:235], a[224:227], v[172:175]
s_nop 0
v_mfma_f32_16x16x32_bf16 v[168:171], v[236:239], a[224:227], v[168:171]
v_perm_b32 v232, v209, v208, v240
v_perm_b32 v233, v209, v208, v241
v_perm_b32 v234, v209, v208, v242
v_perm_b32 v235, v209, v208, v243
v_mfma_f32_16x16x32_bf16 v[172:175], v[236:239], a[228:231], v[172:175]
s_nop 0
v_mfma_f32_16x16x32_bf16 v[168:171], v[232:235], a[228:231], v[168:171]
v_perm_b32 v236, v211, v210, v240
v_perm_b32 v237, v211, v210, v241
v_perm_b32 v238, v211, v210, v242
v_perm_b32 v239, v211, v210, v243
v_mfma_f32_16x16x32_bf16 v[172:175], v[232:235], a[232:235], v[172:175]
s_nop 0
v_mfma_f32_16x16x32_bf16 v[168:171], v[236:239], a[232:235], v[168:171]
v_mfma_f32_16x16x32_bf16 v[172:175], v[236:239], a[236:239], v[172:175]
s_nop 0
s_waitcnt vmcnt(0)
s_barrier
L_mlp:
s_add_u32 s72, s37, s30
s_lshl_b32 s72, s72, 8
s_add_u32 s72, s72, s38
s_mul_i32 s34, s72, 768
s_mul_i32 s73, s31, 384
s_add_u32 s34, s34, s73
s_nop 3
v_mbcnt_lo_u32_b32 v212, -1, 0
v_mbcnt_hi_u32_b32 v212, -1, v212
v_lshlrev_b32 v213, 4, v212
v_add_u32 v252, s26, v213
s_lshl_b32 s72, s29, 12
s_add_u32 s72, s72, 147456
v_add_u32 v250, s72, v213
s_mov_b32 s24, 0
s_mov_b32 s25, 4096
s_add_u32 m0, s26, 0x0
s_nop 0
buffer_load_dwordx4 v252, s[8:11], s24 offen offset:0 lds
v_mov_b32 v192, v16
v_mov_b32 v193, v17
v_pk_mul_f32 v[200:201], v[16:17], v[16:17]
v_mov_b32 v194, v18
v_mov_b32 v195, v19
v_pk_mul_f32 v[202:203], v[18:19], v[18:19]
v_mov_b32 v196, v20
v_mov_b32 v197, v21
v_pk_mul_f32 v[204:205], v[20:21], v[20:21]
v_mov_b32 v198, v22
v_mov_b32 v199, v23
v_pk_mul_f32 v[206:207], v[22:23], v[22:23]
v_pk_add_f32 v[192:193], v[192:193], v[24:25]
v_pk_fma_f32 v[200:201], v[24:25], v[24:25], v[200:201]
v_pk_add_f32 v[194:195], v[194:195], v[26:27]
v_pk_fma_f32 v[202:203], v[26:27], v[26:27], v[202:203]
v_pk_add_f32 v[196:197], v[196:197], v[28:29]
v_pk_fma_f32 v[204:205], v[28:29], v[28:29], v[204:205]
v_pk_add_f32 v[198:199], v[198:199], v[30:31]
v_pk_fma_f32 v[206:207], v[30:31], v[30:31], v[206:207]
buffer_load_dwordx4 v252, s[8:11], s24 offen offset:1024 lds
v_pk_add_f32 v[192:193], v[192:193], v[48:49]
v_pk_fma_f32 v[200:201], v[48:49], v[48:49], v[200:201]
v_pk_add_f32 v[194:195], v[194:195], v[50:51]
v_pk_fma_f32 v[202:203], v[50:51], v[50:51], v[202:203]
v_pk_add_f32 v[196:197], v[196:197], v[52:53]
v_pk_fma_f32 v[204:205], v[52:53], v[52:53], v[204:205]
v_pk_add_f32 v[198:199], v[198:199], v[54:55]
v_pk_fma_f32 v[206:207], v[54:55], v[54:55], v[206:207]
v_pk_add_f32 v[192:193], v[192:193], v[56:57]
v_pk_fma_f32 v[200:201], v[56:57], v[56:57], v[200:201]
v_pk_add_f32 v[194:195], v[194:195], v[58:59]
v_pk_fma_f32 v[202:203], v[58:59], v[58:59], v[202:203]
v_pk_add_f32 v[196:197], v[196:197], v[60:61]
v_pk_fma_f32 v[204:205], v[60:61], v[60:61], v[204:205]
v_pk_add_f32 v[198:199], v[198:199], v[62:63]
v_pk_fma_f32 v[206:207], v[62:63], v[62:63], v[206:207]
buffer_load_dwordx4 v252, s[8:11], s24 offen offset:2048 lds
v_pk_add_f32 v[192:193], v[192:193], v[80:81]
v_pk_fma_f32 v[200:201], v[80:81], v[80:81], v[200:201]
v_pk_add_f32 v[194:195], v[194:195], v[82:83]
v_pk_fma_f32 v[202:203], v[82:83], v[82:83], v[202:203]
v_pk_add_f32 v[196:197], v[196:197], v[84:85]
v_pk_fma_f32 v[204:205], v[84:85], v[84:85], v[204:205]
v_pk_add_f32 v[198:199], v[198:199], v[86:87]
v_pk_fma_f32 v[206:207], v[86:87], v[86:87], v[206:207]
v_pk_add_f32 v[192:193], v[192:193], v[88:89]
v_pk_fma_f32 v[200:201], v[88:89], v[88:89], v[200:201]
v_pk_add_f32 v[194:195], v[194:195], v[90:91]
v_pk_fma_f32 v[202:203], v[90:91], v[90:91], v[202:203]
v_pk_add_f32 v[196:197], v[196:197], v[92:93]
v_pk_fma_f32 v[204:205], v[92:93], v[92:93], v[204:205]
v_pk_add_f32 v[198:199], v[198:199], v[94:95]
v_pk_fma_f32 v[206:207], v[94:95], v[94:95], v[206:207]
buffer_load_dwordx4 v252, s[8:11], s24 offen offset:3072 lds
v_pk_add_f32 v[192:193], v[192:193], v[112:113]
v_pk_fma_f32 v[200:201], v[112:113], v[112:113], v[200:201]
v_pk_add_f32 v[194:195], v[194:195], v[114:115]
v_pk_fma_f32 v[202:203], v[114:115], v[114:115], v[202:203]
v_pk_add_f32 v[196:197], v[196:197], v[116:117]
v_pk_fma_f32 v[204:205], v[116:117], v[116:117], v[204:205]
v_pk_add_f32 v[198:199], v[198:199], v[118:119]
v_pk_fma_f32 v[206:207], v[118:119], v[118:119], v[206:207]
v_pk_add_f32 v[192:193], v[192:193], v[120:121]
v_pk_fma_f32 v[200:201], v[120:121], v[120:121], v[200:201]
v_pk_add_f32 v[194:195], v[194:195], v[122:123]
v_pk_fma_f32 v[202:203], v[122:123], v[122:123], v[202:203]
v_pk_add_f32 v[196:197], v[196:197], v[124:125]
v_pk_fma_f32 v[204:205], v[124:125], v[124:125], v[204:205]
v_pk_add_f32 v[198:199], v[198:199], v[126:127]
v_pk_fma_f32 v[206:207], v[126:127], v[126:127], v[206:207]
s_add_u32 m0, s26, 0x1000
s_nop 0
buffer_load_dwordx4 v252, s[8:11], s25 offen offset:0 lds
v_pk_add_f32 v[192:193], v[192:193], v[144:145]
v_pk_fma_f32 v[200:201], v[144:145], v[144:145], v[200:201]
v_pk_add_f32 v[194:195], v[194:195], v[146:147]
v_pk_fma_f32 v[202:203], v[146:147], v[146:147], v[202:203]
v_pk_add_f32 v[196:197], v[196:197], v[148:149]
v_pk_fma_f32 v[204:205], v[148:149], v[148:149], v[204:205]
v_pk_add_f32 v[198:199], v[198:199], v[150:151]
v_pk_fma_f32 v[206:207], v[150:151], v[150:151], v[206:207]
v_pk_add_f32 v[192:193], v[192:193], v[152:153]
v_pk_fma_f32 v[200:201], v[152:153], v[152:153], v[200:201]
v_pk_add_f32 v[194:195], v[194:195], v[154:155]
v_pk_fma_f32 v[202:203], v[154:155], v[154:155], v[202:203]
v_pk_add_f32 v[196:197], v[196:197], v[156:157]
v_pk_fma_f32 v[204:205], v[156:157], v[156:157], v[204:205]
v_pk_add_f32 v[198:199], v[198:199], v[158:159]
v_pk_fma_f32 v[206:207], v[158:159], v[158:159], v[206:207]
buffer_load_dwordx4 v252, s[8:11], s25 offen offset:1024 lds
v_pk_add_f32 v[192:193], v[192:193], v[176:177]
v_pk_fma_f32 v[200:201], v[176:177], v[176:177], v[200:201]
v_pk_add_f32 v[194:195], v[194:195], v[178:179]
v_pk_fma_f32 v[202:203], v[178:179], v[178:179], v[202:203]
v_pk_add_f32 v[196:197], v[196:197], v[180:181]
v_pk_fma_f32 v[204:205], v[180:181], v[180:181], v[204:205]
v_pk_add_f32 v[198:199], v[198:199], v[182:183]
v_pk_fma_f32 v[206:207], v[182:183], v[182:183], v[206:207]
v_pk_add_f32 v[192:193], v[192:193], v[184:185]
v_pk_fma_f32 v[200:201], v[184:185], v[184:185], v[200:201]
v_pk_add_f32 v[194:195], v[194:195], v[186:187]
v_pk_fma_f32 v[202:203], v[186:187], v[186:187], v[202:203]
v_pk_add_f32 v[196:197], v[196:197], v[188:189]
v_pk_fma_f32 v[204:205], v[188:189], v[188:189], v[204:205]
v_pk_add_f32 v[198:199], v[198:199], v[190:191]
v_pk_fma_f32 v[206:207], v[190:191], v[190:191], v[206:207]
s_add_u32 s24, s24, 24576
s_add_u32 s25, s25, 24576
s_add_u32 m0, s26, 0x6000
s_nop 0
buffer_load_dwordx4 v252, s[8:11], s24 offen offset:0 lds
v_pk_add_f32 v[192:193], v[192:193], v[0:1]
v_pk_fma_f32 v[200:201], v[0:1], v[0:1], v[200:201]
v_pk_add_f32 v[194:195], v[194:195], v[2:3]
v_pk_fma_f32 v[202:203], v[2:3], v[2:3], v[202:203]
v_pk_add_f32 v[196:197], v[196:197], v[4:5]
v_pk_fma_f32 v[204:205], v[4:5], v[4:5], v[204:205]
v_pk_add_f32 v[198:199], v[198:199], v[6:7]
v_pk_fma_f32 v[206:207], v[6:7], v[6:7], v[206:207]
v_pk_add_f32 v[192:193], v[192:193], v[8:9]
v_pk_fma_f32 v[200:201], v[8:9], v[8:9], v[200:201]
v_pk_add_f32 v[194:195], v[194:195], v[10:11]
v_pk_fma_f32 v[202:203], v[10:11], v[10:11], v[202:203]
v_pk_add_f32 v[196:197], v[196:197], v[12:13]
v_pk_fma_f32 v[204:205], v[12:13], v[12:13], v[204:205]
v_pk_add_f32 v[198:199], v[198:199], v[14:15]
v_pk_fma_f32 v[206:207], v[14:15], v[14:15], v[206:207]
buffer_load_dwordx4 v252, s[8:11], s24 offen offset:1024 lds
v_pk_add_f32 v[192:193], v[192:193], v[32:33]
v_pk_fma_f32 v[200:201], v[32:33], v[32:33], v[200:201]
v_pk_add_f32 v[194:195], v[194:195], v[34:35]
v_pk_fma_f32 v[202:203], v[34:35], v[34:35], v[202:203]
v_pk_add_f32 v[196:197], v[196:197], v[36:37]
v_pk_fma_f32 v[204:205], v[36:37], v[36:37], v[204:205]
v_pk_add_f32 v[198:199], v[198:199], v[38:39]
v_pk_fma_f32 v[206:207], v[38:39], v[38:39], v[206:207]
v_pk_add_f32 v[192:193], v[192:193], v[40:41]
v_pk_fma_f32 v[200:201], v[40:41], v[40:41], v[200:201]
v_pk_add_f32 v[194:195], v[194:195], v[42:43]
v_pk_fma_f32 v[202:203], v[42:43], v[42:43], v[202:203]
v_pk_add_f32 v[196:197], v[196:197], v[44:45]
v_pk_fma_f32 v[204:205], v[44:45], v[44:45], v[204:205]
v_pk_add_f32 v[198:199], v[198:199], v[46:47]
v_pk_fma_f32 v[206:207], v[46:47], v[46:47], v[206:207]
buffer_load_dwordx4 v252, s[8:11], s24 offen offset:2048 lds
v_pk_add_f32 v[192:193], v[192:193], v[64:65]
v_pk_fma_f32 v[200:201], v[64:65], v[64:65], v[200:201]
v_pk_add_f32 v[194:195], v[194:195], v[66:67]
v_pk_fma_f32 v[202:203], v[66:67], v[66:67], v[202:203]
v_pk_add_f32 v[196:197], v[196:197], v[68:69]
v_pk_fma_f32 v[204:205], v[68:69], v[68:69], v[204:205]
v_pk_add_f32 v[198:199], v[198:199], v[70:71]
v_pk_fma_f32 v[206:207], v[70:71], v[70:71], v[206:207]
v_pk_add_f32 v[192:193], v[192:193], v[72:73]
v_pk_fma_f32 v[200:201], v[72:73], v[72:73], v[200:201]
v_pk_add_f32 v[194:195], v[194:195], v[74:75]
v_pk_fma_f32 v[202:203], v[74:75], v[74:75], v[202:203]
v_pk_add_f32 v[196:197], v[196:197], v[76:77]
v_pk_fma_f32 v[204:205], v[76:77], v[76:77], v[204:205]
v_pk_add_f32 v[198:199], v[198:199], v[78:79]
v_pk_fma_f32 v[206:207], v[78:79], v[78:79], v[206:207]
buffer_load_dwordx4 v252, s[8:11], s24 offen offset:3072 lds
v_pk_add_f32 v[192:193], v[192:193], v[96:97]
v_pk_fma_f32 v[200:201], v[96:97], v[96:97], v[200:201]
v_pk_add_f32 v[194:195], v[194:195], v[98:99]
v_pk_fma_f32 v[202:203], v[98:99], v[98:99], v[202:203]
v_pk_add_f32 v[196:197], v[196:197], v[100:101]
v_pk_fma_f32 v[204:205], v[100:101], v[100:101], v[204:205]
v_pk_add_f32 v[198:199], v[198:199], v[102:103]
v_pk_fma_f32 v[206:207], v[102:103], v[102:103], v[206:207]
v_pk_add_f32 v[192:193], v[192:193], v[104:105]
v_pk_fma_f32 v[200:201], v[104:105], v[104:105], v[200:201]
v_pk_add_f32 v[194:195], v[194:195], v[106:107]
v_pk_fma_f32 v[202:203], v[106:107], v[106:107], v[202:203]
v_pk_add_f32 v[196:197], v[196:197], v[108:109]
v_pk_fma_f32 v[204:205], v[108:109], v[108:109], v[204:205]
v_pk_add_f32 v[198:199], v[198:199], v[110:111]
v_pk_fma_f32 v[206:207], v[110:111], v[110:111], v[206:207]
s_add_u32 m0, s26, 0x7000
s_nop 0
buffer_load_dwordx4 v252, s[8:11], s25 offen offset:0 lds
v_pk_add_f32 v[192:193], v[192:193], v[128:129]
v_pk_fma_f32 v[200:201], v[128:129], v[128:129], v[200:201]
v_pk_add_f32 v[194:195], v[194:195], v[130:131]
v_pk_fma_f32 v[202:203], v[130:131], v[130:131], v[202:203]
v_pk_add_f32 v[196:197], v[196:197], v[132:133]
v_pk_fma_f32 v[204:205], v[132:133], v[132:133], v[204:205]
v_pk_add_f32 v[198:199], v[198:199], v[134:135]
v_pk_fma_f32 v[206:207], v[134:135], v[134:135], v[206:207]
v_pk_add_f32 v[192:193], v[192:193], v[136:137]
v_pk_fma_f32 v[200:201], v[136:137], v[136:137], v[200:201]
v_pk_add_f32 v[194:195], v[194:195], v[138:139]
v_pk_fma_f32 v[202:203], v[138:139], v[138:139], v[202:203]
v_pk_add_f32 v[196:197], v[196:197], v[140:141]
v_pk_fma_f32 v[204:205], v[140:141], v[140:141], v[204:205]
v_pk_add_f32 v[198:199], v[198:199], v[142:143]
v_pk_fma_f32 v[206:207], v[142:143], v[142:143], v[206:207]
buffer_load_dwordx4 v252, s[8:11], s25 offen offset:1024 lds
v_pk_add_f32 v[192:193], v[192:193], v[160:161]
v_pk_fma_f32 v[200:201], v[160:161], v[160:161], v[200:201]
v_pk_add_f32 v[194:195], v[194:195], v[162:163]
v_pk_fma_f32 v[202:203], v[162:163], v[162:163], v[202:203]
v_pk_add_f32 v[196:197], v[196:197], v[164:165]
v_pk_fma_f32 v[204:205], v[164:165], v[164:165], v[204:205]
v_pk_add_f32 v[198:199], v[198:199], v[166:167]
v_pk_fma_f32 v[206:207], v[166:167], v[166:167], v[206:207]
v_pk_add_f32 v[192:193], v[192:193], v[168:169]
v_pk_fma_f32 v[200:201], v[168:169], v[168:169], v[200:201]
v_pk_add_f32 v[194:195], v[194:195], v[170:171]
v_pk_fma_f32 v[202:203], v[170:171], v[170:171], v[202:203]
v_pk_add_f32 v[196:197], v[196:197], v[172:173]
v_pk_fma_f32 v[204:205], v[172:173], v[172:173], v[204:205]
v_pk_add_f32 v[198:199], v[198:199], v[174:175]
v_pk_fma_f32 v[206:207], v[174:175], v[174:175], v[206:207]
v_add_f32 v192, v192, v193
v_add_f32 v194, v194, v195
v_add_f32 v208, v192, v194
v_add_f32 v200, v200, v201
v_add_f32 v202, v202, v203
v_add_f32 v209, v200, v202
v_add_f32 v196, v196, v197
v_add_f32 v198, v198, v199
v_add_f32 v210, v196, v198
v_add_f32 v204, v204, v205
v_add_f32 v206, v206, v207
v_add_f32 v211, v204, v206
v_lshlrev_b32 v213, 3, v212
v_add_u32 v213, 147456, v213
s_lshl_b32 s72, s29, 10
v_add_u32 v214, s72, v213
ds_write_b64 v214, v[208:209] offset:0
ds_write_b64 v214, v[210:211] offset:512
v_lshrrev_b32 v215, 4, v212
v_lshlrev_b32 v215, 10, v215
v_and_b32 v216, 15, v212
v_lshl_add_u32 v215, v216, 4, v215
s_lshl_b32 s72, s30, 13
s_lshl_b32 s73, s31, 9
s_add_u32 s72, s72, s73
s_add_u32 s72, s72, 49152
v_add_u32 v215, s72, v215
v_add_u32 v218, 49152, v215
s_lshl_b32 s72, s30, 12
s_add_u32 s72, s72, 49152
v_lshlrev_b32 v216, 4, v212
v_add_u32 v216, s72, v216
v_add_u32 v217, 49152, v216
s_lshl_b32 s72, s30, 13
s_lshl_b32 s73, s29, 12
s_sub_u32 s72, s72, s73
v_add_u32 v251, s72, v250
s_waitcnt lgkmcnt(0)
s_barrier
ds_read_b64 v[192:193], v213 offset:0
ds_read_b64 v[194:195], v213 offset:1024
ds_read_b64 v[196:197], v213 offset:2048
ds_read_b64 v[198:199], v213 offset:3072
ds_read_b64 v[200:201], v213 offset:512
ds_read_b64 v[202:203], v213 offset:1536
ds_read_b64 v[204:205], v213 offset:2560
ds_read_b64 v[206:207], v213 offset:3584
s_waitcnt lgkmcnt(0)
v_pk_add_f32 v[192:193], v[192:193], v[194:195]
v_pk_add_f32 v[196:197], v[196:197], v[198:199]
v_pk_add_f32 v[200:201], v[200:201], v[202:203]
v_pk_add_f32 v[204:205], v[204:205], v[206:207]
v_pk_add_f32 v[192:193], v[192:193], v[196:197]
v_pk_add_f32 v[200:201], v[200:201], v[204:205]
v_mul_f32 v192, 0x3b2aaaab, v192
v_mul_f32 v200, 0x3b2aaaab, v200
v_mul_f32 v193, 0x3b2aaaab, v193
v_mul_f32 v201, 0x3b2aaaab, v201
v_fma_f32 v193, -v192, v192, v193
v_fma_f32 v201, -v200, v200, v201
v_max_f32 v193, 0, v193
v_max_f32 v201, 0, v201
v_add_f32 v193, 0x3727c5ac, v193
v_add_f32 v201, 0x3727c5ac, v201
v_rsq_f32 v193, v193
v_rsq_f32 v201, v201
v_mul_f32 v194, s35, v193
v_mul_f32 v202, s35, v201
v_mov_b32 v195, v194
v_mov_b32 v203, v202
v_mul_f32_e64 v196, -v192, v194
v_mul_f32_e64 v204, -v200, v202
v_mov_b32 v197, v196
v_mov_b32 v205, v204
v_pk_fma_f32 v[16:17], v[16:17], v[194:195], v[196:197]
v_pk_fma_f32 v[18:19], v[18:19], v[194:195], v[196:197]
v_pk_fma_f32 v[24:25], v[24:25], v[194:195], v[196:197]
v_pk_fma_f32 v[26:27], v[26:27], v[194:195], v[196:197]
v_cvt_pk_bf16_f32 v16, v16, v17
v_cvt_pk_bf16_f32 v17, v18, v19
v_cvt_pk_bf16_f32 v18, v24, v25
v_cvt_pk_bf16_f32 v19, v26, v27
ds_write_b128 v215, v[16:19] offset:0
v_pk_fma_f32 v[20:21], v[20:21], v[202:203], v[204:205]
v_pk_fma_f32 v[22:23], v[22:23], v[202:203], v[204:205]
v_pk_fma_f32 v[28:29], v[28:29], v[202:203], v[204:205]
v_pk_fma_f32 v[30:31], v[30:31], v[202:203], v[204:205]
v_cvt_pk_bf16_f32 v20, v20, v21
v_cvt_pk_bf16_f32 v21, v22, v23
v_cvt_pk_bf16_f32 v22, v28, v29
v_cvt_pk_bf16_f32 v23, v30, v31
ds_write_b128 v215, v[20:23] offset:4096
v_pk_fma_f32 v[48:49], v[48:49], v[194:195], v[196:197]
v_pk_fma_f32 v[50:51], v[50:51], v[194:195], v[196:197]
v_pk_fma_f32 v[56:57], v[56:57], v[194:195], v[196:197]
v_pk_fma_f32 v[58:59], v[58:59], v[194:195], v[196:197]
v_cvt_pk_bf16_f32 v48, v48, v49
v_cvt_pk_bf16_f32 v49, v50, v51
v_cvt_pk_bf16_f32 v50, v56, v57
v_cvt_pk_bf16_f32 v51, v58, v59
ds_write_b128 v215, v[48:51] offset:256
v_pk_fma_f32 v[52:53], v[52:53], v[202:203], v[204:205]
v_pk_fma_f32 v[54:55], v[54:55], v[202:203], v[204:205]
v_pk_fma_f32 v[60:61], v[60:61], v[202:203], v[204:205]
v_pk_fma_f32 v[62:63], v[62:63], v[202:203], v[204:205]
v_cvt_pk_bf16_f32 v52, v52, v53
v_cvt_pk_bf16_f32 v53, v54, v55
v_cvt_pk_bf16_f32 v54, v60, v61
v_cvt_pk_bf16_f32 v55, v62, v63
ds_write_b128 v215, v[52:55] offset:4352
v_pk_fma_f32 v[80:81], v[80:81], v[194:195], v[196:197]
v_pk_fma_f32 v[82:83], v[82:83], v[194:195], v[196:197]
v_pk_fma_f32 v[88:89], v[88:89], v[194:195], v[196:197]
v_pk_fma_f32 v[90:91], v[90:91], v[194:195], v[196:197]
v_cvt_pk_bf16_f32 v80, v80, v81
v_cvt_pk_bf16_f32 v81, v82, v83
v_cvt_pk_bf16_f32 v82, v88, v89
v_cvt_pk_bf16_f32 v83, v90, v91
ds_write_b128 v215, v[80:83] offset:16384
v_pk_fma_f32 v[84:85], v[84:85], v[202:203], v[204:205]
v_pk_fma_f32 v[86:87], v[86:87], v[202:203], v[204:205]
v_pk_fma_f32 v[92:93], v[92:93], v[202:203], v[204:205]
v_pk_fma_f32 v[94:95], v[94:95], v[202:203], v[204:205]
v_cvt_pk_bf16_f32 v84, v84, v85
v_cvt_pk_bf16_f32 v85, v86, v87
v_cvt_pk_bf16_f32 v86, v92, v93
v_cvt_pk_bf16_f32 v87, v94, v95
ds_write_b128 v215, v[84:87] offset:20480
v_pk_fma_f32 v[112:113], v[112:113], v[194:195], v[196:197]
v_pk_fma_f32 v[114:115], v[114:115], v[194:195], v[196:197]
v_pk_fma_f32 v[120:121], v[120:121], v[194:195], v[196:197]
v_pk_fma_f32 v[122:123], v[122:123], v[194:195], v[196:197]
v_cvt_pk_bf16_f32 v112, v112, v113
v_cvt_pk_bf16_f32 v113, v114, v115
v_cvt_pk_bf16_f32 v114, v120, v121
v_cvt_pk_bf16_f32 v115, v122, v123
ds_write_b128 v215, v[112:115] offset:16640
v_pk_fma_f32 v[116:117], v[116:117], v[202:203], v[204:205]
v_pk_fma_f32 v[118:119], v[118:119], v[202:203], v[204:205]
v_pk_fma_f32 v[124:125], v[124:125], v[202:203], v[204:205]
v_pk_fma_f32 v[126:127], v[126:127], v[202:203], v[204:205]
v_cvt_pk_bf16_f32 v116, v116, v117
v_cvt_pk_bf16_f32 v117, v118, v119
v_cvt_pk_bf16_f32 v118, v124, v125
v_cvt_pk_bf16_f32 v119, v126, v127
ds_write_b128 v215, v[116:119] offset:20736
v_pk_fma_f32 v[144:145], v[144:145], v[194:195], v[196:197]
v_pk_fma_f32 v[146:147], v[146:147], v[194:195], v[196:197]
v_pk_fma_f32 v[152:153], v[152:153], v[194:195], v[196:197]
v_pk_fma_f32 v[154:155], v[154:155], v[194:195], v[196:197]
v_cvt_pk_bf16_f32 v144, v144, v145
v_cvt_pk_bf16_f32 v145, v146, v147
v_cvt_pk_bf16_f32 v146, v152, v153
v_cvt_pk_bf16_f32 v147, v154, v155
ds_write_b128 v215, v[144:147] offset:32768
v_pk_fma_f32 v[148:149], v[148:149], v[202:203], v[204:205]
v_pk_fma_f32 v[150:151], v[150:151], v[202:203], v[204:205]
v_pk_fma_f32 v[156:157], v[156:157], v[202:203], v[204:205]
v_pk_fma_f32 v[158:159], v[158:159], v[202:203], v[204:205]
v_cvt_pk_bf16_f32 v148, v148, v149
v_cvt_pk_bf16_f32 v149, v150, v151
v_cvt_pk_bf16_f32 v150, v156, v157
v_cvt_pk_bf16_f32 v151, v158, v159
ds_write_b128 v215, v[148:151] offset:36864
v_pk_fma_f32 v[176:177], v[176:177], v[194:195], v[196:197]
v_pk_fma_f32 v[178:179], v[178:179], v[194:195], v[196:197]
v_pk_fma_f32 v[184:185], v[184:185], v[194:195], v[196:197]
v_pk_fma_f32 v[186:187], v[186:187], v[194:195], v[196:197]
v_cvt_pk_bf16_f32 v176, v176, v177
v_cvt_pk_bf16_f32 v177, v178, v179
v_cvt_pk_bf16_f32 v178, v184, v185
v_cvt_pk_bf16_f32 v179, v186, v187
ds_write_b128 v215, v[176:179] offset:33024
v_pk_fma_f32 v[180:181], v[180:181], v[202:203], v[204:205]
v_pk_fma_f32 v[182:183], v[182:183], v[202:203], v[204:205]
v_pk_fma_f32 v[188:189], v[188:189], v[202:203], v[204:205]
v_pk_fma_f32 v[190:191], v[190:191], v[202:203], v[204:205]
v_cvt_pk_bf16_f32 v180, v180, v181
v_cvt_pk_bf16_f32 v181, v182, v183
v_cvt_pk_bf16_f32 v182, v188, v189
v_cvt_pk_bf16_f32 v183, v190, v191
ds_write_b128 v215, v[180:183] offset:37120
v_pk_fma_f32 v[0:1], v[0:1], v[194:195], v[196:197]
v_pk_fma_f32 v[2:3], v[2:3], v[194:195], v[196:197]
v_pk_fma_f32 v[8:9], v[8:9], v[194:195], v[196:197]
v_pk_fma_f32 v[10:11], v[10:11], v[194:195], v[196:197]
v_cvt_pk_bf16_f32 v0, v0, v1
v_cvt_pk_bf16_f32 v1, v2, v3
v_cvt_pk_bf16_f32 v2, v8, v9
v_cvt_pk_bf16_f32 v3, v10, v11
ds_write_b128 v218, v[0:3] offset:0
v_pk_fma_f32 v[4:5], v[4:5], v[202:203], v[204:205]
v_pk_fma_f32 v[6:7], v[6:7], v[202:203], v[204:205]
v_pk_fma_f32 v[12:13], v[12:13], v[202:203], v[204:205]
v_pk_fma_f32 v[14:15], v[14:15], v[202:203], v[204:205]
v_cvt_pk_bf16_f32 v4, v4, v5
v_cvt_pk_bf16_f32 v5, v6, v7
v_cvt_pk_bf16_f32 v6, v12, v13
v_cvt_pk_bf16_f32 v7, v14, v15
ds_write_b128 v218, v[4:7] offset:4096
v_pk_fma_f32 v[32:33], v[32:33], v[194:195], v[196:197]
v_pk_fma_f32 v[34:35], v[34:35], v[194:195], v[196:197]
v_pk_fma_f32 v[40:41], v[40:41], v[194:195], v[196:197]
v_pk_fma_f32 v[42:43], v[42:43], v[194:195], v[196:197]
v_cvt_pk_bf16_f32 v32, v32, v33
v_cvt_pk_bf16_f32 v33, v34, v35
v_cvt_pk_bf16_f32 v34, v40, v41
v_cvt_pk_bf16_f32 v35, v42, v43
ds_write_b128 v218, v[32:35] offset:256
v_pk_fma_f32 v[36:37], v[36:37], v[202:203], v[204:205]
v_pk_fma_f32 v[38:39], v[38:39], v[202:203], v[204:205]
v_pk_fma_f32 v[44:45], v[44:45], v[202:203], v[204:205]
v_pk_fma_f32 v[46:47], v[46:47], v[202:203], v[204:205]
v_cvt_pk_bf16_f32 v36, v36, v37
v_cvt_pk_bf16_f32 v37, v38, v39
v_cvt_pk_bf16_f32 v38, v44, v45
v_cvt_pk_bf16_f32 v39, v46, v47
ds_write_b128 v218, v[36:39] offset:4352
v_pk_fma_f32 v[64:65], v[64:65], v[194:195], v[196:197]
v_pk_fma_f32 v[66:67], v[66:67], v[194:195], v[196:197]
v_pk_fma_f32 v[72:73], v[72:73], v[194:195], v[196:197]
v_pk_fma_f32 v[74:75], v[74:75], v[194:195], v[196:197]
v_cvt_pk_bf16_f32 v64, v64, v65
v_cvt_pk_bf16_f32 v65, v66, v67
v_cvt_pk_bf16_f32 v66, v72, v73
v_cvt_pk_bf16_f32 v67, v74, v75
ds_write_b128 v218, v[64:67] offset:16384
v_pk_fma_f32 v[68:69], v[68:69], v[202:203], v[204:205]
v_pk_fma_f32 v[70:71], v[70:71], v[202:203], v[204:205]
v_pk_fma_f32 v[76:77], v[76:77], v[202:203], v[204:205]
v_pk_fma_f32 v[78:79], v[78:79], v[202:203], v[204:205]
v_cvt_pk_bf16_f32 v68, v68, v69
v_cvt_pk_bf16_f32 v69, v70, v71
v_cvt_pk_bf16_f32 v70, v76, v77
v_cvt_pk_bf16_f32 v71, v78, v79
ds_write_b128 v218, v[68:71] offset:20480
v_pk_fma_f32 v[96:97], v[96:97], v[194:195], v[196:197]
v_pk_fma_f32 v[98:99], v[98:99], v[194:195], v[196:197]
v_pk_fma_f32 v[104:105], v[104:105], v[194:195], v[196:197]
v_pk_fma_f32 v[106:107], v[106:107], v[194:195], v[196:197]
v_cvt_pk_bf16_f32 v96, v96, v97
v_cvt_pk_bf16_f32 v97, v98, v99
v_cvt_pk_bf16_f32 v98, v104, v105
v_cvt_pk_bf16_f32 v99, v106, v107
ds_write_b128 v218, v[96:99] offset:16640
v_pk_fma_f32 v[100:101], v[100:101], v[202:203], v[204:205]
v_pk_fma_f32 v[102:103], v[102:103], v[202:203], v[204:205]
v_pk_fma_f32 v[108:109], v[108:109], v[202:203], v[204:205]
v_pk_fma_f32 v[110:111], v[110:111], v[202:203], v[204:205]
v_cvt_pk_bf16_f32 v100, v100, v101
v_cvt_pk_bf16_f32 v101, v102, v103
v_cvt_pk_bf16_f32 v102, v108, v109
v_cvt_pk_bf16_f32 v103, v110, v111
ds_write_b128 v218, v[100:103] offset:20736
v_pk_fma_f32 v[128:129], v[128:129], v[194:195], v[196:197]
v_pk_fma_f32 v[130:131], v[130:131], v[194:195], v[196:197]
v_pk_fma_f32 v[136:137], v[136:137], v[194:195], v[196:197]
v_pk_fma_f32 v[138:139], v[138:139], v[194:195], v[196:197]
v_cvt_pk_bf16_f32 v128, v128, v129
v_cvt_pk_bf16_f32 v129, v130, v131
v_cvt_pk_bf16_f32 v130, v136, v137
v_cvt_pk_bf16_f32 v131, v138, v139
ds_write_b128 v218, v[128:131] offset:32768
v_pk_fma_f32 v[132:133], v[132:133], v[202:203], v[204:205]
v_pk_fma_f32 v[134:135], v[134:135], v[202:203], v[204:205]
v_pk_fma_f32 v[140:141], v[140:141], v[202:203], v[204:205]
v_pk_fma_f32 v[142:143], v[142:143], v[202:203], v[204:205]
v_cvt_pk_bf16_f32 v132, v132, v133
v_cvt_pk_bf16_f32 v133, v134, v135
v_cvt_pk_bf16_f32 v134, v140, v141
v_cvt_pk_bf16_f32 v135, v142, v143
ds_write_b128 v218, v[132:135] offset:36864
v_pk_fma_f32 v[160:161], v[160:161], v[194:195], v[196:197]
v_pk_fma_f32 v[162:163], v[162:163], v[194:195], v[196:197]
v_pk_fma_f32 v[168:169], v[168:169], v[194:195], v[196:197]
v_pk_fma_f32 v[170:171], v[170:171], v[194:195], v[196:197]
v_cvt_pk_bf16_f32 v160, v160, v161
v_cvt_pk_bf16_f32 v161, v162, v163
v_cvt_pk_bf16_f32 v162, v168, v169
v_cvt_pk_bf16_f32 v163, v170, v171
ds_write_b128 v218, v[160:163] offset:33024
v_pk_fma_f32 v[164:165], v[164:165], v[202:203], v[204:205]
v_pk_fma_f32 v[166:167], v[166:167], v[202:203], v[204:205]
v_pk_fma_f32 v[172:173], v[172:173], v[202:203], v[204:205]
v_pk_fma_f32 v[174:175], v[174:175], v[202:203], v[204:205]
v_cvt_pk_bf16_f32 v164, v164, v165
v_cvt_pk_bf16_f32 v165, v166, v167
v_cvt_pk_bf16_f32 v166, v172, v173
v_cvt_pk_bf16_f32 v167, v174, v175
ds_write_b128 v218, v[164:167] offset:37120
s_nop 1
v_mfma_f32_16x16x32_bf16 v[0:3], a[248:251], a[0:3], 0
v_mfma_f32_16x16x32_bf16 v[4:7], a[252:255], a[0:3], 0
v_mfma_f32_16x16x32_bf16 v[8:11], a[248:251], a[4:7], 0
v_mfma_f32_16x16x32_bf16 v[12:15], a[252:255], a[4:7], 0
v_mfma_f32_16x16x32_bf16 v[16:19], a[248:251], a[8:11], 0
v_mfma_f32_16x16x32_bf16 v[20:23], a[252:255], a[8:11], 0
v_mfma_f32_16x16x32_bf16 v[24:27], a[248:251], a[12:15], 0
v_mfma_f32_16x16x32_bf16 v[28:31], a[252:255], a[12:15], 0
v_mfma_f32_16x16x32_bf16 v[32:35], a[248:251], a[16:19], 0
v_mfma_f32_16x16x32_bf16 v[36:39], a[252:255], a[16:19], 0
v_mfma_f32_16x16x32_bf16 v[40:43], a[248:251], a[20:23], 0
v_mfma_f32_16x16x32_bf16 v[44:47], a[252:255], a[20:23], 0
v_mfma_f32_16x16x32_bf16 v[48:51], a[248:251], a[24:27], 0
v_mfma_f32_16x16x32_bf16 v[52:55], a[252:255], a[24:27], 0
v_mfma_f32_16x16x32_bf16 v[56:59], a[248:251], a[28:31], 0
v_mfma_f32_16x16x32_bf16 v[60:63], a[252:255], a[28:31], 0
v_mfma_f32_16x16x32_bf16 v[64:67], a[248:251], a[32:35], 0
v_mfma_f32_16x16x32_bf16 v[68:71], a[252:255], a[32:35], 0
v_mfma_f32_16x16x32_bf16 v[72:75], a[248:251], a[36:39], 0
v_mfma_f32_16x16x32_bf16 v[76:79], a[252:255], a[36:39], 0
v_mfma_f32_16x16x32_bf16 v[80:83], a[248:251], a[40:43], 0
v_mfma_f32_16x16x32_bf16 v[84:87], a[252:255], a[40:43], 0
v_mfma_f32_16x16x32_bf16 v[88:91], a[248:251], a[44:47], 0
v_mfma_f32_16x16x32_bf16 v[92:95], a[252:255], a[44:47], 0
v_mfma_f32_16x16x32_bf16 v[96:99], a[248:251], a[48:51], 0
v_mfma_f32_16x16x32_bf16 v[100:103], a[252:255], a[48:51], 0
v_mfma_f32_16x16x32_bf16 v[104:107], a[248:251], a[52:55], 0
v_mfma_f32_16x16x32_bf16 v[108:111], a[252:255], a[52:55], 0
v_mfma_f32_16x16x32_bf16 v[112:115], a[248:251], a[56:59], 0
v_mfma_f32_16x16x32_bf16 v[116:119], a[252:255], a[56:59], 0
v_mfma_f32_16x16x32_bf16 v[120:123], a[248:251], a[60:63], 0
v_mfma_f32_16x16x32_bf16 v[124:127], a[252:255], a[60:63], 0
v_mfma_f32_16x16x32_bf16 v[128:131], a[248:251], a[64:67], 0
v_mfma_f32_16x16x32_bf16 v[132:135], a[252:255], a[64:67], 0
v_mfma_f32_16x16x32_bf16 v[136:139], a[248:251], a[68:71], 0
v_mfma_f32_16x16x32_bf16 v[140:143], a[252:255], a[68:71], 0
v_mfma_f32_16x16x32_bf16 v[144:147], a[248:251], a[72:75], 0
v_mfma_f32_16x16x32_bf16 v[148:151], a[252:255], a[72:75], 0
v_mfma_f32_16x16x32_bf16 v[152:155], a[248:251], a[76:79], 0
v_mfma_f32_16x16x32_bf16 v[156:159], a[252:255], a[76:79], 0
v_mfma_f32_16x16x32_bf16 v[160:163], a[248:251], a[80:83], 0
v_mfma_f32_16x16x32_bf16 v[164:167], a[252:255], a[80:83], 0
v_mfma_f32_16x16x32_bf16 v[168:171], a[248:251], a[84:87], 0
v_mfma_f32_16x16x32_bf16 v[172:175], a[252:255], a[84:87], 0
v_mfma_f32_16x16x32_bf16 v[176:179], a[248:251], a[88:91], 0
v_mfma_f32_16x16x32_bf16 v[180:183], a[252:255], a[88:91], 0
v_mfma_f32_16x16x32_bf16 v[184:187], a[248:251], a[92:95], 0
v_mfma_f32_16x16x32_bf16 v[188:191], a[252:255], a[92:95], 0
s_waitcnt vmcnt(0) lgkmcnt(0)
s_barrier
ds_read_b128 a[224:227], v248 offset:0
ds_read_b128 a[228:231], v248 offset:1024
ds_read_b128 a[0:3], v216 offset:0
ds_read_b128 a[4:7], v216 offset:1024
ds_read_b128 a[8:11], v216 offset:2048
ds_read_b128 a[12:15], v216 offset:3072
ds_read_b128 a[16:19], v216 offset:8192
ds_read_b128 a[20:23], v216 offset:9216
ds_read_b128 a[24:27], v216 offset:10240
ds_read_b128 a[28:31], v216 offset:11264
ds_read_b128 a[232:235], v248 offset:2048
ds_read_b128 a[236:239], v248 offset:3072
ds_read_b128 a[32:35], v216 offset:16384
ds_read_b128 a[36:39], v216 offset:17408
ds_read_b128 a[40:43], v216 offset:18432
ds_read_b128 a[44:47], v216 offset:19456
ds_read_b128 a[48:51], v216 offset:24576
ds_read_b128 a[52:55], v216 offset:25600
ds_read_b128 a[56:59], v216 offset:26624
ds_read_b128 a[60:63], v216 offset:27648
s_waitcnt lgkmcnt(10)
s_add_u32 s37, s37, 128
s_cmp_eq_u32 s32, 0
s_cselect_b32 s37, s37, 0x1000
s_mul_i32 s72, s29, 3
s_add_u32 s72, s72, s37
s_sub_u32 s72, s72, 2
s_mul_i32 s74, s38, 768
s_mul_i32 s73, s72, 196608
s_cmp_lt_u32 s72, 256
s_cselect_b32 s73, s73, 0x40000000
s_mov_b32 s66, s73
s_add_u32 s60, s73, s74
s_add_u32 s61, s60, 6144
s_add_u32 s72, s72, 1
s_mul_i32 s73, s72, 196608
s_cmp_lt_u32 s72, 256
s_cselect_b32 s73, s73, 0x40000000
s_add_u32 s62, s73, s74
s_add_u32 s63, s62, 6144
s_add_u32 s72, s72, 1
s_mul_i32 s73, s72, 196608
s_cmp_lt_u32 s72, 256
s_cselect_b32 s73, s73, 0x40000000
s_mov_b32 s67, s73
s_add_u32 s64, s73, s74
s_add_u32 s65, s64, 6144
v_mfma_f32_16x16x32_bf16 v[192:195], a[224:227], a[0:3], 0
ds_read_b128 a[240:243], v248 offset:4096
v_mfma_f32_16x16x32_bf16 v[192:195], a[228:231], a[16:19], v[192:195]
ds_read_b128 a[64:67], v216 offset:32768
ds_read_b128 a[68:71], v216 offset:33792
v_mfma_f32_16x16x32_bf16 v[196:199], a[224:227], a[4:7], 0
ds_read_b128 a[244:247], v248 offset:5120
v_mfma_f32_16x16x32_bf16 v[196:199], a[228:231], a[20:23], v[196:199]
ds_read_b128 a[72:75], v216 offset:34816
ds_read_b128 a[76:79], v216 offset:35840
v_mfma_f32_16x16x32_bf16 v[200:203], a[224:227], a[8:11], 0
ds_read_b128 a[80:83], v216 offset:40960
v_mfma_f32_16x16x32_bf16 v[200:203], a[228:231], a[24:27], v[200:203]
ds_read_b128 a[84:87], v216 offset:41984
ds_read_b128 a[88:91], v216 offset:43008
v_mfma_f32_16x16x32_bf16 v[204:207], a[224:227], a[12:15], 0
ds_read_b128 a[92:95], v216 offset:44032
v_mfma_f32_16x16x32_bf16 v[204:207], a[228:231], a[28:31], v[204:207]
s_waitcnt lgkmcnt(10)
v_mfma_f32_16x16x32_bf16 v[192:195], a[232:235], a[32:35], v[192:195]
ds_read_b128 a[224:227], v248 offset:6144
v_mfma_f32_16x16x32_bf16 v[192:195], a[236:239], a[48:51], v[192:195]
ds_read_b128 a[96:99], v217 offset:0
ds_read_b128 a[100:103], v217 offset:1024
v_mfma_f32_16x16x32_bf16 v[196:199], a[232:235], a[36:39], v[196:199]
ds_read_b128 a[228:231], v248 offset:7168
v_mfma_f32_16x16x32_bf16 v[196:199], a[236:239], a[52:55], v[196:199]
ds_read_b128 a[104:107], v217 offset:2048
ds_read_b128 a[108:111], v217 offset:3072
v_mfma_f32_16x16x32_bf16 v[200:203], a[232:235], a[40:43], v[200:203]
ds_read_b128 a[112:115], v217 offset:8192
v_mfma_f32_16x16x32_bf16 v[200:203], a[236:239], a[56:59], v[200:203]
ds_read_b128 a[116:119], v217 offset:9216
ds_read_b128 a[120:123], v217 offset:10240
v_mfma_f32_16x16x32_bf16 v[204:207], a[232:235], a[44:47], v[204:207]
ds_read_b128 a[124:127], v217 offset:11264
v_mfma_f32_16x16x32_bf16 v[204:207], a[236:239], a[60:63], v[204:207]
s_waitcnt lgkmcnt(10)
s_add_u32 s24, s24, 24576
s_barrier
v_mfma_f32_16x16x32_bf16 v[192:195], a[240:243], a[64:67], v[192:195]
s_add_u32 m0, s26, 0xc000
ds_read_b128 a[232:235], v248 offset:8192
v_mfma_f32_16x16x32_bf16 v[192:195], a[244:247], a[80:83], v[192:195]
ds_read_b128 a[128:131], v217 offset:16384
ds_read_b128 a[132:135], v217 offset:17408
buffer_load_dwordx4 v252, s[8:11], s24 offen offset:0 lds
v_mfma_f32_16x16x32_bf16 v[196:199], a[240:243], a[68:71], v[196:199]
ds_read_b128 a[236:239], v248 offset:9216
buffer_load_dwordx4 v252, s[8:11], s24 offen offset:1024 lds
v_mfma_f32_16x16x32_bf16 v[196:199], a[244:247], a[84:87], v[196:199]
ds_read_b128 a[136:139], v217 offset:18432
ds_read_b128 a[140:143], v217 offset:19456
buffer_load_dwordx4 v252, s[8:11], s24 offen offset:2048 lds
v_mfma_f32_16x16x32_bf16 v[200:203], a[240:243], a[72:75], v[200:203]
s_add_u32 s25, s25, 24576
ds_read_b128 a[144:147], v217 offset:24576
buffer_load_dwordx4 v252, s[8:11], s24 offen offset:3072 lds
v_mfma_f32_16x16x32_bf16 v[200:203], a[244:247], a[88:91], v[200:203]
s_add_u32 m0, s26, 0xd000
ds_read_b128 a[148:151], v217 offset:25600
ds_read_b128 a[152:155], v217 offset:26624
v_mfma_f32_16x16x32_bf16 v[204:207], a[240:243], a[76:79], v[204:207]
ds_read_b128 a[156:159], v217 offset:27648
buffer_load_dwordx4 v252, s[8:11], s25 offen offset:0 lds
v_mfma_f32_16x16x32_bf16 v[204:207], a[244:247], a[92:95], v[204:207]
s_waitcnt lgkmcnt(10)
v_mfma_f32_16x16x32_bf16 v[192:195], a[224:227], a[96:99], v[192:195]
ds_read_b128 a[240:243], v248 offset:10240
v_mfma_f32_16x16x32_bf16 v[192:195], a[228:231], a[112:115], v[192:195]
s_add_u32 s24, s24, 24576
ds_read_b128 a[160:163], v217 offset:32768
ds_read_b128 a[164:167], v217 offset:33792
buffer_load_dwordx4 v252, s[8:11], s25 offen offset:1024 lds
v_mfma_f32_16x16x32_bf16 v[196:199], a[224:227], a[100:103], v[196:199]
s_add_u32 m0, s26, 0x12000
ds_read_b128 a[244:247], v248 offset:11264
v_mfma_f32_16x16x32_bf16 v[196:199], a[228:231], a[116:119], v[196:199]
ds_read_b128 a[168:171], v217 offset:34816
ds_read_b128 a[172:175], v217 offset:35840
buffer_load_dwordx4 v252, s[8:11], s24 offen offset:0 lds
v_mfma_f32_16x16x32_bf16 v[200:203], a[224:227], a[104:107], v[200:203]
ds_read_b128 a[176:179], v217 offset:40960
buffer_load_dwordx4 v252, s[8:11], s24 offen offset:1024 lds
v_mfma_f32_16x16x32_bf16 v[200:203], a[228:231], a[120:123], v[200:203]
ds_read_b128 a[180:183], v217 offset:41984
ds_read_b128 a[184:187], v217 offset:43008
buffer_load_dwordx4 v252, s[8:11], s24 offen offset:2048 lds
v_mfma_f32_16x16x32_bf16 v[204:207], a[224:227], a[108:111], v[204:207]
ds_read_b128 a[188:191], v217 offset:44032
buffer_load_dwordx4 v252, s[8:11], s24 offen offset:3072 lds
v_mfma_f32_16x16x32_bf16 v[204:207], a[228:231], a[124:127], v[204:207]
s_waitcnt lgkmcnt(10)
s_add_u32 s25, s25, 24576
v_mfma_f32_16x16x32_bf16 v[192:195], a[232:235], a[128:131], v[192:195]
s_add_u32 m0, s26, 0x13000
ds_read_b128 a[224:227], v248 offset:24576
v_mfma_f32_16x16x32_bf16 v[192:195], a[236:239], a[144:147], v[192:195]
buffer_load_dwordx4 v252, s[8:11], s25 offen offset:0 lds
v_mfma_f32_16x16x32_bf16 v[196:199], a[232:235], a[132:135], v[196:199]
ds_read_b128 a[228:231], v248 offset:25600
v_mfma_f32_16x16x32_bf16 v[196:199], a[236:239], a[148:151], v[196:199]
buffer_load_dwordx4 v252, s[8:11], s25 offen offset:1024 lds
v_mfma_f32_16x16x32_bf16 v[200:203], a[232:235], a[136:139], v[200:203]
v_mfma_f32_16x16x32_bf16 v[200:203], a[236:239], a[152:155], v[200:203]
v_mfma_f32_16x16x32_bf16 v[204:207], a[232:235], a[140:143], v[204:207]
v_mfma_f32_16x16x32_bf16 v[204:207], a[236:239], a[156:159], v[204:207]
s_waitcnt lgkmcnt(2)
s_add_u32 s24, s24, 24576
s_barrier
v_mfma_f32_16x16x32_bf16 v[192:195], a[240:243], a[160:163], v[192:195]
s_add_u32 m0, s26, 0x18000
ds_read_b128 a[232:235], v248 offset:26624
v_mfma_f32_16x16x32_bf16 v[192:195], a[244:247], a[176:179], v[192:195]
buffer_load_dwordx4 v252, s[8:11], s24 offen offset:0 lds
v_mfma_f32_16x16x32_bf16 v[196:199], a[240:243], a[164:167], v[196:199]
ds_read_b128 a[236:239], v248 offset:27648
buffer_load_dwordx4 v252, s[8:11], s24 offen offset:1024 lds
v_mfma_f32_16x16x32_bf16 v[196:199], a[244:247], a[180:183], v[196:199]
buffer_load_dwordx4 v252, s[8:11], s24 offen offset:2048 lds
v_mfma_f32_16x16x32_bf16 v[200:203], a[240:243], a[168:171], v[200:203]
s_add_u32 s25, s25, 24576
buffer_load_dwordx4 v252, s[8:11], s24 offen offset:3072 lds
v_mfma_f32_16x16x32_bf16 v[200:203], a[244:247], a[184:187], v[200:203]
s_add_u32 m0, s26, 0x19000
v_mfma_f32_16x16x32_bf16 v[204:207], a[240:243], a[172:175], v[204:207]
buffer_load_dwordx4 v252, s[8:11], s25 offen offset:0 lds
v_mfma_f32_16x16x32_bf16 v[204:207], a[244:247], a[188:191], v[204:207]
s_waitcnt lgkmcnt(2)
buffer_load_dwordx4 v252, s[8:11], s25 offen offset:1024 lds
v_mfma_f32_16x16x32_bf16 v[208:211], a[224:227], a[0:3], 0
ds_read_b128 a[240:243], v248 offset:28672
v_mfma_f32_16x16x32_bf16 v[208:211], a[228:231], a[16:19], v[208:211]
s_add_u32 s24, s24, 24576
v_mfma_f32_16x16x32_bf16 v[212:215], a[224:227], a[4:7], 0
s_add_u32 s25, s25, 24576
ds_read_b128 a[244:247], v248 offset:29696
v_mfma_f32_16x16x32_bf16 v[212:215], a[228:231], a[20:23], v[212:215]
v_mfma_f32_16x16x32_bf16 v[216:219], a[224:227], a[8:11], 0
v_fma_f32 v240, v192, v192, s27
v_fma_f32 v241, v193, v193, s27
v_mfma_f32_16x16x32_bf16 v[216:219], a[228:231], a[24:27], v[216:219]
v_fma_f32 v242, v194, v194, s27
v_fma_f32 v243, v195, v195, s27
v_mfma_f32_16x16x32_bf16 v[220:223], a[224:227], a[12:15], 0
v_mul_f32_e64 v240, -v192, v240
v_mul_f32_e64 v241, -v193, v241
v_mfma_f32_16x16x32_bf16 v[220:223], a[228:231], a[28:31], v[220:223]
s_waitcnt lgkmcnt(2)
v_mul_f32_e64 v242, -v194, v242
v_mul_f32_e64 v243, -v195, v243
v_mfma_f32_16x16x32_bf16 v[208:211], a[232:235], a[32:35], v[208:211]
ds_read_b128 a[224:227], v248 offset:30720
v_fma_f32 v244, v196, v196, s27
v_mfma_f32_16x16x32_bf16 v[208:211], a[236:239], a[48:51], v[208:211]
v_exp_f32 v240, v240
v_mfma_f32_16x16x32_bf16 v[212:215], a[232:235], a[36:39], v[212:215]
ds_read_b128 a[228:231], v248 offset:31744
v_fma_f32 v240, v240, s35, s35
v_exp_f32 v241, v241
v_exp_f32 v242, v242
v_exp_f32 v243, v243
v_mfma_f32_16x16x32_bf16 v[212:215], a[236:239], a[52:55], v[212:215]
v_fma_f32 v241, v241, s35, s35
v_fma_f32 v242, v242, s35, s35
v_fma_f32 v243, v243, s35, s35
v_mfma_f32_16x16x32_bf16 v[216:219], a[232:235], a[40:43], v[216:219]
v_rcp_f32 v240, v240
v_rcp_f32 v241, v241
v_rcp_f32 v242, v242
v_rcp_f32 v243, v243
v_mfma_f32_16x16x32_bf16 v[216:219], a[236:239], a[56:59], v[216:219]
v_mul_f32 v240, v192, v240
v_mul_f32 v241, v193, v241
v_mul_f32 v242, v194, v242
v_mul_f32 v243, v195, v243
v_mfma_f32_16x16x32_bf16 v[220:223], a[232:235], a[44:47], v[220:223]
v_cvt_pk_bf16_f32 v224, v240, v241
v_cvt_pk_bf16_f32 v225, v242, v243
v_mfma_f32_16x16x32_bf16 v[220:223], a[236:239], a[60:63], v[220:223]
s_waitcnt vmcnt(6) lgkmcnt(2)
s_barrier
v_fma_f32 v245, v197, v197, s27
v_fma_f32 v246, v198, v198, s27
v_mfma_f32_16x16x32_bf16 v[208:211], a[240:243], a[64:67], v[208:211]
ds_read_b128 a[232:235], v248 offset:32768
v_fma_f32 v247, v199, v199, s27
v_mfma_f32_16x16x32_bf16 v[208:211], a[244:247], a[80:83], v[208:211]
v_mul_f32_e64 v244, -v196, v244
v_mul_f32_e64 v245, -v197, v245
v_mfma_f32_16x16x32_bf16 v[212:215], a[240:243], a[68:71], v[212:215]
s_add_u32 m0, s26, 0x1e000
ds_read_b128 a[236:239], v248 offset:33792
v_mul_f32_e64 v246, -v198, v246
v_mfma_f32_16x16x32_bf16 v[212:215], a[244:247], a[84:87], v[212:215]
buffer_load_dwordx4 v252, s[8:11], s24 offen offset:0 lds
v_mfma_f32_16x16x32_bf16 v[216:219], a[240:243], a[72:75], v[216:219]
v_mul_f32_e64 v247, -v199, v247
v_fma_f32 v240, v200, v200, s27
v_mfma_f32_16x16x32_bf16 v[216:219], a[244:247], a[88:91], v[216:219]
v_exp_f32 v244, v244
v_exp_f32 v245, v245
v_exp_f32 v246, v246
v_exp_f32 v247, v247
v_mfma_f32_16x16x32_bf16 v[220:223], a[240:243], a[76:79], v[220:223]
v_fma_f32 v244, v244, s35, s35
v_fma_f32 v245, v245, s35, s35
v_fma_f32 v246, v246, s35, s35
v_fma_f32 v247, v247, s35, s35
v_mfma_f32_16x16x32_bf16 v[220:223], a[244:247], a[92:95], v[220:223]
s_waitcnt lgkmcnt(2)
v_rcp_f32 v244, v244
v_rcp_f32 v245, v245
v_rcp_f32 v246, v246
v_rcp_f32 v247, v247
v_mfma_f32_16x16x32_bf16 v[208:211], a[224:227], a[96:99], v[208:211]
ds_read_b128 a[240:243], v248 offset:34816
v_mul_f32 v244, v196, v244
v_mul_f32 v245, v197, v245
v_mul_f32 v246, v198, v246
v_mul_f32 v247, v199, v247
v_mfma_f32_16x16x32_bf16 v[208:211], a[228:231], a[112:115], v[208:211]
buffer_load_dwordx4 v252, s[8:11], s24 offen offset:1024 lds
v_mfma_f32_16x16x32_bf16 v[212:215], a[224:227], a[100:103], v[212:215]
ds_read_b128 a[244:247], v248 offset:35840
v_cvt_pk_bf16_f32 v228, v244, v245
v_mfma_f32_16x16x32_bf16 v[212:215], a[228:231], a[116:119], v[212:215]
v_cvt_pk_bf16_f32 v229, v246, v247
v_fma_f32 v241, v201, v201, s27
v_mfma_f32_16x16x32_bf16 v[216:219], a[224:227], a[104:107], v[216:219]
v_fma_f32 v242, v202, v202, s27
v_fma_f32 v243, v203, v203, s27
v_mfma_f32_16x16x32_bf16 v[216:219], a[228:231], a[120:123], v[216:219]
v_mul_f32_e64 v240, -v200, v240
v_mul_f32_e64 v241, -v201, v241
v_mfma_f32_16x16x32_bf16 v[220:223], a[224:227], a[108:111], v[220:223]
buffer_load_dwordx4 v252, s[8:11], s24 offen offset:2048 lds
v_mfma_f32_16x16x32_bf16 v[220:223], a[228:231], a[124:127], v[220:223]
s_waitcnt lgkmcnt(2)
v_mul_f32_e64 v242, -v202, v242
v_mul_f32_e64 v243, -v203, v243
v_mfma_f32_16x16x32_bf16 v[208:211], a[232:235], a[128:131], v[208:211]
ds_read_b128 a[224:227], v248 offset:49152
v_fma_f32 v244, v204, v204, s27
v_exp_f32 v240, v240
v_exp_f32 v241, v241
v_exp_f32 v242, v242
v_exp_f32 v243, v243
v_mfma_f32_16x16x32_bf16 v[208:211], a[236:239], a[144:147], v[208:211]
v_fma_f32 v240, v240, s35, s35
v_fma_f32 v241, v241, s35, s35
v_fma_f32 v242, v242, s35, s35
v_fma_f32 v243, v243, s35, s35
v_mfma_f32_16x16x32_bf16 v[212:215], a[232:235], a[132:135], v[212:215]
ds_read_b128 a[228:231], v248 offset:50176
v_fma_f32 v245, v205, v205, s27
v_rcp_f32 v240, v240
v_rcp_f32 v241, v241
v_rcp_f32 v242, v242
v_rcp_f32 v243, v243
v_mfma_f32_16x16x32_bf16 v[212:215], a[236:239], a[148:151], v[212:215]
buffer_load_dwordx4 v252, s[8:11], s24 offen offset:3072 lds
v_mul_f32 v240, v200, v240
v_mul_f32 v241, v201, v241
v_mul_f32 v242, v202, v242
v_mul_f32 v243, v203, v243
v_mfma_f32_16x16x32_bf16 v[216:219], a[232:235], a[136:139], v[216:219]
v_cvt_pk_bf16_f32 v232, v240, v241
v_cvt_pk_bf16_f32 v233, v242, v243
v_mfma_f32_16x16x32_bf16 v[216:219], a[236:239], a[152:155], v[216:219]
v_fma_f32 v246, v206, v206, s27
v_fma_f32 v247, v207, v207, s27
v_mfma_f32_16x16x32_bf16 v[220:223], a[232:235], a[140:143], v[220:223]
v_mul_f32_e64 v244, -v204, v244
v_mul_f32_e64 v245, -v205, v245
v_mfma_f32_16x16x32_bf16 v[220:223], a[236:239], a[156:159], v[220:223]
s_waitcnt lgkmcnt(2)
v_mul_f32_e64 v246, -v206, v246
v_mul_f32_e64 v247, -v207, v247
v_mfma_f32_16x16x32_bf16 v[208:211], a[240:243], a[160:163], v[208:211]
s_add_u32 m0, s26, 0x1f000
ds_read_b128 a[232:235], v248 offset:51200
v_mfma_f32_16x16x32_bf16 v[208:211], a[244:247], a[176:179], v[208:211]
buffer_load_dwordx4 v252, s[8:11], s25 offen offset:0 lds
v_mfma_f32_16x16x32_bf16 v[212:215], a[240:243], a[164:167], v[212:215]
ds_read_b128 a[236:239], v248 offset:52224
v_mfma_f32_16x16x32_bf16 v[212:215], a[244:247], a[180:183], v[212:215]
v_exp_f32 v244, v244
v_exp_f32 v245, v245
v_exp_f32 v246, v246
v_exp_f32 v247, v247
v_mfma_f32_16x16x32_bf16 v[216:219], a[240:243], a[168:171], v[216:219]
v_fma_f32 v244, v244, s35, s35
v_fma_f32 v245, v245, s35, s35
v_fma_f32 v246, v246, s35, s35
v_fma_f32 v247, v247, s35, s35
v_mfma_f32_16x16x32_bf16 v[216:219], a[244:247], a[184:187], v[216:219]
v_rcp_f32 v244, v244
v_rcp_f32 v245, v245
v_rcp_f32 v246, v246
v_rcp_f32 v247, v247
v_mfma_f32_16x16x32_bf16 v[220:223], a[240:243], a[172:175], v[220:223]
buffer_load_dwordx4 v252, s[8:11], s25 offen offset:1024 lds
v_mul_f32 v244, v204, v244
v_mul_f32 v245, v205, v245
v_mul_f32 v246, v206, v246
v_mul_f32 v247, v207, v247
v_mfma_f32_16x16x32_bf16 v[220:223], a[244:247], a[188:191], v[220:223]
s_waitcnt lgkmcnt(2)
v_cvt_pk_bf16_f32 v236, v244, v245
v_cvt_pk_bf16_f32 v237, v246, v247
v_mfma_f32_16x16x32_bf16 v[192:195], a[224:227], a[0:3], 0
ds_read_b128 a[240:243], v248 offset:53248
v_mfma_f32_16x16x32_bf16 v[192:195], a[228:231], a[16:19], v[192:195]
s_add_u32 s24, s24, 24576
v_mfma_f32_16x16x32_bf16 v[196:199], a[224:227], a[4:7], 0
s_add_u32 s25, s25, 24576
ds_read_b128 a[244:247], v248 offset:54272
v_fma_f32 v240, v208, v208, s27
v_mfma_f32_16x16x32_bf16 v[196:199], a[228:231], a[20:23], v[196:199]
v_fma_f32 v241, v209, v209, s27
v_fma_f32 v242, v210, v210, s27
v_mfma_f32_16x16x32_bf16 v[200:203], a[224:227], a[8:11], 0
s_add_u32 m0, s26, 0x0
v_fma_f32 v243, v211, v211, s27
v_mul_f32_e64 v240, -v208, v240
v_mfma_f32_16x16x32_bf16 v[200:203], a[228:231], a[24:27], v[200:203]
buffer_load_dwordx4 v252, s[8:11], s24 offen offset:0 lds
v_mfma_f32_16x16x32_bf16 v[204:207], a[224:227], a[12:15], 0
v_mul_f32_e64 v241, -v209, v241
v_mul_f32_e64 v242, -v210, v242
v_mfma_f32_16x16x32_bf16 v[204:207], a[228:231], a[28:31], v[204:207]
s_waitcnt lgkmcnt(2)
v_mul_f32_e64 v243, -v211, v243
v_fma_f32 v244, v212, v212, s27
v_mfma_f32_16x16x32_bf16 v[192:195], a[232:235], a[32:35], v[192:195]
ds_read_b128 a[224:227], v248 offset:55296
v_fma_f32 v245, v213, v213, s27
v_mfma_f32_16x16x32_bf16 v[192:195], a[236:239], a[48:51], v[192:195]
v_exp_f32 v240, v240
v_exp_f32 v241, v241
v_exp_f32 v242, v242
v_exp_f32 v243, v243
v_mfma_f32_16x16x32_bf16 v[196:199], a[232:235], a[36:39], v[196:199]
ds_read_b128 a[228:231], v248 offset:56320
v_fma_f32 v240, v240, s35, s35
v_fma_f32 v241, v241, s35, s35
v_fma_f32 v242, v242, s35, s35
v_fma_f32 v243, v243, s35, s35
v_mfma_f32_16x16x32_bf16 v[196:199], a[236:239], a[52:55], v[196:199]
v_rcp_f32 v240, v240
v_rcp_f32 v241, v241
v_rcp_f32 v242, v242
v_rcp_f32 v243, v243
v_mfma_f32_16x16x32_bf16 v[200:203], a[232:235], a[40:43], v[200:203]
v_mul_f32 v240, v208, v240
v_mul_f32 v241, v209, v241
v_mul_f32 v242, v210, v242
v_mul_f32 v243, v211, v243
v_mfma_f32_16x16x32_bf16 v[200:203], a[236:239], a[56:59], v[200:203]
buffer_load_dwordx4 v252, s[8:11], s24 offen offset:1024 lds
v_mfma_f32_16x16x32_bf16 v[204:207], a[232:235], a[44:47], v[204:207]
v_cvt_pk_bf16_f32 v226, v240, v241
v_cvt_pk_bf16_f32 v227, v242, v243
v_mfma_f32_16x16x32_bf16 v[204:207], a[236:239], a[60:63], v[204:207]
s_waitcnt lgkmcnt(2)
ds_write_b128 v250, v[224:227] offset:0
v_mfma_f32_16x16x32_bf16 v[192:195], a[240:243], a[64:67], v[192:195]
ds_read_b128 a[232:235], v248 offset:57344
v_fma_f32 v246, v214, v214, s27
v_mfma_f32_16x16x32_bf16 v[192:195], a[244:247], a[80:83], v[192:195]
v_fma_f32 v247, v215, v215, s27
v_mul_f32_e64 v244, -v212, v244
v_mfma_f32_16x16x32_bf16 v[196:199], a[240:243], a[68:71], v[196:199]
ds_read_b128 a[236:239], v248 offset:58368
v_mul_f32_e64 v245, -v213, v245
v_mfma_f32_16x16x32_bf16 v[196:199], a[244:247], a[84:87], v[196:199]
v_mul_f32_e64 v246, -v214, v246
v_mul_f32_e64 v247, -v215, v247
v_mfma_f32_16x16x32_bf16 v[200:203], a[240:243], a[72:75], v[200:203]
v_exp_f32 v244, v244
v_mfma_f32_16x16x32_bf16 v[200:203], a[244:247], a[88:91], v[200:203]
buffer_load_dwordx4 v252, s[8:11], s24 offen offset:2048 lds
v_exp_f32 v245, v245
v_exp_f32 v246, v246
v_exp_f32 v247, v247
v_mfma_f32_16x16x32_bf16 v[204:207], a[240:243], a[76:79], v[204:207]
v_fma_f32 v244, v244, s35, s35
v_fma_f32 v245, v245, s35, s35
v_fma_f32 v246, v246, s35, s35
v_fma_f32 v247, v247, s35, s35
v_mfma_f32_16x16x32_bf16 v[204:207], a[244:247], a[92:95], v[204:207]
s_waitcnt lgkmcnt(3)
v_rcp_f32 v244, v244
v_rcp_f32 v245, v245
v_rcp_f32 v246, v246
v_rcp_f32 v247, v247
v_mfma_f32_16x16x32_bf16 v[192:195], a[224:227], a[96:99], v[192:195]
ds_read_b128 a[240:243], v248 offset:59392
v_mul_f32 v244, v212, v244
v_mul_f32 v245, v213, v245
v_mul_f32 v246, v214, v246
v_mul_f32 v247, v215, v247
v_mfma_f32_16x16x32_bf16 v[192:195], a[228:231], a[112:115], v[192:195]
v_cvt_pk_bf16_f32 v230, v244, v245
v_cvt_pk_bf16_f32 v231, v246, v247
v_mfma_f32_16x16x32_bf16 v[196:199], a[224:227], a[100:103], v[196:199]
ds_read_b128 a[244:247], v248 offset:60416
v_fma_f32 v240, v216, v216, s27
v_mfma_f32_16x16x32_bf16 v[196:199], a[228:231], a[116:119], v[196:199]
ds_write_b128 v250, v[228:231] offset:1024
v_mfma_f32_16x16x32_bf16 v[200:203], a[224:227], a[104:107], v[200:203]
v_fma_f32 v241, v217, v217, s27
v_fma_f32 v242, v218, v218, s27
v_mfma_f32_16x16x32_bf16 v[200:203], a[228:231], a[120:123], v[200:203]
buffer_load_dwordx4 v252, s[8:11], s24 offen offset:3072 lds
v_mfma_f32_16x16x32_bf16 v[204:207], a[224:227], a[108:111], v[204:207]
v_fma_f32 v243, v219, v219, s27
v_mul_f32_e64 v240, -v216, v240
v_mfma_f32_16x16x32_bf16 v[204:207], a[228:231], a[124:127], v[204:207]
s_waitcnt lgkmcnt(3)
v_mul_f32_e64 v241, -v217, v241
v_mul_f32_e64 v242, -v218, v242
v_mfma_f32_16x16x32_bf16 v[192:195], a[232:235], a[128:131], v[192:195]
ds_read_b128 a[224:227], v249 offset:0
v_mul_f32_e64 v243, -v219, v243
v_mfma_f32_16x16x32_bf16 v[192:195], a[236:239], a[144:147], v[192:195]
v_exp_f32 v240, v240
v_exp_f32 v241, v241
v_exp_f32 v242, v242
v_exp_f32 v243, v243
v_mfma_f32_16x16x32_bf16 v[196:199], a[232:235], a[132:135], v[196:199]
ds_read_b128 a[228:231], v249 offset:1024
v_fma_f32 v240, v240, s35, s35
v_fma_f32 v241, v241, s35, s35
v_fma_f32 v242, v242, s35, s35
v_fma_f32 v243, v243, s35, s35
v_mfma_f32_16x16x32_bf16 v[196:199], a[236:239], a[148:151], v[196:199]
v_rcp_f32 v240, v240
v_rcp_f32 v241, v241
v_rcp_f32 v242, v242
v_rcp_f32 v243, v243
v_mfma_f32_16x16x32_bf16 v[200:203], a[232:235], a[136:139], v[200:203]
s_add_u32 m0, s26, 0x1000
v_mul_f32 v240, v216, v240
v_mul_f32 v241, v217, v241
v_mul_f32 v242, v218, v242
v_mul_f32 v243, v219, v243
v_mfma_f32_16x16x32_bf16 v[200:203], a[236:239], a[152:155], v[200:203]
buffer_load_dwordx4 v252, s[8:11], s25 offen offset:0 lds
v_mfma_f32_16x16x32_bf16 v[204:207], a[232:235], a[140:143], v[204:207]
v_cvt_pk_bf16_f32 v234, v240, v241
v_cvt_pk_bf16_f32 v235, v242, v243
v_mfma_f32_16x16x32_bf16 v[204:207], a[236:239], a[156:159], v[204:207]
s_waitcnt lgkmcnt(3)
ds_write_b128 v250, v[232:235] offset:2048
v_mfma_f32_16x16x32_bf16 v[192:195], a[240:243], a[160:163], v[192:195]
ds_read_b128 a[232:235], v249 offset:2048
v_fma_f32 v244, v220, v220, s27
v_mfma_f32_16x16x32_bf16 v[192:195], a[244:247], a[176:179], v[192:195]
v_fma_f32 v245, v221, v221, s27
v_fma_f32 v246, v222, v222, s27
v_mfma_f32_16x16x32_bf16 v[196:199], a[240:243], a[164:167], v[196:199]
ds_read_b128 a[236:239], v249 offset:3072
v_fma_f32 v247, v223, v223, s27
v_mfma_f32_16x16x32_bf16 v[196:199], a[244:247], a[180:183], v[196:199]
v_mul_f32_e64 v244, -v220, v244
v_mul_f32_e64 v245, -v221, v245
v_mfma_f32_16x16x32_bf16 v[200:203], a[240:243], a[168:171], v[200:203]
v_mul_f32_e64 v246, -v222, v246
v_mul_f32_e64 v247, -v223, v247
v_mfma_f32_16x16x32_bf16 v[200:203], a[244:247], a[184:187], v[200:203]
buffer_load_dwordx4 v252, s[8:11], s25 offen offset:1024 lds
v_exp_f32 v244, v244
v_exp_f32 v245, v245
v_exp_f32 v246, v246
v_exp_f32 v247, v247
v_mfma_f32_16x16x32_bf16 v[204:207], a[240:243], a[172:175], v[204:207]
v_fma_f32 v244, v244, s35, s35
v_fma_f32 v245, v245, s35, s35
v_fma_f32 v246, v246, s35, s35
v_fma_f32 v247, v247, s35, s35
v_mfma_f32_16x16x32_bf16 v[204:207], a[244:247], a[188:191], v[204:207]
s_waitcnt lgkmcnt(3)
v_rcp_f32 v244, v244
v_rcp_f32 v245, v245
v_rcp_f32 v246, v246
v_rcp_f32 v247, v247
v_mfma_f32_16x16x32_bf16 v[208:211], a[224:227], a[0:3], 0
ds_read_b128 a[240:243], v249 offset:4096
v_mul_f32 v244, v220, v244
v_mul_f32 v245, v221, v245
v_mul_f32 v246, v222, v246
v_mul_f32 v247, v223, v247
v_mfma_f32_16x16x32_bf16 v[208:211], a[228:231], a[16:19], v[208:211]
s_add_u32 s24, s24, 24576
v_cvt_pk_bf16_f32 v238, v244, v245
v_cvt_pk_bf16_f32 v239, v246, v247
v_mfma_f32_16x16x32_bf16 v[212:215], a[224:227], a[4:7], 0
s_add_u32 s25, s25, 24576
ds_read_b128 a[244:247], v249 offset:5120
v_mfma_f32_16x16x32_bf16 v[212:215], a[228:231], a[20:23], v[212:215]
ds_write_b128 v250, v[236:239] offset:3072
v_mfma_f32_16x16x32_bf16 v[216:219], a[224:227], a[8:11], 0
v_mfma_f32_16x16x32_bf16 v[216:219], a[228:231], a[24:27], v[216:219]
v_fma_f32 v240, v192, v192, s27
v_fma_f32 v241, v193, v193, s27
v_mfma_f32_16x16x32_bf16 v[220:223], a[224:227], a[12:15], 0
v_fma_f32 v242, v194, v194, s27
v_fma_f32 v243, v195, v195, s27
v_mfma_f32_16x16x32_bf16 v[220:223], a[228:231], a[28:31], v[220:223]
s_waitcnt lgkmcnt(3)
v_mul_f32_e64 v240, -v192, v240
v_mul_f32_e64 v241, -v193, v241
v_mfma_f32_16x16x32_bf16 v[208:211], a[232:235], a[32:35], v[208:211]
ds_read_b128 a[224:227], v249 offset:6144
v_mul_f32_e64 v242, -v194, v242
v_mfma_f32_16x16x32_bf16 v[208:211], a[236:239], a[48:51], v[208:211]
v_mul_f32_e64 v243, -v195, v243
v_fma_f32 v244, v196, v196, s27
v_mfma_f32_16x16x32_bf16 v[212:215], a[232:235], a[36:39], v[212:215]
ds_read_b128 a[228:231], v249 offset:7168
v_fma_f32 v245, v197, v197, s27
v_mfma_f32_16x16x32_bf16 v[212:215], a[236:239], a[52:55], v[212:215]
v_exp_f32 v240, v240
v_mfma_f32_16x16x32_bf16 v[216:219], a[232:235], a[40:43], v[216:219]
v_exp_f32 v241, v241
v_mfma_f32_16x16x32_bf16 v[216:219], a[236:239], a[56:59], v[216:219]
v_exp_f32 v242, v242
v_mfma_f32_16x16x32_bf16 v[220:223], a[232:235], a[44:47], v[220:223]
v_exp_f32 v243, v243
v_mfma_f32_16x16x32_bf16 v[220:223], a[236:239], a[60:63], v[220:223]
s_waitcnt lgkmcnt(3)
v_fma_f32 v240, v240, s35, s35
v_fma_f32 v241, v241, s35, s35
v_mfma_f32_16x16x32_bf16 v[208:211], a[240:243], a[64:67], v[208:211]
ds_read_b128 a[232:235], v249 offset:8192
v_fma_f32 v242, v242, s35, s35
v_mfma_f32_16x16x32_bf16 v[208:211], a[244:247], a[80:83], v[208:211]
v_fma_f32 v243, v243, s35, s35
v_fma_f32 v246, v198, v198, s27
v_mfma_f32_16x16x32_bf16 v[212:215], a[240:243], a[68:71], v[212:215]
ds_read_b128 a[236:239], v249 offset:9216
v_fma_f32 v247, v199, v199, s27
v_mfma_f32_16x16x32_bf16 v[212:215], a[244:247], a[84:87], v[212:215]
v_rcp_f32 v240, v240
v_mfma_f32_16x16x32_bf16 v[216:219], a[240:243], a[72:75], v[216:219]
v_rcp_f32 v241, v241
v_mfma_f32_16x16x32_bf16 v[216:219], a[244:247], a[88:91], v[216:219]
v_rcp_f32 v242, v242
v_mfma_f32_16x16x32_bf16 v[220:223], a[240:243], a[76:79], v[220:223]
v_rcp_f32 v243, v243
v_mfma_f32_16x16x32_bf16 v[220:223], a[244:247], a[92:95], v[220:223]
s_waitcnt vmcnt(6) lgkmcnt(2)
s_barrier
v_mul_f32 v240, v192, v240
v_mul_f32 v241, v193, v241
v_mfma_f32_16x16x32_bf16 v[208:211], a[224:227], a[96:99], v[208:211]
s_add_u32 m0, s26, 0x6000
ds_read_b128 a[240:243], v249 offset:10240
v_mul_f32 v242, v194, v242
v_mfma_f32_16x16x32_bf16 v[208:211], a[228:231], a[112:115], v[208:211]
buffer_load_dwordx4 v252, s[8:11], s24 offen offset:0 lds
v_mfma_f32_16x16x32_bf16 v[212:215], a[224:227], a[100:103], v[212:215]
ds_read_b128 a[244:247], v249 offset:11264
v_mul_f32 v243, v195, v243
v_mfma_f32_16x16x32_bf16 v[212:215], a[228:231], a[116:119], v[212:215]
buffer_load_dwordx4 v252, s[8:11], s24 offen offset:1024 lds
v_mfma_f32_16x16x32_bf16 v[216:219], a[224:227], a[104:107], v[216:219]
ds_read_b128 a[192:195], v251 offset:0
v_cvt_pk_bf16_f32 v224, v240, v241
v_mfma_f32_16x16x32_bf16 v[216:219], a[228:231], a[120:123], v[216:219]
ds_read_b128 a[196:199], v251 offset:1024
v_cvt_pk_bf16_f32 v225, v242, v243
v_mfma_f32_16x16x32_bf16 v[220:223], a[224:227], a[108:111], v[220:223]
buffer_load_dwordx4 v252, s[8:11], s24 offen offset:2048 lds
v_mfma_f32_16x16x32_bf16 v[220:223], a[228:231], a[124:127], v[220:223]
s_waitcnt lgkmcnt(4)
v_mul_f32_e64 v244, -v196, v244
v_mul_f32_e64 v245, -v197, v245
v_mfma_f32_16x16x32_bf16 v[208:211], a[232:235], a[128:131], v[208:211]
ds_read_b128 a[224:227], v249 offset:24576
v_mul_f32_e64 v246, -v198, v246
v_mfma_f32_16x16x32_bf16 v[208:211], a[236:239], a[144:147], v[208:211]
ds_read_b128 a[200:203], v251 offset:2048
v_mul_f32_e64 v247, -v199, v247
v_mfma_f32_16x16x32_bf16 v[212:215], a[232:235], a[132:135], v[212:215]
ds_read_b128 a[228:231], v249 offset:25600
v_fma_f32 v240, v200, v200, s27
v_mfma_f32_16x16x32_bf16 v[212:215], a[236:239], a[148:151], v[212:215]
v_exp_f32 v244, v244
v_mfma_f32_16x16x32_bf16 v[216:219], a[232:235], a[136:139], v[216:219]
ds_read_b128 a[204:207], v251 offset:3072
v_fma_f32 v244, v244, s35, s35
v_mfma_f32_16x16x32_bf16 v[216:219], a[236:239], a[152:155], v[216:219]
ds_read_b128 a[208:211], v251 offset:4096
v_fma_f32 v241, v201, v201, s27
v_mfma_f32_16x16x32_bf16 v[220:223], a[232:235], a[140:143], v[220:223]
buffer_load_dwordx4 v252, s[8:11], s24 offen offset:3072 lds
v_mfma_f32_16x16x32_bf16 v[220:223], a[236:239], a[156:159], v[220:223]
s_waitcnt lgkmcnt(7)
v_exp_f32 v245, v245
v_mfma_f32_16x16x32_bf16 v[208:211], a[240:243], a[160:163], v[208:211]
ds_read_b128 a[232:235], v249 offset:26624
v_fma_f32 v245, v245, s35, s35
v_mfma_f32_16x16x32_bf16 v[208:211], a[244:247], a[176:179], v[208:211]
ds_read_b128 a[212:215], v251 offset:5120
v_fma_f32 v242, v202, v202, s27
v_mfma_f32_16x16x32_bf16 v[212:215], a[240:243], a[164:167], v[212:215]
s_add_u32 m0, s26, 0x7000
ds_read_b128 a[236:239], v249 offset:27648
v_fma_f32 v243, v203, v203, s27
v_mfma_f32_16x16x32_bf16 v[212:215], a[244:247], a[180:183], v[212:215]
buffer_load_dwordx4 v252, s[8:11], s25 offen offset:0 lds
v_mfma_f32_16x16x32_bf16 v[216:219], a[240:243], a[168:171], v[216:219]
ds_read_b128 a[216:219], v251 offset:6144
v_mul_f32_e64 v240, -v200, v240
v_mfma_f32_16x16x32_bf16 v[216:219], a[244:247], a[184:187], v[216:219]
ds_read_b128 a[220:223], v251 offset:7168
v_mul_f32_e64 v241, -v201, v241
v_mfma_f32_16x16x32_bf16 v[220:223], a[240:243], a[172:175], v[220:223]
buffer_load_dwordx4 v252, s[8:11], s25 offen offset:1024 lds
v_mfma_f32_16x16x32_bf16 v[220:223], a[244:247], a[188:191], v[220:223]
s_waitcnt lgkmcnt(0)
v_exp_f32 v246, v246
v_mfma_f32_16x16x32_bf16 v[0:3], a[224:227], a[192:195], v[0:3]
ds_read_b128 a[240:243], v249 offset:28672
v_fma_f32 v246, v246, s35, s35
v_mfma_f32_16x16x32_bf16 v[0:3], a[228:231], a[208:211], v[0:3]
s_add_u32 s24, s24, 24576
v_exp_f32 v247, v247
v_mfma_f32_16x16x32_bf16 v[4:7], a[224:227], a[196:199], v[4:7]
s_add_u32 s25, s25, 24576
ds_read_b128 a[244:247], v249 offset:29696
v_fma_f32 v247, v247, s35, s35
v_mfma_f32_16x16x32_bf16 v[4:7], a[228:231], a[212:215], v[4:7]
v_rcp_f32 v244, v244
v_mfma_f32_16x16x32_bf16 v[8:11], a[224:227], a[200:203], v[8:11]
s_add_u32 m0, s26, 0xc000
v_rcp_f32 v245, v245
v_mfma_f32_16x16x32_bf16 v[8:11], a[228:231], a[216:219], v[8:11]
buffer_load_dwordx4 v252, s[8:11], s24 offen offset:0 lds
v_mfma_f32_16x16x32_bf16 v[12:15], a[224:227], a[204:207], v[12:15]
v_rcp_f32 v246, v246
v_mfma_f32_16x16x32_bf16 v[12:15], a[228:231], a[220:223], v[12:15]
v_rcp_f32 v247, v247
v_mfma_f32_16x16x32_bf16 v[16:19], a[232:235], a[192:195], v[16:19]
ds_read_b128 a[224:227], v249 offset:30720
v_mul_f32 v244, v196, v244
v_mfma_f32_16x16x32_bf16 v[16:19], a[236:239], a[208:211], v[16:19]
v_mul_f32 v245, v197, v245
v_mul_f32 v246, v198, v246
v_mfma_f32_16x16x32_bf16 v[20:23], a[232:235], a[196:199], v[20:23]
ds_read_b128 a[228:231], v249 offset:31744
v_mul_f32 v247, v199, v247
v_mfma_f32_16x16x32_bf16 v[20:23], a[236:239], a[212:215], v[20:23]
v_cvt_pk_bf16_f32 v228, v244, v245
v_cvt_pk_bf16_f32 v229, v246, v247
v_mfma_f32_16x16x32_bf16 v[24:27], a[232:235], a[200:203], v[24:27]
v_mul_f32_e64 v242, -v202, v242
v_mul_f32_e64 v243, -v203, v243
v_mfma_f32_16x16x32_bf16 v[24:27], a[236:239], a[216:219], v[24:27]
buffer_load_dwordx4 v252, s[8:11], s24 offen offset:1024 lds
v_mfma_f32_16x16x32_bf16 v[28:31], a[232:235], a[204:207], v[28:31]
v_exp_f32 v240, v240
v_mfma_f32_16x16x32_bf16 v[28:31], a[236:239], a[220:223], v[28:31]
s_waitcnt lgkmcnt(2)
v_exp_f32 v241, v241
v_mfma_f32_16x16x32_bf16 v[32:35], a[240:243], a[192:195], v[32:35]
ds_read_b128 a[232:235], v249 offset:32768
v_fma_f32 v240, v240, s35, s35
v_mfma_f32_16x16x32_bf16 v[32:35], a[244:247], a[208:211], v[32:35]
v_exp_f32 v242, v242
v_mfma_f32_16x16x32_bf16 v[36:39], a[240:243], a[196:199], v[36:39]
ds_read_b128 a[236:239], v249 offset:33792
v_fma_f32 v241, v241, s35, s35
v_mfma_f32_16x16x32_bf16 v[36:39], a[244:247], a[212:215], v[36:39]
v_exp_f32 v243, v243
v_mfma_f32_16x16x32_bf16 v[40:43], a[240:243], a[200:203], v[40:43]
v_fma_f32 v242, v242, s35, s35
v_fma_f32 v243, v243, s35, s35
v_mfma_f32_16x16x32_bf16 v[40:43], a[244:247], a[216:219], v[40:43]
buffer_load_dwordx4 v252, s[8:11], s24 offen offset:2048 lds
v_mfma_f32_16x16x32_bf16 v[44:47], a[240:243], a[204:207], v[44:47]
v_rcp_f32 v240, v240
v_mfma_f32_16x16x32_bf16 v[44:47], a[244:247], a[220:223], v[44:47]
s_waitcnt lgkmcnt(2)
v_rcp_f32 v241, v241
v_mfma_f32_16x16x32_bf16 v[48:51], a[224:227], a[192:195], v[48:51]
ds_read_b128 a[240:243], v249 offset:34816
v_mul_f32 v240, v200, v240
v_mfma_f32_16x16x32_bf16 v[48:51], a[228:231], a[208:211], v[48:51]
v_rcp_f32 v242, v242
v_mfma_f32_16x16x32_bf16 v[52:55], a[224:227], a[196:199], v[52:55]
ds_read_b128 a[244:247], v249 offset:35840
v_mul_f32 v241, v201, v241
v_mfma_f32_16x16x32_bf16 v[52:55], a[228:231], a[212:215], v[52:55]
v_rcp_f32 v243, v243
v_mfma_f32_16x16x32_bf16 v[56:59], a[224:227], a[200:203], v[56:59]
v_mul_f32 v242, v202, v242
v_mul_f32 v243, v203, v243
v_mfma_f32_16x16x32_bf16 v[56:59], a[228:231], a[216:219], v[56:59]
buffer_load_dwordx4 v252, s[8:11], s24 offen offset:3072 lds
v_mfma_f32_16x16x32_bf16 v[60:63], a[224:227], a[204:207], v[60:63]
v_cvt_pk_bf16_f32 v232, v240, v241
v_cvt_pk_bf16_f32 v233, v242, v243
v_mfma_f32_16x16x32_bf16 v[60:63], a[228:231], a[220:223], v[60:63]
s_waitcnt lgkmcnt(2)
v_fma_f32 v244, v204, v204, s27
v_fma_f32 v245, v205, v205, s27
v_mfma_f32_16x16x32_bf16 v[64:67], a[232:235], a[192:195], v[64:67]
ds_read_b128 a[224:227], v249 offset:49152
v_fma_f32 v246, v206, v206, s27
v_mfma_f32_16x16x32_bf16 v[64:67], a[236:239], a[208:211], v[64:67]
v_fma_f32 v247, v207, v207, s27
v_mul_f32_e64 v244, -v204, v244
v_mfma_f32_16x16x32_bf16 v[68:71], a[232:235], a[196:199], v[68:71]
ds_read_b128 a[228:231], v249 offset:50176
v_mul_f32_e64 v245, -v205, v245
v_mfma_f32_16x16x32_bf16 v[68:71], a[236:239], a[212:215], v[68:71]
v_mul_f32_e64 v246, -v206, v246
v_mul_f32_e64 v247, -v207, v247
v_mfma_f32_16x16x32_bf16 v[72:75], a[232:235], a[200:203], v[72:75]
s_add_u32 m0, s26, 0xd000
v_exp_f32 v244, v244
v_mfma_f32_16x16x32_bf16 v[72:75], a[236:239], a[216:219], v[72:75]
buffer_load_dwordx4 v252, s[8:11], s25 offen offset:0 lds
v_mfma_f32_16x16x32_bf16 v[76:79], a[232:235], a[204:207], v[76:79]
v_exp_f32 v245, v245
v_mfma_f32_16x16x32_bf16 v[76:79], a[236:239], a[220:223], v[76:79]
s_waitcnt lgkmcnt(2)
v_exp_f32 v246, v246
v_mfma_f32_16x16x32_bf16 v[80:83], a[240:243], a[192:195], v[80:83]
ds_read_b128 a[232:235], v249 offset:51200
v_fma_f32 v244, v244, s35, s35
v_mfma_f32_16x16x32_bf16 v[80:83], a[244:247], a[208:211], v[80:83]
v_exp_f32 v247, v247
v_mfma_f32_16x16x32_bf16 v[84:87], a[240:243], a[196:199], v[84:87]
ds_read_b128 a[236:239], v249 offset:52224
v_fma_f32 v245, v245, s35, s35
v_mfma_f32_16x16x32_bf16 v[84:87], a[244:247], a[212:215], v[84:87]
v_fma_f32 v246, v246, s35, s35
v_fma_f32 v247, v247, s35, s35
v_mfma_f32_16x16x32_bf16 v[88:91], a[240:243], a[200:203], v[88:91]
v_rcp_f32 v244, v244
v_mfma_f32_16x16x32_bf16 v[88:91], a[244:247], a[216:219], v[88:91]
buffer_load_dwordx4 v252, s[8:11], s25 offen offset:1024 lds
v_mfma_f32_16x16x32_bf16 v[92:95], a[240:243], a[204:207], v[92:95]
v_rcp_f32 v245, v245
v_mfma_f32_16x16x32_bf16 v[92:95], a[244:247], a[220:223], v[92:95]
s_waitcnt lgkmcnt(2)
v_rcp_f32 v246, v246
v_mfma_f32_16x16x32_bf16 v[96:99], a[224:227], a[192:195], v[96:99]
ds_read_b128 a[240:243], v249 offset:53248
v_mul_f32 v244, v204, v244
v_mfma_f32_16x16x32_bf16 v[96:99], a[228:231], a[208:211], v[96:99]
s_add_u32 s24, s24, 24576
v_rcp_f32 v247, v247
v_mfma_f32_16x16x32_bf16 v[100:103], a[224:227], a[196:199], v[100:103]
s_add_u32 s25, s25, 24576
ds_read_b128 a[244:247], v249 offset:54272
v_mul_f32 v245, v205, v245
v_mfma_f32_16x16x32_bf16 v[100:103], a[228:231], a[212:215], v[100:103]
v_mul_f32 v246, v206, v246
v_mul_f32 v247, v207, v247
v_mfma_f32_16x16x32_bf16 v[104:107], a[224:227], a[200:203], v[104:107]
v_cvt_pk_bf16_f32 v236, v244, v245
v_cvt_pk_bf16_f32 v237, v246, v247
v_mfma_f32_16x16x32_bf16 v[104:107], a[228:231], a[216:219], v[104:107]
v_fma_f32 v240, v208, v208, s27
v_fma_f32 v241, v209, v209, s27
v_mfma_f32_16x16x32_bf16 v[108:111], a[224:227], a[204:207], v[108:111]
v_fma_f32 v242, v210, v210, s27
v_fma_f32 v243, v211, v211, s27
v_mfma_f32_16x16x32_bf16 v[108:111], a[228:231], a[220:223], v[108:111]
s_waitcnt lgkmcnt(2)
v_mul_f32_e64 v240, -v208, v240
v_mul_f32_e64 v241, -v209, v241
v_mfma_f32_16x16x32_bf16 v[112:115], a[232:235], a[192:195], v[112:115]
ds_read_b128 a[224:227], v249 offset:55296
v_mul_f32_e64 v242, -v210, v242
v_mfma_f32_16x16x32_bf16 v[112:115], a[236:239], a[208:211], v[112:115]
v_mul_f32_e64 v243, -v211, v243
v_fma_f32 v244, v212, v212, s27
v_mfma_f32_16x16x32_bf16 v[116:119], a[232:235], a[196:199], v[116:119]
ds_read_b128 a[228:231], v249 offset:56320
v_fma_f32 v245, v213, v213, s27
v_mfma_f32_16x16x32_bf16 v[116:119], a[236:239], a[212:215], v[116:119]
v_exp_f32 v240, v240
v_mfma_f32_16x16x32_bf16 v[120:123], a[232:235], a[200:203], v[120:123]
v_exp_f32 v241, v241
v_mfma_f32_16x16x32_bf16 v[120:123], a[236:239], a[216:219], v[120:123]
v_exp_f32 v242, v242
v_mfma_f32_16x16x32_bf16 v[124:127], a[232:235], a[204:207], v[124:127]
v_exp_f32 v243, v243
v_mfma_f32_16x16x32_bf16 v[124:127], a[236:239], a[220:223], v[124:127]
s_waitcnt vmcnt(6) lgkmcnt(2)
s_barrier
v_fma_f32 v240, v240, s35, s35
v_fma_f32 v241, v241, s35, s35
v_mfma_f32_16x16x32_bf16 v[128:131], a[240:243], a[192:195], v[128:131]
ds_read_b128 a[232:235], v249 offset:57344
v_fma_f32 v242, v242, s35, s35
v_mfma_f32_16x16x32_bf16 v[128:131], a[244:247], a[208:211], v[128:131]
v_fma_f32 v243, v243, s35, s35
v_fma_f32 v246, v214, v214, s27
v_mfma_f32_16x16x32_bf16 v[132:135], a[240:243], a[196:199], v[132:135]
s_add_u32 m0, s26, 0x12000
ds_read_b128 a[236:239], v249 offset:58368
v_fma_f32 v247, v215, v215, s27
v_mfma_f32_16x16x32_bf16 v[132:135], a[244:247], a[212:215], v[132:135]
buffer_load_dwordx4 v252, s[8:11], s24 offen offset:0 lds
v_mfma_f32_16x16x32_bf16 v[136:139], a[240:243], a[200:203], v[136:139]
v_rcp_f32 v240, v240
v_mfma_f32_16x16x32_bf16 v[136:139], a[244:247], a[216:219], v[136:139]
v_rcp_f32 v241, v241
v_mfma_f32_16x16x32_bf16 v[140:143], a[240:243], a[204:207], v[140:143]
v_rcp_f32 v242, v242
v_mfma_f32_16x16x32_bf16 v[140:143], a[244:247], a[220:223], v[140:143]
s_waitcnt lgkmcnt(2)
v_rcp_f32 v243, v243
v_mfma_f32_16x16x32_bf16 v[144:147], a[224:227], a[192:195], v[144:147]
ds_read_b128 a[240:243], v249 offset:59392
v_mul_f32 v240, v208, v240
v_mfma_f32_16x16x32_bf16 v[144:147], a[228:231], a[208:211], v[144:147]
buffer_load_dwordx4 v252, s[8:11], s24 offen offset:1024 lds
v_mfma_f32_16x16x32_bf16 v[148:151], a[224:227], a[196:199], v[148:151]
ds_read_b128 a[244:247], v249 offset:60416
v_mul_f32 v241, v209, v241
v_mfma_f32_16x16x32_bf16 v[148:151], a[228:231], a[212:215], v[148:151]
v_mul_f32 v242, v210, v242
v_mul_f32 v243, v211, v243
v_mfma_f32_16x16x32_bf16 v[152:155], a[224:227], a[200:203], v[152:155]
v_cvt_pk_bf16_f32 v226, v240, v241
v_cvt_pk_bf16_f32 v227, v242, v243
v_mfma_f32_16x16x32_bf16 v[152:155], a[228:231], a[216:219], v[152:155]
ds_write_b128 v250, v[224:227] offset:0
v_mfma_f32_16x16x32_bf16 v[156:159], a[224:227], a[204:207], v[156:159]
buffer_load_dwordx4 v252, s[8:11], s24 offen offset:2048 lds
v_mfma_f32_16x16x32_bf16 v[156:159], a[228:231], a[220:223], v[156:159]
s_waitcnt lgkmcnt(3)
v_mul_f32_e64 v244, -v212, v244
v_mul_f32_e64 v245, -v213, v245
v_mfma_f32_16x16x32_bf16 v[160:163], a[232:235], a[192:195], v[160:163]
ds_read_b128 a[224:227], v248 offset:0
v_mul_f32_e64 v246, -v214, v246
v_mfma_f32_16x16x32_bf16 v[160:163], a[236:239], a[208:211], v[160:163]
v_mul_f32_e64 v247, -v215, v247
v_fma_f32 v240, v216, v216, s27
v_mfma_f32_16x16x32_bf16 v[164:167], a[232:235], a[196:199], v[164:167]
ds_read_b128 a[228:231], v248 offset:1024
v_fma_f32 v241, v217, v217, s27
v_mfma_f32_16x16x32_bf16 v[164:167], a[236:239], a[212:215], v[164:167]
buffer_load_dwordx4 v252, s[8:11], s24 offen offset:3072 lds
v_mfma_f32_16x16x32_bf16 v[168:171], a[232:235], a[200:203], v[168:171]
v_exp_f32 v244, v244
v_mfma_f32_16x16x32_bf16 v[168:171], a[236:239], a[216:219], v[168:171]
v_exp_f32 v245, v245
v_mfma_f32_16x16x32_bf16 v[172:175], a[232:235], a[204:207], v[172:175]
v_exp_f32 v246, v246
v_mfma_f32_16x16x32_bf16 v[172:175], a[236:239], a[220:223], v[172:175]
s_waitcnt lgkmcnt(3)
v_exp_f32 v247, v247
v_mfma_f32_16x16x32_bf16 v[176:179], a[240:243], a[192:195], v[176:179]
s_add_u32 m0, s26, 0x13000
ds_read_b128 a[232:235], v248 offset:2048
v_fma_f32 v244, v244, s35, s35
v_mfma_f32_16x16x32_bf16 v[176:179], a[244:247], a[208:211], v[176:179]
buffer_load_dwordx4 v252, s[8:11], s25 offen offset:0 lds
v_mfma_f32_16x16x32_bf16 v[180:183], a[240:243], a[196:199], v[180:183]
ds_read_b128 a[236:239], v248 offset:3072
v_fma_f32 v245, v245, s35, s35
v_mfma_f32_16x16x32_bf16 v[180:183], a[244:247], a[212:215], v[180:183]
v_fma_f32 v246, v246, s35, s35
v_fma_f32 v247, v247, s35, s35
v_mfma_f32_16x16x32_bf16 v[184:187], a[240:243], a[200:203], v[184:187]
v_rcp_f32 v244, v244
v_mfma_f32_16x16x32_bf16 v[184:187], a[244:247], a[216:219], v[184:187]
v_rcp_f32 v245, v245
v_mfma_f32_16x16x32_bf16 v[188:191], a[240:243], a[204:207], v[188:191]
buffer_load_dwordx4 v252, s[8:11], s25 offen offset:1024 lds
v_mfma_f32_16x16x32_bf16 v[188:191], a[244:247], a[220:223], v[188:191]
s_waitcnt lgkmcnt(2)
v_rcp_f32 v246, v246
s_mov_b32 s28, 7
.p2align 6
L_loop:
v_mfma_f32_16x16x32_bf16 v[192:195], a[224:227], a[0:3], 0
ds_read_b128 a[240:243], v248 offset:4096
v_mul_f32 v244, v212, v244
v_mfma_f32_16x16x32_bf16 v[192:195], a[228:231], a[16:19], v[192:195]
s_add_u32 s24, s24, 24576
v_rcp_f32 v247, v247
v_mfma_f32_16x16x32_bf16 v[196:199], a[224:227], a[4:7], 0
s_add_u32 s25, s25, 24576
ds_read_b128 a[244:247], v248 offset:5120
v_mul_f32 v245, v213, v245
v_mfma_f32_16x16x32_bf16 v[196:199], a[228:231], a[20:23], v[196:199]
v_mul_f32 v246, v214, v246
v_mul_f32 v247, v215, v247
v_mfma_f32_16x16x32_bf16 v[200:203], a[224:227], a[8:11], 0
s_add_u32 m0, s26, 0x18000
v_cvt_pk_bf16_f32 v230, v244, v245
v_cvt_pk_bf16_f32 v231, v246, v247
v_mfma_f32_16x16x32_bf16 v[200:203], a[228:231], a[24:27], v[200:203]
buffer_load_dwordx4 v252, s[8:11], s24 offen offset:0 lds
v_mfma_f32_16x16x32_bf16 v[204:207], a[224:227], a[12:15], 0
ds_write_b128 v250, v[228:231] offset:1024
v_mfma_f32_16x16x32_bf16 v[204:207], a[228:231], a[28:31], v[204:207]
s_waitcnt lgkmcnt(3)
v_fma_f32 v242, v218, v218, s27
v_fma_f32 v243, v219, v219, s27
v_mfma_f32_16x16x32_bf16 v[192:195], a[232:235], a[32:35], v[192:195]
ds_read_b128 a[224:227], v248 offset:6144
v_mul_f32_e64 v240, -v216, v240
v_mfma_f32_16x16x32_bf16 v[192:195], a[236:239], a[48:51], v[192:195]
v_mul_f32_e64 v241, -v217, v241
v_mul_f32_e64 v242, -v218, v242
v_mfma_f32_16x16x32_bf16 v[196:199], a[232:235], a[36:39], v[196:199]
ds_read_b128 a[228:231], v248 offset:7168
v_mul_f32_e64 v243, -v219, v243
v_mfma_f32_16x16x32_bf16 v[196:199], a[236:239], a[52:55], v[196:199]
v_exp_f32 v240, v240
v_mfma_f32_16x16x32_bf16 v[200:203], a[232:235], a[40:43], v[200:203]
v_exp_f32 v241, v241
v_mfma_f32_16x16x32_bf16 v[200:203], a[236:239], a[56:59], v[200:203]
buffer_load_dwordx4 v252, s[8:11], s24 offen offset:1024 lds
v_mfma_f32_16x16x32_bf16 v[204:207], a[232:235], a[44:47], v[204:207]
v_exp_f32 v242, v242
v_mfma_f32_16x16x32_bf16 v[204:207], a[236:239], a[60:63], v[204:207]
s_waitcnt lgkmcnt(3)
v_exp_f32 v243, v243
v_mfma_f32_16x16x32_bf16 v[192:195], a[240:243], a[64:67], v[192:195]
ds_read_b128 a[232:235], v248 offset:8192
v_fma_f32 v240, v240, s35, s35
v_mfma_f32_16x16x32_bf16 v[192:195], a[244:247], a[80:83], v[192:195]
v_fma_f32 v241, v241, s35, s35
v_fma_f32 v242, v242, s35, s35
v_mfma_f32_16x16x32_bf16 v[196:199], a[240:243], a[68:71], v[196:199]
ds_read_b128 a[236:239], v248 offset:9216
v_fma_f32 v243, v243, s35, s35
v_mfma_f32_16x16x32_bf16 v[196:199], a[244:247], a[84:87], v[196:199]
v_rcp_f32 v240, v240
v_mfma_f32_16x16x32_bf16 v[200:203], a[240:243], a[72:75], v[200:203]
v_rcp_f32 v241, v241
v_mfma_f32_16x16x32_bf16 v[200:203], a[244:247], a[88:91], v[200:203]
buffer_load_dwordx4 v252, s[8:11], s24 offen offset:2048 lds
v_mfma_f32_16x16x32_bf16 v[204:207], a[240:243], a[76:79], v[204:207]
v_rcp_f32 v242, v242
v_mfma_f32_16x16x32_bf16 v[204:207], a[244:247], a[92:95], v[204:207]
s_waitcnt lgkmcnt(2)
v_rcp_f32 v243, v243
v_mfma_f32_16x16x32_bf16 v[192:195], a[224:227], a[96:99], v[192:195]
ds_read_b128 a[240:243], v248 offset:10240
v_mul_f32 v240, v216, v240
v_mfma_f32_16x16x32_bf16 v[192:195], a[228:231], a[112:115], v[192:195]
v_mul_f32 v241, v217, v241
v_mul_f32 v242, v218, v242
v_mfma_f32_16x16x32_bf16 v[196:199], a[224:227], a[100:103], v[196:199]
ds_read_b128 a[244:247], v248 offset:11264
v_mul_f32 v243, v219, v243
v_mfma_f32_16x16x32_bf16 v[196:199], a[228:231], a[116:119], v[196:199]
v_cvt_pk_bf16_f32 v234, v240, v241
v_cvt_pk_bf16_f32 v235, v242, v243
v_mfma_f32_16x16x32_bf16 v[200:203], a[224:227], a[104:107], v[200:203]
ds_write_b128 v250, v[232:235] offset:2048
v_mfma_f32_16x16x32_bf16 v[200:203], a[228:231], a[120:123], v[200:203]
buffer_load_dwordx4 v252, s[8:11], s24 offen offset:3072 lds
v_mfma_f32_16x16x32_bf16 v[204:207], a[224:227], a[108:111], v[204:207]
v_fma_f32 v244, v220, v220, s27
v_fma_f32 v245, v221, v221, s27
v_mfma_f32_16x16x32_bf16 v[204:207], a[228:231], a[124:127], v[204:207]
s_waitcnt lgkmcnt(3)
v_fma_f32 v246, v222, v222, s27
v_fma_f32 v247, v223, v223, s27
v_mfma_f32_16x16x32_bf16 v[192:195], a[232:235], a[128:131], v[192:195]
ds_read_b128 a[224:227], v248 offset:24576
v_mul_f32_e64 v244, -v220, v244
v_mfma_f32_16x16x32_bf16 v[192:195], a[236:239], a[144:147], v[192:195]
v_mul_f32_e64 v245, -v221, v245
v_mul_f32_e64 v246, -v222, v246
v_mfma_f32_16x16x32_bf16 v[196:199], a[232:235], a[132:135], v[196:199]
ds_read_b128 a[228:231], v248 offset:25600
v_mul_f32_e64 v247, -v223, v247
v_mfma_f32_16x16x32_bf16 v[196:199], a[236:239], a[148:151], v[196:199]
v_exp_f32 v244, v244
v_mfma_f32_16x16x32_bf16 v[200:203], a[232:235], a[136:139], v[200:203]
s_add_u32 m0, s26, 0x19000
v_exp_f32 v245, v245
v_mfma_f32_16x16x32_bf16 v[200:203], a[236:239], a[152:155], v[200:203]
buffer_load_dwordx4 v252, s[8:11], s25 offen offset:0 lds
v_mfma_f32_16x16x32_bf16 v[204:207], a[232:235], a[140:143], v[204:207]
v_exp_f32 v246, v246
v_mfma_f32_16x16x32_bf16 v[204:207], a[236:239], a[156:159], v[204:207]
s_waitcnt lgkmcnt(3)
v_exp_f32 v247, v247
v_mfma_f32_16x16x32_bf16 v[192:195], a[240:243], a[160:163], v[192:195]
ds_read_b128 a[232:235], v248 offset:26624
v_fma_f32 v244, v244, s35, s35
v_mfma_f32_16x16x32_bf16 v[192:195], a[244:247], a[176:179], v[192:195]
v_fma_f32 v245, v245, s35, s35
v_fma_f32 v246, v246, s35, s35
v_mfma_f32_16x16x32_bf16 v[196:199], a[240:243], a[164:167], v[196:199]
ds_read_b128 a[236:239], v248 offset:27648
v_fma_f32 v247, v247, s35, s35
v_mfma_f32_16x16x32_bf16 v[196:199], a[244:247], a[180:183], v[196:199]
v_rcp_f32 v244, v244
v_mfma_f32_16x16x32_bf16 v[200:203], a[240:243], a[168:171], v[200:203]
v_rcp_f32 v245, v245
v_mfma_f32_16x16x32_bf16 v[200:203], a[244:247], a[184:187], v[200:203]
buffer_load_dwordx4 v252, s[8:11], s25 offen offset:1024 lds
v_mfma_f32_16x16x32_bf16 v[204:207], a[240:243], a[172:175], v[204:207]
v_rcp_f32 v246, v246
v_mfma_f32_16x16x32_bf16 v[204:207], a[244:247], a[188:191], v[204:207]
s_waitcnt lgkmcnt(2)
v_rcp_f32 v247, v247
v_mfma_f32_16x16x32_bf16 v[208:211], a[224:227], a[0:3], 0
ds_read_b128 a[240:243], v248 offset:28672
v_mul_f32 v244, v220, v244
v_mfma_f32_16x16x32_bf16 v[208:211], a[228:231], a[16:19], v[208:211]
s_add_u32 s24, s24, 24576
v_mul_f32 v245, v221, v245
v_mul_f32 v246, v222, v246
v_mfma_f32_16x16x32_bf16 v[212:215], a[224:227], a[4:7], 0
s_add_u32 s25, s25, 24576
ds_read_b128 a[244:247], v248 offset:29696
v_mul_f32 v247, v223, v247
v_mfma_f32_16x16x32_bf16 v[212:215], a[228:231], a[20:23], v[212:215]
v_cvt_pk_bf16_f32 v238, v244, v245
v_cvt_pk_bf16_f32 v239, v246, v247
v_mfma_f32_16x16x32_bf16 v[216:219], a[224:227], a[8:11], 0
ds_write_b128 v250, v[236:239] offset:3072
v_mfma_f32_16x16x32_bf16 v[216:219], a[228:231], a[24:27], v[216:219]
v_fma_f32 v240, v192, v192, s27
v_fma_f32 v241, v193, v193, s27
v_mfma_f32_16x16x32_bf16 v[220:223], a[224:227], a[12:15], 0
v_fma_f32 v242, v194, v194, s27
v_fma_f32 v243, v195, v195, s27
v_mfma_f32_16x16x32_bf16 v[220:223], a[228:231], a[28:31], v[220:223]
s_waitcnt lgkmcnt(3)
v_mul_f32_e64 v240, -v192, v240
v_mul_f32_e64 v241, -v193, v241
v_mfma_f32_16x16x32_bf16 v[208:211], a[232:235], a[32:35], v[208:211]
ds_read_b128 a[224:227], v248 offset:30720
v_mul_f32_e64 v242, -v194, v242
v_mfma_f32_16x16x32_bf16 v[208:211], a[236:239], a[48:51], v[208:211]
v_mul_f32_e64 v243, -v195, v243
v_fma_f32 v244, v196, v196, s27
v_mfma_f32_16x16x32_bf16 v[212:215], a[232:235], a[36:39], v[212:215]
ds_read_b128 a[228:231], v248 offset:31744
v_fma_f32 v245, v197, v197, s27
v_mfma_f32_16x16x32_bf16 v[212:215], a[236:239], a[52:55], v[212:215]
v_exp_f32 v240, v240
v_mfma_f32_16x16x32_bf16 v[216:219], a[232:235], a[40:43], v[216:219]
v_exp_f32 v241, v241
v_mfma_f32_16x16x32_bf16 v[216:219], a[236:239], a[56:59], v[216:219]
v_exp_f32 v242, v242
v_mfma_f32_16x16x32_bf16 v[220:223], a[232:235], a[44:47], v[220:223]
v_exp_f32 v243, v243
v_mfma_f32_16x16x32_bf16 v[220:223], a[236:239], a[60:63], v[220:223]
s_waitcnt lgkmcnt(3)
v_fma_f32 v240, v240, s35, s35
v_fma_f32 v241, v241, s35, s35
v_mfma_f32_16x16x32_bf16 v[208:211], a[240:243], a[64:67], v[208:211]
ds_read_b128 a[232:235], v248 offset:32768
v_fma_f32 v242, v242, s35, s35
v_mfma_f32_16x16x32_bf16 v[208:211], a[244:247], a[80:83], v[208:211]
v_fma_f32 v243, v243, s35, s35
v_fma_f32 v246, v198, v198, s27
v_mfma_f32_16x16x32_bf16 v[212:215], a[240:243], a[68:71], v[212:215]
ds_read_b128 a[236:239], v248 offset:33792
v_fma_f32 v247, v199, v199, s27
v_mfma_f32_16x16x32_bf16 v[212:215], a[244:247], a[84:87], v[212:215]
v_rcp_f32 v240, v240
v_mfma_f32_16x16x32_bf16 v[216:219], a[240:243], a[72:75], v[216:219]
v_rcp_f32 v241, v241
v_mfma_f32_16x16x32_bf16 v[216:219], a[244:247], a[88:91], v[216:219]
v_rcp_f32 v242, v242
v_mfma_f32_16x16x32_bf16 v[220:223], a[240:243], a[76:79], v[220:223]
v_rcp_f32 v243, v243
v_mfma_f32_16x16x32_bf16 v[220:223], a[244:247], a[92:95], v[220:223]
s_waitcnt vmcnt(6) lgkmcnt(2)
s_barrier
v_mul_f32 v240, v192, v240
v_mul_f32 v241, v193, v241
v_mfma_f32_16x16x32_bf16 v[208:211], a[224:227], a[96:99], v[208:211]
s_add_u32 m0, s26, 0x1e000
ds_read_b128 a[240:243], v248 offset:34816
v_mul_f32 v242, v194, v242
v_mfma_f32_16x16x32_bf16 v[208:211], a[228:231], a[112:115], v[208:211]
buffer_load_dwordx4 v252, s[8:11], s24 offen offset:0 lds
v_mfma_f32_16x16x32_bf16 v[212:215], a[224:227], a[100:103], v[212:215]
ds_read_b128 a[244:247], v248 offset:35840
v_mul_f32 v243, v195, v243
v_mfma_f32_16x16x32_bf16 v[212:215], a[228:231], a[116:119], v[212:215]
buffer_load_dwordx4 v252, s[8:11], s24 offen offset:1024 lds
v_mfma_f32_16x16x32_bf16 v[216:219], a[224:227], a[104:107], v[216:219]
ds_read_b128 a[192:195], v251 offset:0
v_cvt_pk_bf16_f32 v224, v240, v241
v_mfma_f32_16x16x32_bf16 v[216:219], a[228:231], a[120:123], v[216:219]
ds_read_b128 a[196:199], v251 offset:1024
v_cvt_pk_bf16_f32 v225, v242, v243
v_mfma_f32_16x16x32_bf16 v[220:223], a[224:227], a[108:111], v[220:223]
buffer_load_dwordx4 v252, s[8:11], s24 offen offset:2048 lds
v_mfma_f32_16x16x32_bf16 v[220:223], a[228:231], a[124:127], v[220:223]
s_waitcnt lgkmcnt(4)
v_mul_f32_e64 v244, -v196, v244
v_mul_f32_e64 v245, -v197, v245
v_mfma_f32_16x16x32_bf16 v[208:211], a[232:235], a[128:131], v[208:211]
ds_read_b128 a[224:227], v248 offset:49152
v_mul_f32_e64 v246, -v198, v246
v_mfma_f32_16x16x32_bf16 v[208:211], a[236:239], a[144:147], v[208:211]
ds_read_b128 a[200:203], v251 offset:2048
v_mul_f32_e64 v247, -v199, v247
v_mfma_f32_16x16x32_bf16 v[212:215], a[232:235], a[132:135], v[212:215]
ds_read_b128 a[228:231], v248 offset:50176
v_fma_f32 v240, v200, v200, s27
v_mfma_f32_16x16x32_bf16 v[212:215], a[236:239], a[148:151], v[212:215]
v_exp_f32 v244, v244
v_mfma_f32_16x16x32_bf16 v[216:219], a[232:235], a[136:139], v[216:219]
ds_read_b128 a[204:207], v251 offset:3072
v_fma_f32 v244, v244, s35, s35
v_mfma_f32_16x16x32_bf16 v[216:219], a[236:239], a[152:155], v[216:219]
ds_read_b128 a[208:211], v251 offset:4096
v_fma_f32 v241, v201, v201, s27
v_mfma_f32_16x16x32_bf16 v[220:223], a[232:235], a[140:143], v[220:223]
buffer_load_dwordx4 v252, s[8:11], s24 offen offset:3072 lds
v_mfma_f32_16x16x32_bf16 v[220:223], a[236:239], a[156:159], v[220:223]
s_waitcnt lgkmcnt(7)
v_exp_f32 v245, v245
v_mfma_f32_16x16x32_bf16 v[208:211], a[240:243], a[160:163], v[208:211]
ds_read_b128 a[232:235], v248 offset:51200
v_fma_f32 v245, v245, s35, s35
v_mfma_f32_16x16x32_bf16 v[208:211], a[244:247], a[176:179], v[208:211]
ds_read_b128 a[212:215], v251 offset:5120
v_fma_f32 v242, v202, v202, s27
v_mfma_f32_16x16x32_bf16 v[212:215], a[240:243], a[164:167], v[212:215]
s_add_u32 m0, s26, 0x1f000
ds_read_b128 a[236:239], v248 offset:52224
v_fma_f32 v243, v203, v203, s27
v_mfma_f32_16x16x32_bf16 v[212:215], a[244:247], a[180:183], v[212:215]
buffer_load_dwordx4 v252, s[8:11], s25 offen offset:0 lds
v_mfma_f32_16x16x32_bf16 v[216:219], a[240:243], a[168:171], v[216:219]
ds_read_b128 a[216:219], v251 offset:6144
v_mul_f32_e64 v240, -v200, v240
v_mfma_f32_16x16x32_bf16 v[216:219], a[244:247], a[184:187], v[216:219]
ds_read_b128 a[220:223], v251 offset:7168
v_mul_f32_e64 v241, -v201, v241
v_mfma_f32_16x16x32_bf16 v[220:223], a[240:243], a[172:175], v[220:223]
buffer_load_dwordx4 v252, s[8:11], s25 offen offset:1024 lds
v_mfma_f32_16x16x32_bf16 v[220:223], a[244:247], a[188:191], v[220:223]
s_waitcnt lgkmcnt(0)
v_exp_f32 v246, v246
v_mfma_f32_16x16x32_bf16 v[0:3], a[224:227], a[192:195], v[0:3]
ds_read_b128 a[240:243], v248 offset:53248
v_fma_f32 v246, v246, s35, s35
v_mfma_f32_16x16x32_bf16 v[0:3], a[228:231], a[208:211], v[0:3]
s_add_u32 s24, s24, 24576
v_exp_f32 v247, v247
v_mfma_f32_16x16x32_bf16 v[4:7], a[224:227], a[196:199], v[4:7]
s_add_u32 s25, s25, 24576
ds_read_b128 a[244:247], v248 offset:54272
v_fma_f32 v247, v247, s35, s35
v_mfma_f32_16x16x32_bf16 v[4:7], a[228:231], a[212:215], v[4:7]
v_rcp_f32 v244, v244
v_mfma_f32_16x16x32_bf16 v[8:11], a[224:227], a[200:203], v[8:11]
s_add_u32 m0, s26, 0x0
v_rcp_f32 v245, v245
v_mfma_f32_16x16x32_bf16 v[8:11], a[228:231], a[216:219], v[8:11]
buffer_load_dwordx4 v252, s[8:11], s24 offen offset:0 lds
v_mfma_f32_16x16x32_bf16 v[12:15], a[224:227], a[204:207], v[12:15]
v_rcp_f32 v246, v246
v_mfma_f32_16x16x32_bf16 v[12:15], a[228:231], a[220:223], v[12:15]
v_rcp_f32 v247, v247
v_mfma_f32_16x16x32_bf16 v[16:19], a[232:235], a[192:195], v[16:19]
ds_read_b128 a[224:227], v248 offset:55296
v_mul_f32 v244, v196, v244
v_mfma_f32_16x16x32_bf16 v[16:19], a[236:239], a[208:211], v[16:19]
v_mul_f32 v245, v197, v245
v_mul_f32 v246, v198, v246
v_mfma_f32_16x16x32_bf16 v[20:23], a[232:235], a[196:199], v[20:23]
ds_read_b128 a[228:231], v248 offset:56320
v_mul_f32 v247, v199, v247
v_mfma_f32_16x16x32_bf16 v[20:23], a[236:239], a[212:215], v[20:23]
v_cvt_pk_bf16_f32 v228, v244, v245
v_cvt_pk_bf16_f32 v229, v246, v247
v_mfma_f32_16x16x32_bf16 v[24:27], a[232:235], a[200:203], v[24:27]
v_mul_f32_e64 v242, -v202, v242
v_mul_f32_e64 v243, -v203, v243
v_mfma_f32_16x16x32_bf16 v[24:27], a[236:239], a[216:219], v[24:27]
buffer_load_dwordx4 v252, s[8:11], s24 offen offset:1024 lds
v_mfma_f32_16x16x32_bf16 v[28:31], a[232:235], a[204:207], v[28:31]
v_exp_f32 v240, v240
v_mfma_f32_16x16x32_bf16 v[28:31], a[236:239], a[220:223], v[28:31]
s_waitcnt lgkmcnt(2)
v_exp_f32 v241, v241
v_mfma_f32_16x16x32_bf16 v[32:35], a[240:243], a[192:195], v[32:35]
ds_read_b128 a[232:235], v248 offset:57344
v_fma_f32 v240, v240, s35, s35
v_mfma_f32_16x16x32_bf16 v[32:35], a[244:247], a[208:211], v[32:35]
v_exp_f32 v242, v242
v_mfma_f32_16x16x32_bf16 v[36:39], a[240:243], a[196:199], v[36:39]
ds_read_b128 a[236:239], v248 offset:58368
v_fma_f32 v241, v241, s35, s35
v_mfma_f32_16x16x32_bf16 v[36:39], a[244:247], a[212:215], v[36:39]
v_exp_f32 v243, v243
v_mfma_f32_16x16x32_bf16 v[40:43], a[240:243], a[200:203], v[40:43]
v_fma_f32 v242, v242, s35, s35
v_fma_f32 v243, v243, s35, s35
v_mfma_f32_16x16x32_bf16 v[40:43], a[244:247], a[216:219], v[40:43]
buffer_load_dwordx4 v252, s[8:11], s24 offen offset:2048 lds
v_mfma_f32_16x16x32_bf16 v[44:47], a[240:243], a[204:207], v[44:47]
v_rcp_f32 v240, v240
v_mfma_f32_16x16x32_bf16 v[44:47], a[244:247], a[220:223], v[44:47]
s_waitcnt lgkmcnt(2)
v_rcp_f32 v241, v241
v_mfma_f32_16x16x32_bf16 v[48:51], a[224:227], a[192:195], v[48:51]
ds_read_b128 a[240:243], v248 offset:59392
v_mul_f32 v240, v200, v240
v_mfma_f32_16x16x32_bf16 v[48:51], a[228:231], a[208:211], v[48:51]
v_rcp_f32 v242, v242
v_mfma_f32_16x16x32_bf16 v[52:55], a[224:227], a[196:199], v[52:55]
ds_read_b128 a[244:247], v248 offset:60416
v_mul_f32 v241, v201, v241
v_mfma_f32_16x16x32_bf16 v[52:55], a[228:231], a[212:215], v[52:55]
v_rcp_f32 v243, v243
v_mfma_f32_16x16x32_bf16 v[56:59], a[224:227], a[200:203], v[56:59]
v_mul_f32 v242, v202, v242
v_mul_f32 v243, v203, v243
v_mfma_f32_16x16x32_bf16 v[56:59], a[228:231], a[216:219], v[56:59]
buffer_load_dwordx4 v252, s[8:11], s24 offen offset:3072 lds
v_mfma_f32_16x16x32_bf16 v[60:63], a[224:227], a[204:207], v[60:63]
v_cvt_pk_bf16_f32 v232, v240, v241
v_cvt_pk_bf16_f32 v233, v242, v243
v_mfma_f32_16x16x32_bf16 v[60:63], a[228:231], a[220:223], v[60:63]
s_waitcnt lgkmcnt(2)
v_fma_f32 v244, v204, v204, s27
v_fma_f32 v245, v205, v205, s27
v_mfma_f32_16x16x32_bf16 v[64:67], a[232:235], a[192:195], v[64:67]
ds_read_b128 a[224:227], v249 offset:0
v_fma_f32 v246, v206, v206, s27
v_mfma_f32_16x16x32_bf16 v[64:67], a[236:239], a[208:211], v[64:67]
v_fma_f32 v247, v207, v207, s27
v_mul_f32_e64 v244, -v204, v244
v_mfma_f32_16x16x32_bf16 v[68:71], a[232:235], a[196:199], v[68:71]
ds_read_b128 a[228:231], v249 offset:1024
v_mul_f32_e64 v245, -v205, v245
v_mfma_f32_16x16x32_bf16 v[68:71], a[236:239], a[212:215], v[68:71]
v_mul_f32_e64 v246, -v206, v246
v_mul_f32_e64 v247, -v207, v247
v_mfma_f32_16x16x32_bf16 v[72:75], a[232:235], a[200:203], v[72:75]
s_add_u32 m0, s26, 0x1000
v_exp_f32 v244, v244
v_mfma_f32_16x16x32_bf16 v[72:75], a[236:239], a[216:219], v[72:75]
buffer_load_dwordx4 v252, s[8:11], s25 offen offset:0 lds
v_mfma_f32_16x16x32_bf16 v[76:79], a[232:235], a[204:207], v[76:79]
v_exp_f32 v245, v245
v_mfma_f32_16x16x32_bf16 v[76:79], a[236:239], a[220:223], v[76:79]
s_waitcnt lgkmcnt(2)
v_exp_f32 v246, v246
v_mfma_f32_16x16x32_bf16 v[80:83], a[240:243], a[192:195], v[80:83]
ds_read_b128 a[232:235], v249 offset:2048
v_fma_f32 v244, v244, s35, s35
v_mfma_f32_16x16x32_bf16 v[80:83], a[244:247], a[208:211], v[80:83]
v_exp_f32 v247, v247
v_mfma_f32_16x16x32_bf16 v[84:87], a[240:243], a[196:199], v[84:87]
ds_read_b128 a[236:239], v249 offset:3072
v_fma_f32 v245, v245, s35, s35
v_mfma_f32_16x16x32_bf16 v[84:87], a[244:247], a[212:215], v[84:87]
v_fma_f32 v246, v246, s35, s35
v_fma_f32 v247, v247, s35, s35
v_mfma_f32_16x16x32_bf16 v[88:91], a[240:243], a[200:203], v[88:91]
v_rcp_f32 v244, v244
v_mfma_f32_16x16x32_bf16 v[88:91], a[244:247], a[216:219], v[88:91]
buffer_load_dwordx4 v252, s[8:11], s25 offen offset:1024 lds
v_mfma_f32_16x16x32_bf16 v[92:95], a[240:243], a[204:207], v[92:95]
v_rcp_f32 v245, v245
v_mfma_f32_16x16x32_bf16 v[92:95], a[244:247], a[220:223], v[92:95]
s_waitcnt lgkmcnt(2)
v_rcp_f32 v246, v246
v_mfma_f32_16x16x32_bf16 v[96:99], a[224:227], a[192:195], v[96:99]
ds_read_b128 a[240:243], v249 offset:4096
v_mul_f32 v244, v204, v244
v_mfma_f32_16x16x32_bf16 v[96:99], a[228:231], a[208:211], v[96:99]
s_add_u32 s24, s24, 24576
v_rcp_f32 v247, v247
v_mfma_f32_16x16x32_bf16 v[100:103], a[224:227], a[196:199], v[100:103]
s_add_u32 s25, s25, 24576
ds_read_b128 a[244:247], v249 offset:5120
v_mul_f32 v245, v205, v245
v_mfma_f32_16x16x32_bf16 v[100:103], a[228:231], a[212:215], v[100:103]
v_mul_f32 v246, v206, v246
v_mul_f32 v247, v207, v247
v_mfma_f32_16x16x32_bf16 v[104:107], a[224:227], a[200:203], v[104:107]
v_cvt_pk_bf16_f32 v236, v244, v245
v_cvt_pk_bf16_f32 v237, v246, v247
v_mfma_f32_16x16x32_bf16 v[104:107], a[228:231], a[216:219], v[104:107]
v_fma_f32 v240, v208, v208, s27
v_fma_f32 v241, v209, v209, s27
v_mfma_f32_16x16x32_bf16 v[108:111], a[224:227], a[204:207], v[108:111]
v_fma_f32 v242, v210, v210, s27
v_fma_f32 v243, v211, v211, s27
v_mfma_f32_16x16x32_bf16 v[108:111], a[228:231], a[220:223], v[108:111]
s_waitcnt lgkmcnt(2)
v_mul_f32_e64 v240, -v208, v240
v_mul_f32_e64 v241, -v209, v241
v_mfma_f32_16x16x32_bf16 v[112:115], a[232:235], a[192:195], v[112:115]
ds_read_b128 a[224:227], v249 offset:6144
v_mul_f32_e64 v242, -v210, v242
v_mfma_f32_16x16x32_bf16 v[112:115], a[236:239], a[208:211], v[112:115]
v_mul_f32_e64 v243, -v211, v243
v_fma_f32 v244, v212, v212, s27
v_mfma_f32_16x16x32_bf16 v[116:119], a[232:235], a[196:199], v[116:119]
ds_read_b128 a[228:231], v249 offset:7168
v_fma_f32 v245, v213, v213, s27
v_mfma_f32_16x16x32_bf16 v[116:119], a[236:239], a[212:215], v[116:119]
v_exp_f32 v240, v240
v_mfma_f32_16x16x32_bf16 v[120:123], a[232:235], a[200:203], v[120:123]
v_exp_f32 v241, v241
v_mfma_f32_16x16x32_bf16 v[120:123], a[236:239], a[216:219], v[120:123]
v_exp_f32 v242, v242
v_mfma_f32_16x16x32_bf16 v[124:127], a[232:235], a[204:207], v[124:127]
v_exp_f32 v243, v243
v_mfma_f32_16x16x32_bf16 v[124:127], a[236:239], a[220:223], v[124:127]
s_waitcnt vmcnt(6) lgkmcnt(2)
s_barrier
v_fma_f32 v240, v240, s35, s35
v_fma_f32 v241, v241, s35, s35
v_mfma_f32_16x16x32_bf16 v[128:131], a[240:243], a[192:195], v[128:131]
ds_read_b128 a[232:235], v249 offset:8192
v_fma_f32 v242, v242, s35, s35
v_mfma_f32_16x16x32_bf16 v[128:131], a[244:247], a[208:211], v[128:131]
v_fma_f32 v243, v243, s35, s35
v_fma_f32 v246, v214, v214, s27
v_mfma_f32_16x16x32_bf16 v[132:135], a[240:243], a[196:199], v[132:135]
s_add_u32 m0, s26, 0x6000
ds_read_b128 a[236:239], v249 offset:9216
v_fma_f32 v247, v215, v215, s27
v_mfma_f32_16x16x32_bf16 v[132:135], a[244:247], a[212:215], v[132:135]
buffer_load_dwordx4 v252, s[8:11], s24 offen offset:0 lds
v_mfma_f32_16x16x32_bf16 v[136:139], a[240:243], a[200:203], v[136:139]
v_rcp_f32 v240, v240
v_mfma_f32_16x16x32_bf16 v[136:139], a[244:247], a[216:219], v[136:139]
v_rcp_f32 v241, v241
v_mfma_f32_16x16x32_bf16 v[140:143], a[240:243], a[204:207], v[140:143]
v_rcp_f32 v242, v242
v_mfma_f32_16x16x32_bf16 v[140:143], a[244:247], a[220:223], v[140:143]
s_waitcnt lgkmcnt(2)
v_rcp_f32 v243, v243
v_mfma_f32_16x16x32_bf16 v[144:147], a[224:227], a[192:195], v[144:147]
ds_read_b128 a[240:243], v249 offset:10240
v_mul_f32 v240, v208, v240
v_mfma_f32_16x16x32_bf16 v[144:147], a[228:231], a[208:211], v[144:147]
buffer_load_dwordx4 v252, s[8:11], s24 offen offset:1024 lds
v_mfma_f32_16x16x32_bf16 v[148:151], a[224:227], a[196:199], v[148:151]
ds_read_b128 a[244:247], v249 offset:11264
v_mul_f32 v241, v209, v241
v_mfma_f32_16x16x32_bf16 v[148:151], a[228:231], a[212:215], v[148:151]
v_mul_f32 v242, v210, v242
v_mul_f32 v243, v211, v243
v_mfma_f32_16x16x32_bf16 v[152:155], a[224:227], a[200:203], v[152:155]
v_cvt_pk_bf16_f32 v226, v240, v241
v_cvt_pk_bf16_f32 v227, v242, v243
v_mfma_f32_16x16x32_bf16 v[152:155], a[228:231], a[216:219], v[152:155]
ds_write_b128 v250, v[224:227] offset:0
v_mfma_f32_16x16x32_bf16 v[156:159], a[224:227], a[204:207], v[156:159]
buffer_load_dwordx4 v252, s[8:11], s24 offen offset:2048 lds
v_mfma_f32_16x16x32_bf16 v[156:159], a[228:231], a[220:223], v[156:159]
s_waitcnt lgkmcnt(3)
v_mul_f32_e64 v244, -v212, v244
v_mul_f32_e64 v245, -v213, v245
v_mfma_f32_16x16x32_bf16 v[160:163], a[232:235], a[192:195], v[160:163]
ds_read_b128 a[224:227], v249 offset:24576
v_mul_f32_e64 v246, -v214, v246
v_mfma_f32_16x16x32_bf16 v[160:163], a[236:239], a[208:211], v[160:163]
v_mul_f32_e64 v247, -v215, v247
v_fma_f32 v240, v216, v216, s27
v_mfma_f32_16x16x32_bf16 v[164:167], a[232:235], a[196:199], v[164:167]
ds_read_b128 a[228:231], v249 offset:25600
v_fma_f32 v241, v217, v217, s27
v_mfma_f32_16x16x32_bf16 v[164:167], a[236:239], a[212:215], v[164:167]
buffer_load_dwordx4 v252, s[8:11], s24 offen offset:3072 lds
v_mfma_f32_16x16x32_bf16 v[168:171], a[232:235], a[200:203], v[168:171]
v_exp_f32 v244, v244
v_mfma_f32_16x16x32_bf16 v[168:171], a[236:239], a[216:219], v[168:171]
v_exp_f32 v245, v245
v_mfma_f32_16x16x32_bf16 v[172:175], a[232:235], a[204:207], v[172:175]
v_exp_f32 v246, v246
v_mfma_f32_16x16x32_bf16 v[172:175], a[236:239], a[220:223], v[172:175]
s_waitcnt lgkmcnt(3)
v_exp_f32 v247, v247
v_mfma_f32_16x16x32_bf16 v[176:179], a[240:243], a[192:195], v[176:179]
s_add_u32 m0, s26, 0x7000
ds_read_b128 a[232:235], v249 offset:26624
v_fma_f32 v244, v244, s35, s35
v_mfma_f32_16x16x32_bf16 v[176:179], a[244:247], a[208:211], v[176:179]
buffer_load_dwordx4 v252, s[8:11], s25 offen offset:0 lds
v_mfma_f32_16x16x32_bf16 v[180:183], a[240:243], a[196:199], v[180:183]
ds_read_b128 a[236:239], v249 offset:27648
v_fma_f32 v245, v245, s35, s35
v_mfma_f32_16x16x32_bf16 v[180:183], a[244:247], a[212:215], v[180:183]
v_fma_f32 v246, v246, s35, s35
v_fma_f32 v247, v247, s35, s35
v_mfma_f32_16x16x32_bf16 v[184:187], a[240:243], a[200:203], v[184:187]
v_rcp_f32 v244, v244
v_mfma_f32_16x16x32_bf16 v[184:187], a[244:247], a[216:219], v[184:187]
v_rcp_f32 v245, v245
v_mfma_f32_16x16x32_bf16 v[188:191], a[240:243], a[204:207], v[188:191]
buffer_load_dwordx4 v252, s[8:11], s25 offen offset:1024 lds
v_mfma_f32_16x16x32_bf16 v[188:191], a[244:247], a[220:223], v[188:191]
s_waitcnt lgkmcnt(2)
v_rcp_f32 v246, v246
v_mfma_f32_16x16x32_bf16 v[192:195], a[224:227], a[0:3], 0
ds_read_b128 a[240:243], v249 offset:28672
v_mul_f32 v244, v212, v244
v_mfma_f32_16x16x32_bf16 v[192:195], a[228:231], a[16:19], v[192:195]
s_add_u32 s24, s24, 24576
v_rcp_f32 v247, v247
v_mfma_f32_16x16x32_bf16 v[196:199], a[224:227], a[4:7], 0
s_add_u32 s25, s25, 24576
ds_read_b128 a[244:247], v249 offset:29696
v_mul_f32 v245, v213, v245
v_mfma_f32_16x16x32_bf16 v[196:199], a[228:231], a[20:23], v[196:199]
v_mul_f32 v246, v214, v246
v_mul_f32 v247, v215, v247
v_mfma_f32_16x16x32_bf16 v[200:203], a[224:227], a[8:11], 0
s_add_u32 m0, s26, 0xc000
v_cvt_pk_bf16_f32 v230, v244, v245
v_cvt_pk_bf16_f32 v231, v246, v247
v_mfma_f32_16x16x32_bf16 v[200:203], a[228:231], a[24:27], v[200:203]
buffer_load_dwordx4 v252, s[8:11], s24 offen offset:0 lds
v_mfma_f32_16x16x32_bf16 v[204:207], a[224:227], a[12:15], 0
ds_write_b128 v250, v[228:231] offset:1024
v_mfma_f32_16x16x32_bf16 v[204:207], a[228:231], a[28:31], v[204:207]
s_waitcnt lgkmcnt(3)
v_fma_f32 v242, v218, v218, s27
v_fma_f32 v243, v219, v219, s27
v_mfma_f32_16x16x32_bf16 v[192:195], a[232:235], a[32:35], v[192:195]
ds_read_b128 a[224:227], v249 offset:30720
v_mul_f32_e64 v240, -v216, v240
v_mfma_f32_16x16x32_bf16 v[192:195], a[236:239], a[48:51], v[192:195]
v_mul_f32_e64 v241, -v217, v241
v_mul_f32_e64 v242, -v218, v242
v_mfma_f32_16x16x32_bf16 v[196:199], a[232:235], a[36:39], v[196:199]
ds_read_b128 a[228:231], v249 offset:31744
v_mul_f32_e64 v243, -v219, v243
v_mfma_f32_16x16x32_bf16 v[196:199], a[236:239], a[52:55], v[196:199]
v_exp_f32 v240, v240
v_mfma_f32_16x16x32_bf16 v[200:203], a[232:235], a[40:43], v[200:203]
v_exp_f32 v241, v241
v_mfma_f32_16x16x32_bf16 v[200:203], a[236:239], a[56:59], v[200:203]
buffer_load_dwordx4 v252, s[8:11], s24 offen offset:1024 lds
v_mfma_f32_16x16x32_bf16 v[204:207], a[232:235], a[44:47], v[204:207]
v_exp_f32 v242, v242
v_mfma_f32_16x16x32_bf16 v[204:207], a[236:239], a[60:63], v[204:207]
s_waitcnt lgkmcnt(3)
v_exp_f32 v243, v243
v_mfma_f32_16x16x32_bf16 v[192:195], a[240:243], a[64:67], v[192:195]
ds_read_b128 a[232:235], v249 offset:32768
v_fma_f32 v240, v240, s35, s35
v_mfma_f32_16x16x32_bf16 v[192:195], a[244:247], a[80:83], v[192:195]
v_fma_f32 v241, v241, s35, s35
v_fma_f32 v242, v242, s35, s35
v_mfma_f32_16x16x32_bf16 v[196:199], a[240:243], a[68:71], v[196:199]
ds_read_b128 a[236:239], v249 offset:33792
v_fma_f32 v243, v243, s35, s35
v_mfma_f32_16x16x32_bf16 v[196:199], a[244:247], a[84:87], v[196:199]
v_rcp_f32 v240, v240
v_mfma_f32_16x16x32_bf16 v[200:203], a[240:243], a[72:75], v[200:203]
v_rcp_f32 v241, v241
v_mfma_f32_16x16x32_bf16 v[200:203], a[244:247], a[88:91], v[200:203]
buffer_load_dwordx4 v252, s[8:11], s24 offen offset:2048 lds
v_mfma_f32_16x16x32_bf16 v[204:207], a[240:243], a[76:79], v[204:207]
v_rcp_f32 v242, v242
v_mfma_f32_16x16x32_bf16 v[204:207], a[244:247], a[92:95], v[204:207]
s_waitcnt lgkmcnt(2)
v_rcp_f32 v243, v243
v_mfma_f32_16x16x32_bf16 v[192:195], a[224:227], a[96:99], v[192:195]
ds_read_b128 a[240:243], v249 offset:34816
v_mul_f32 v240, v216, v240
v_mfma_f32_16x16x32_bf16 v[192:195], a[228:231], a[112:115], v[192:195]
v_mul_f32 v241, v217, v241
v_mul_f32 v242, v218, v242
v_mfma_f32_16x16x32_bf16 v[196:199], a[224:227], a[100:103], v[196:199]
ds_read_b128 a[244:247], v249 offset:35840
v_mul_f32 v243, v219, v243
v_mfma_f32_16x16x32_bf16 v[196:199], a[228:231], a[116:119], v[196:199]
v_cvt_pk_bf16_f32 v234, v240, v241
v_cvt_pk_bf16_f32 v235, v242, v243
v_mfma_f32_16x16x32_bf16 v[200:203], a[224:227], a[104:107], v[200:203]
ds_write_b128 v250, v[232:235] offset:2048
v_mfma_f32_16x16x32_bf16 v[200:203], a[228:231], a[120:123], v[200:203]
buffer_load_dwordx4 v252, s[8:11], s24 offen offset:3072 lds
v_mfma_f32_16x16x32_bf16 v[204:207], a[224:227], a[108:111], v[204:207]
v_fma_f32 v244, v220, v220, s27
v_fma_f32 v245, v221, v221, s27
v_mfma_f32_16x16x32_bf16 v[204:207], a[228:231], a[124:127], v[204:207]
s_waitcnt lgkmcnt(3)
v_fma_f32 v246, v222, v222, s27
v_fma_f32 v247, v223, v223, s27
v_mfma_f32_16x16x32_bf16 v[192:195], a[232:235], a[128:131], v[192:195]
ds_read_b128 a[224:227], v249 offset:49152
v_mul_f32_e64 v244, -v220, v244
v_mfma_f32_16x16x32_bf16 v[192:195], a[236:239], a[144:147], v[192:195]
v_mul_f32_e64 v245, -v221, v245
v_mul_f32_e64 v246, -v222, v246
v_mfma_f32_16x16x32_bf16 v[196:199], a[232:235], a[132:135], v[196:199]
ds_read_b128 a[228:231], v249 offset:50176
v_mul_f32_e64 v247, -v223, v247
v_mfma_f32_16x16x32_bf16 v[196:199], a[236:239], a[148:151], v[196:199]
v_exp_f32 v244, v244
v_mfma_f32_16x16x32_bf16 v[200:203], a[232:235], a[136:139], v[200:203]
s_add_u32 m0, s26, 0xd000
v_exp_f32 v245, v245
v_mfma_f32_16x16x32_bf16 v[200:203], a[236:239], a[152:155], v[200:203]
buffer_load_dwordx4 v252, s[8:11], s25 offen offset:0 lds
v_mfma_f32_16x16x32_bf16 v[204:207], a[232:235], a[140:143], v[204:207]
v_exp_f32 v246, v246
v_mfma_f32_16x16x32_bf16 v[204:207], a[236:239], a[156:159], v[204:207]
s_waitcnt lgkmcnt(3)
v_exp_f32 v247, v247
v_mfma_f32_16x16x32_bf16 v[192:195], a[240:243], a[160:163], v[192:195]
ds_read_b128 a[232:235], v249 offset:51200
v_fma_f32 v244, v244, s35, s35
v_mfma_f32_16x16x32_bf16 v[192:195], a[244:247], a[176:179], v[192:195]
v_fma_f32 v245, v245, s35, s35
v_fma_f32 v246, v246, s35, s35
v_mfma_f32_16x16x32_bf16 v[196:199], a[240:243], a[164:167], v[196:199]
ds_read_b128 a[236:239], v249 offset:52224
v_fma_f32 v247, v247, s35, s35
v_mfma_f32_16x16x32_bf16 v[196:199], a[244:247], a[180:183], v[196:199]
v_rcp_f32 v244, v244
v_mfma_f32_16x16x32_bf16 v[200:203], a[240:243], a[168:171], v[200:203]
v_rcp_f32 v245, v245
v_mfma_f32_16x16x32_bf16 v[200:203], a[244:247], a[184:187], v[200:203]
buffer_load_dwordx4 v252, s[8:11], s25 offen offset:1024 lds
v_mfma_f32_16x16x32_bf16 v[204:207], a[240:243], a[172:175], v[204:207]
v_rcp_f32 v246, v246
v_mfma_f32_16x16x32_bf16 v[204:207], a[244:247], a[188:191], v[204:207]
s_waitcnt lgkmcnt(2)
v_rcp_f32 v247, v247
v_mfma_f32_16x16x32_bf16 v[208:211], a[224:227], a[0:3], 0
ds_read_b128 a[240:243], v249 offset:53248
v_mul_f32 v244, v220, v244
v_mfma_f32_16x16x32_bf16 v[208:211], a[228:231], a[16:19], v[208:211]
s_add_u32 s24, s24, 24576
v_mul_f32 v245, v221, v245
v_mul_f32 v246, v222, v246
v_mfma_f32_16x16x32_bf16 v[212:215], a[224:227], a[4:7], 0
s_add_u32 s25, s25, 24576
ds_read_b128 a[244:247], v249 offset:54272
v_mul_f32 v247, v223, v247
v_mfma_f32_16x16x32_bf16 v[212:215], a[228:231], a[20:23], v[212:215]
v_cvt_pk_bf16_f32 v238, v244, v245
v_cvt_pk_bf16_f32 v239, v246, v247
v_mfma_f32_16x16x32_bf16 v[216:219], a[224:227], a[8:11], 0
ds_write_b128 v250, v[236:239] offset:3072
v_mfma_f32_16x16x32_bf16 v[216:219], a[228:231], a[24:27], v[216:219]
v_fma_f32 v240, v192, v192, s27
v_fma_f32 v241, v193, v193, s27
v_mfma_f32_16x16x32_bf16 v[220:223], a[224:227], a[12:15], 0
v_fma_f32 v242, v194, v194, s27
v_fma_f32 v243, v195, v195, s27
v_mfma_f32_16x16x32_bf16 v[220:223], a[228:231], a[28:31], v[220:223]
s_waitcnt lgkmcnt(3)
v_mul_f32_e64 v240, -v192, v240
v_mul_f32_e64 v241, -v193, v241
v_mfma_f32_16x16x32_bf16 v[208:211], a[232:235], a[32:35], v[208:211]
ds_read_b128 a[224:227], v249 offset:55296
v_mul_f32_e64 v242, -v194, v242
v_mfma_f32_16x16x32_bf16 v[208:211], a[236:239], a[48:51], v[208:211]
v_mul_f32_e64 v243, -v195, v243
v_fma_f32 v244, v196, v196, s27
v_mfma_f32_16x16x32_bf16 v[212:215], a[232:235], a[36:39], v[212:215]
ds_read_b128 a[228:231], v249 offset:56320
v_fma_f32 v245, v197, v197, s27
v_mfma_f32_16x16x32_bf16 v[212:215], a[236:239], a[52:55], v[212:215]
v_exp_f32 v240, v240
v_mfma_f32_16x16x32_bf16 v[216:219], a[232:235], a[40:43], v[216:219]
v_exp_f32 v241, v241
v_mfma_f32_16x16x32_bf16 v[216:219], a[236:239], a[56:59], v[216:219]
v_exp_f32 v242, v242
v_mfma_f32_16x16x32_bf16 v[220:223], a[232:235], a[44:47], v[220:223]
v_exp_f32 v243, v243
v_mfma_f32_16x16x32_bf16 v[220:223], a[236:239], a[60:63], v[220:223]
s_waitcnt lgkmcnt(3)
v_fma_f32 v240, v240, s35, s35
v_fma_f32 v241, v241, s35, s35
v_mfma_f32_16x16x32_bf16 v[208:211], a[240:243], a[64:67], v[208:211]
ds_read_b128 a[232:235], v249 offset:57344
v_fma_f32 v242, v242, s35, s35
v_mfma_f32_16x16x32_bf16 v[208:211], a[244:247], a[80:83], v[208:211]
v_fma_f32 v243, v243, s35, s35
v_fma_f32 v246, v198, v198, s27
v_mfma_f32_16x16x32_bf16 v[212:215], a[240:243], a[68:71], v[212:215]
ds_read_b128 a[236:239], v249 offset:58368
v_fma_f32 v247, v199, v199, s27
v_mfma_f32_16x16x32_bf16 v[212:215], a[244:247], a[84:87], v[212:215]
v_rcp_f32 v240, v240
v_mfma_f32_16x16x32_bf16 v[216:219], a[240:243], a[72:75], v[216:219]
v_rcp_f32 v241, v241
v_mfma_f32_16x16x32_bf16 v[216:219], a[244:247], a[88:91], v[216:219]
v_rcp_f32 v242, v242
v_mfma_f32_16x16x32_bf16 v[220:223], a[240:243], a[76:79], v[220:223]
v_rcp_f32 v243, v243
v_mfma_f32_16x16x32_bf16 v[220:223], a[244:247], a[92:95], v[220:223]
s_waitcnt vmcnt(6) lgkmcnt(2)
s_barrier
v_mul_f32 v240, v192, v240
v_mul_f32 v241, v193, v241
v_mfma_f32_16x16x32_bf16 v[208:211], a[224:227], a[96:99], v[208:211]
s_add_u32 m0, s26, 0x12000
ds_read_b128 a[240:243], v249 offset:59392
v_mul_f32 v242, v194, v242
v_mfma_f32_16x16x32_bf16 v[208:211], a[228:231], a[112:115], v[208:211]
buffer_load_dwordx4 v252, s[8:11], s24 offen offset:0 lds
v_mfma_f32_16x16x32_bf16 v[212:215], a[224:227], a[100:103], v[212:215]
ds_read_b128 a[244:247], v249 offset:60416
v_mul_f32 v243, v195, v243
v_mfma_f32_16x16x32_bf16 v[212:215], a[228:231], a[116:119], v[212:215]
buffer_load_dwordx4 v252, s[8:11], s24 offen offset:1024 lds
v_mfma_f32_16x16x32_bf16 v[216:219], a[224:227], a[104:107], v[216:219]
ds_read_b128 a[192:195], v251 offset:0
v_cvt_pk_bf16_f32 v224, v240, v241
v_mfma_f32_16x16x32_bf16 v[216:219], a[228:231], a[120:123], v[216:219]
ds_read_b128 a[196:199], v251 offset:1024
v_cvt_pk_bf16_f32 v225, v242, v243
v_mfma_f32_16x16x32_bf16 v[220:223], a[224:227], a[108:111], v[220:223]
buffer_load_dwordx4 v252, s[8:11], s24 offen offset:2048 lds
v_mfma_f32_16x16x32_bf16 v[220:223], a[228:231], a[124:127], v[220:223]
s_waitcnt lgkmcnt(4)
v_mul_f32_e64 v244, -v196, v244
v_mul_f32_e64 v245, -v197, v245
v_mfma_f32_16x16x32_bf16 v[208:211], a[232:235], a[128:131], v[208:211]
ds_read_b128 a[224:227], v248 offset:0
v_mul_f32_e64 v246, -v198, v246
v_mfma_f32_16x16x32_bf16 v[208:211], a[236:239], a[144:147], v[208:211]
ds_read_b128 a[200:203], v251 offset:2048
v_mul_f32_e64 v247, -v199, v247
v_mfma_f32_16x16x32_bf16 v[212:215], a[232:235], a[132:135], v[212:215]
ds_read_b128 a[228:231], v248 offset:1024
v_fma_f32 v240, v200, v200, s27
v_mfma_f32_16x16x32_bf16 v[212:215], a[236:239], a[148:151], v[212:215]
v_exp_f32 v244, v244
v_mfma_f32_16x16x32_bf16 v[216:219], a[232:235], a[136:139], v[216:219]
ds_read_b128 a[204:207], v251 offset:3072
v_fma_f32 v244, v244, s35, s35
v_mfma_f32_16x16x32_bf16 v[216:219], a[236:239], a[152:155], v[216:219]
ds_read_b128 a[208:211], v251 offset:4096
v_fma_f32 v241, v201, v201, s27
v_mfma_f32_16x16x32_bf16 v[220:223], a[232:235], a[140:143], v[220:223]
buffer_load_dwordx4 v252, s[8:11], s24 offen offset:3072 lds
v_mfma_f32_16x16x32_bf16 v[220:223], a[236:239], a[156:159], v[220:223]
s_waitcnt lgkmcnt(7)
v_exp_f32 v245, v245
v_mfma_f32_16x16x32_bf16 v[208:211], a[240:243], a[160:163], v[208:211]
ds_read_b128 a[232:235], v248 offset:2048
v_fma_f32 v245, v245, s35, s35
v_mfma_f32_16x16x32_bf16 v[208:211], a[244:247], a[176:179], v[208:211]
ds_read_b128 a[212:215], v251 offset:5120
v_fma_f32 v242, v202, v202, s27
v_mfma_f32_16x16x32_bf16 v[212:215], a[240:243], a[164:167], v[212:215]
s_add_u32 m0, s26, 0x13000
ds_read_b128 a[236:239], v248 offset:3072
v_fma_f32 v243, v203, v203, s27
v_mfma_f32_16x16x32_bf16 v[212:215], a[244:247], a[180:183], v[212:215]
buffer_load_dwordx4 v252, s[8:11], s25 offen offset:0 lds
v_mfma_f32_16x16x32_bf16 v[216:219], a[240:243], a[168:171], v[216:219]
ds_read_b128 a[216:219], v251 offset:6144
v_mul_f32_e64 v240, -v200, v240
v_mfma_f32_16x16x32_bf16 v[216:219], a[244:247], a[184:187], v[216:219]
ds_read_b128 a[220:223], v251 offset:7168
v_mul_f32_e64 v241, -v201, v241
v_mfma_f32_16x16x32_bf16 v[220:223], a[240:243], a[172:175], v[220:223]
buffer_load_dwordx4 v252, s[8:11], s25 offen offset:1024 lds
v_mfma_f32_16x16x32_bf16 v[220:223], a[244:247], a[188:191], v[220:223]
s_waitcnt lgkmcnt(0)
v_exp_f32 v246, v246
v_mfma_f32_16x16x32_bf16 v[0:3], a[224:227], a[192:195], v[0:3]
ds_read_b128 a[240:243], v248 offset:4096
v_fma_f32 v246, v246, s35, s35
v_mfma_f32_16x16x32_bf16 v[0:3], a[228:231], a[208:211], v[0:3]
s_add_u32 s24, s24, 24576
v_exp_f32 v247, v247
v_mfma_f32_16x16x32_bf16 v[4:7], a[224:227], a[196:199], v[4:7]
s_add_u32 s25, s25, 24576
ds_read_b128 a[244:247], v248 offset:5120
v_fma_f32 v247, v247, s35, s35
v_mfma_f32_16x16x32_bf16 v[4:7], a[228:231], a[212:215], v[4:7]
v_rcp_f32 v244, v244
v_mfma_f32_16x16x32_bf16 v[8:11], a[224:227], a[200:203], v[8:11]
s_add_u32 m0, s26, 0x18000
v_rcp_f32 v245, v245
v_mfma_f32_16x16x32_bf16 v[8:11], a[228:231], a[216:219], v[8:11]
buffer_load_dwordx4 v252, s[8:11], s24 offen offset:0 lds
v_mfma_f32_16x16x32_bf16 v[12:15], a[224:227], a[204:207], v[12:15]
v_rcp_f32 v246, v246
v_mfma_f32_16x16x32_bf16 v[12:15], a[228:231], a[220:223], v[12:15]
v_rcp_f32 v247, v247
v_mfma_f32_16x16x32_bf16 v[16:19], a[232:235], a[192:195], v[16:19]
ds_read_b128 a[224:227], v248 offset:6144
v_mul_f32 v244, v196, v244
v_mfma_f32_16x16x32_bf16 v[16:19], a[236:239], a[208:211], v[16:19]
v_mul_f32 v245, v197, v245
v_mul_f32 v246, v198, v246
v_mfma_f32_16x16x32_bf16 v[20:23], a[232:235], a[196:199], v[20:23]
ds_read_b128 a[228:231], v248 offset:7168
v_mul_f32 v247, v199, v247
v_mfma_f32_16x16x32_bf16 v[20:23], a[236:239], a[212:215], v[20:23]
v_cvt_pk_bf16_f32 v228, v244, v245
v_cvt_pk_bf16_f32 v229, v246, v247
v_mfma_f32_16x16x32_bf16 v[24:27], a[232:235], a[200:203], v[24:27]
v_mul_f32_e64 v242, -v202, v242
v_mul_f32_e64 v243, -v203, v243
v_mfma_f32_16x16x32_bf16 v[24:27], a[236:239], a[216:219], v[24:27]
buffer_load_dwordx4 v252, s[8:11], s24 offen offset:1024 lds
v_mfma_f32_16x16x32_bf16 v[28:31], a[232:235], a[204:207], v[28:31]
v_exp_f32 v240, v240
v_mfma_f32_16x16x32_bf16 v[28:31], a[236:239], a[220:223], v[28:31]
s_waitcnt lgkmcnt(2)
v_exp_f32 v241, v241
v_mfma_f32_16x16x32_bf16 v[32:35], a[240:243], a[192:195], v[32:35]
ds_read_b128 a[232:235], v248 offset:8192
v_fma_f32 v240, v240, s35, s35
v_mfma_f32_16x16x32_bf16 v[32:35], a[244:247], a[208:211], v[32:35]
v_exp_f32 v242, v242
v_mfma_f32_16x16x32_bf16 v[36:39], a[240:243], a[196:199], v[36:39]
ds_read_b128 a[236:239], v248 offset:9216
v_fma_f32 v241, v241, s35, s35
v_mfma_f32_16x16x32_bf16 v[36:39], a[244:247], a[212:215], v[36:39]
v_exp_f32 v243, v243
v_mfma_f32_16x16x32_bf16 v[40:43], a[240:243], a[200:203], v[40:43]
v_fma_f32 v242, v242, s35, s35
v_fma_f32 v243, v243, s35, s35
v_mfma_f32_16x16x32_bf16 v[40:43], a[244:247], a[216:219], v[40:43]
buffer_load_dwordx4 v252, s[8:11], s24 offen offset:2048 lds
v_mfma_f32_16x16x32_bf16 v[44:47], a[240:243], a[204:207], v[44:47]
v_rcp_f32 v240, v240
v_mfma_f32_16x16x32_bf16 v[44:47], a[244:247], a[220:223], v[44:47]
s_waitcnt lgkmcnt(2)
v_rcp_f32 v241, v241
v_mfma_f32_16x16x32_bf16 v[48:51], a[224:227], a[192:195], v[48:51]
ds_read_b128 a[240:243], v248 offset:10240
v_mul_f32 v240, v200, v240
v_mfma_f32_16x16x32_bf16 v[48:51], a[228:231], a[208:211], v[48:51]
v_rcp_f32 v242, v242
v_mfma_f32_16x16x32_bf16 v[52:55], a[224:227], a[196:199], v[52:55]
ds_read_b128 a[244:247], v248 offset:11264
v_mul_f32 v241, v201, v241
v_mfma_f32_16x16x32_bf16 v[52:55], a[228:231], a[212:215], v[52:55]
v_rcp_f32 v243, v243
v_mfma_f32_16x16x32_bf16 v[56:59], a[224:227], a[200:203], v[56:59]
v_mul_f32 v242, v202, v242
v_mul_f32 v243, v203, v243
v_mfma_f32_16x16x32_bf16 v[56:59], a[228:231], a[216:219], v[56:59]
buffer_load_dwordx4 v252, s[8:11], s24 offen offset:3072 lds
v_mfma_f32_16x16x32_bf16 v[60:63], a[224:227], a[204:207], v[60:63]
v_cvt_pk_bf16_f32 v232, v240, v241
v_cvt_pk_bf16_f32 v233, v242, v243
v_mfma_f32_16x16x32_bf16 v[60:63], a[228:231], a[220:223], v[60:63]
s_waitcnt lgkmcnt(2)
v_fma_f32 v244, v204, v204, s27
v_fma_f32 v245, v205, v205, s27
v_mfma_f32_16x16x32_bf16 v[64:67], a[232:235], a[192:195], v[64:67]
ds_read_b128 a[224:227], v248 offset:24576
v_fma_f32 v246, v206, v206, s27
v_mfma_f32_16x16x32_bf16 v[64:67], a[236:239], a[208:211], v[64:67]
v_fma_f32 v247, v207, v207, s27
v_mul_f32_e64 v244, -v204, v244
v_mfma_f32_16x16x32_bf16 v[68:71], a[232:235], a[196:199], v[68:71]
ds_read_b128 a[228:231], v248 offset:25600
v_mul_f32_e64 v245, -v205, v245
v_mfma_f32_16x16x32_bf16 v[68:71], a[236:239], a[212:215], v[68:71]
v_mul_f32_e64 v246, -v206, v246
v_mul_f32_e64 v247, -v207, v247
v_mfma_f32_16x16x32_bf16 v[72:75], a[232:235], a[200:203], v[72:75]
s_add_u32 m0, s26, 0x19000
v_exp_f32 v244, v244
v_mfma_f32_16x16x32_bf16 v[72:75], a[236:239], a[216:219], v[72:75]
buffer_load_dwordx4 v252, s[8:11], s25 offen offset:0 lds
v_mfma_f32_16x16x32_bf16 v[76:79], a[232:235], a[204:207], v[76:79]
v_exp_f32 v245, v245
v_mfma_f32_16x16x32_bf16 v[76:79], a[236:239], a[220:223], v[76:79]
s_waitcnt lgkmcnt(2)
v_exp_f32 v246, v246
v_mfma_f32_16x16x32_bf16 v[80:83], a[240:243], a[192:195], v[80:83]
ds_read_b128 a[232:235], v248 offset:26624
v_fma_f32 v244, v244, s35, s35
v_mfma_f32_16x16x32_bf16 v[80:83], a[244:247], a[208:211], v[80:83]
v_exp_f32 v247, v247
v_mfma_f32_16x16x32_bf16 v[84:87], a[240:243], a[196:199], v[84:87]
ds_read_b128 a[236:239], v248 offset:27648
v_fma_f32 v245, v245, s35, s35
v_mfma_f32_16x16x32_bf16 v[84:87], a[244:247], a[212:215], v[84:87]
v_fma_f32 v246, v246, s35, s35
v_fma_f32 v247, v247, s35, s35
v_mfma_f32_16x16x32_bf16 v[88:91], a[240:243], a[200:203], v[88:91]
v_rcp_f32 v244, v244
v_mfma_f32_16x16x32_bf16 v[88:91], a[244:247], a[216:219], v[88:91]
buffer_load_dwordx4 v252, s[8:11], s25 offen offset:1024 lds
v_mfma_f32_16x16x32_bf16 v[92:95], a[240:243], a[204:207], v[92:95]
v_rcp_f32 v245, v245
v_mfma_f32_16x16x32_bf16 v[92:95], a[244:247], a[220:223], v[92:95]
s_waitcnt lgkmcnt(2)
v_rcp_f32 v246, v246
v_mfma_f32_16x16x32_bf16 v[96:99], a[224:227], a[192:195], v[96:99]
ds_read_b128 a[240:243], v248 offset:28672
v_mul_f32 v244, v204, v244
v_mfma_f32_16x16x32_bf16 v[96:99], a[228:231], a[208:211], v[96:99]
s_add_u32 s24, s24, 24576
v_rcp_f32 v247, v247
v_mfma_f32_16x16x32_bf16 v[100:103], a[224:227], a[196:199], v[100:103]
s_add_u32 s25, s25, 24576
ds_read_b128 a[244:247], v248 offset:29696
v_mul_f32 v245, v205, v245
v_mfma_f32_16x16x32_bf16 v[100:103], a[228:231], a[212:215], v[100:103]
v_mul_f32 v246, v206, v246
v_mul_f32 v247, v207, v247
v_mfma_f32_16x16x32_bf16 v[104:107], a[224:227], a[200:203], v[104:107]
v_cvt_pk_bf16_f32 v236, v244, v245
v_cvt_pk_bf16_f32 v237, v246, v247
v_mfma_f32_16x16x32_bf16 v[104:107], a[228:231], a[216:219], v[104:107]
v_fma_f32 v240, v208, v208, s27
v_fma_f32 v241, v209, v209, s27
v_mfma_f32_16x16x32_bf16 v[108:111], a[224:227], a[204:207], v[108:111]
v_fma_f32 v242, v210, v210, s27
v_fma_f32 v243, v211, v211, s27
v_mfma_f32_16x16x32_bf16 v[108:111], a[228:231], a[220:223], v[108:111]
s_waitcnt lgkmcnt(2)
v_mul_f32_e64 v240, -v208, v240
v_mul_f32_e64 v241, -v209, v241
v_mfma_f32_16x16x32_bf16 v[112:115], a[232:235], a[192:195], v[112:115]
ds_read_b128 a[224:227], v248 offset:30720
v_mul_f32_e64 v242, -v210, v242
v_mfma_f32_16x16x32_bf16 v[112:115], a[236:239], a[208:211], v[112:115]
v_mul_f32_e64 v243, -v211, v243
v_fma_f32 v244, v212, v212, s27
v_mfma_f32_16x16x32_bf16 v[116:119], a[232:235], a[196:199], v[116:119]
ds_read_b128 a[228:231], v248 offset:31744
v_fma_f32 v245, v213, v213, s27
v_mfma_f32_16x16x32_bf16 v[116:119], a[236:239], a[212:215], v[116:119]
v_exp_f32 v240, v240
v_mfma_f32_16x16x32_bf16 v[120:123], a[232:235], a[200:203], v[120:123]
v_exp_f32 v241, v241
v_mfma_f32_16x16x32_bf16 v[120:123], a[236:239], a[216:219], v[120:123]
v_exp_f32 v242, v242
v_mfma_f32_16x16x32_bf16 v[124:127], a[232:235], a[204:207], v[124:127]
v_exp_f32 v243, v243
v_mfma_f32_16x16x32_bf16 v[124:127], a[236:239], a[220:223], v[124:127]
s_waitcnt vmcnt(6) lgkmcnt(2)
s_barrier
v_fma_f32 v240, v240, s35, s35
v_fma_f32 v241, v241, s35, s35
v_mfma_f32_16x16x32_bf16 v[128:131], a[240:243], a[192:195], v[128:131]
ds_read_b128 a[232:235], v248 offset:32768
v_fma_f32 v242, v242, s35, s35
v_mfma_f32_16x16x32_bf16 v[128:131], a[244:247], a[208:211], v[128:131]
v_fma_f32 v243, v243, s35, s35
v_fma_f32 v246, v214, v214, s27
v_mfma_f32_16x16x32_bf16 v[132:135], a[240:243], a[196:199], v[132:135]
s_add_u32 m0, s26, 0x1e000
ds_read_b128 a[236:239], v248 offset:33792
v_fma_f32 v247, v215, v215, s27
v_mfma_f32_16x16x32_bf16 v[132:135], a[244:247], a[212:215], v[132:135]
buffer_load_dwordx4 v252, s[8:11], s24 offen offset:0 lds
v_mfma_f32_16x16x32_bf16 v[136:139], a[240:243], a[200:203], v[136:139]
v_rcp_f32 v240, v240
v_mfma_f32_16x16x32_bf16 v[136:139], a[244:247], a[216:219], v[136:139]
v_rcp_f32 v241, v241
v_mfma_f32_16x16x32_bf16 v[140:143], a[240:243], a[204:207], v[140:143]
v_rcp_f32 v242, v242
v_mfma_f32_16x16x32_bf16 v[140:143], a[244:247], a[220:223], v[140:143]
s_waitcnt lgkmcnt(2)
v_rcp_f32 v243, v243
v_mfma_f32_16x16x32_bf16 v[144:147], a[224:227], a[192:195], v[144:147]
ds_read_b128 a[240:243], v248 offset:34816
v_mul_f32 v240, v208, v240
v_mfma_f32_16x16x32_bf16 v[144:147], a[228:231], a[208:211], v[144:147]
buffer_load_dwordx4 v252, s[8:11], s24 offen offset:1024 lds
v_mfma_f32_16x16x32_bf16 v[148:151], a[224:227], a[196:199], v[148:151]
ds_read_b128 a[244:247], v248 offset:35840
v_mul_f32 v241, v209, v241
v_mfma_f32_16x16x32_bf16 v[148:151], a[228:231], a[212:215], v[148:151]
v_mul_f32 v242, v210, v242
v_mul_f32 v243, v211, v243
v_mfma_f32_16x16x32_bf16 v[152:155], a[224:227], a[200:203], v[152:155]
v_cvt_pk_bf16_f32 v226, v240, v241
v_cvt_pk_bf16_f32 v227, v242, v243
v_mfma_f32_16x16x32_bf16 v[152:155], a[228:231], a[216:219], v[152:155]
ds_write_b128 v250, v[224:227] offset:0
v_mfma_f32_16x16x32_bf16 v[156:159], a[224:227], a[204:207], v[156:159]
buffer_load_dwordx4 v252, s[8:11], s24 offen offset:2048 lds
v_mfma_f32_16x16x32_bf16 v[156:159], a[228:231], a[220:223], v[156:159]
s_waitcnt lgkmcnt(3)
v_mul_f32_e64 v244, -v212, v244
v_mul_f32_e64 v245, -v213, v245
v_mfma_f32_16x16x32_bf16 v[160:163], a[232:235], a[192:195], v[160:163]
ds_read_b128 a[224:227], v248 offset:49152
v_mul_f32_e64 v246, -v214, v246
v_mfma_f32_16x16x32_bf16 v[160:163], a[236:239], a[208:211], v[160:163]
v_mul_f32_e64 v247, -v215, v247
v_fma_f32 v240, v216, v216, s27
v_mfma_f32_16x16x32_bf16 v[164:167], a[232:235], a[196:199], v[164:167]
ds_read_b128 a[228:231], v248 offset:50176
v_fma_f32 v241, v217, v217, s27
v_mfma_f32_16x16x32_bf16 v[164:167], a[236:239], a[212:215], v[164:167]
buffer_load_dwordx4 v252, s[8:11], s24 offen offset:3072 lds
v_mfma_f32_16x16x32_bf16 v[168:171], a[232:235], a[200:203], v[168:171]
v_exp_f32 v244, v244
v_mfma_f32_16x16x32_bf16 v[168:171], a[236:239], a[216:219], v[168:171]
v_exp_f32 v245, v245
v_mfma_f32_16x16x32_bf16 v[172:175], a[232:235], a[204:207], v[172:175]
v_exp_f32 v246, v246
v_mfma_f32_16x16x32_bf16 v[172:175], a[236:239], a[220:223], v[172:175]
s_waitcnt lgkmcnt(3)
v_exp_f32 v247, v247
v_mfma_f32_16x16x32_bf16 v[176:179], a[240:243], a[192:195], v[176:179]
s_add_u32 m0, s26, 0x1f000
ds_read_b128 a[232:235], v248 offset:51200
v_fma_f32 v244, v244, s35, s35
v_mfma_f32_16x16x32_bf16 v[176:179], a[244:247], a[208:211], v[176:179]
buffer_load_dwordx4 v252, s[8:11], s25 offen offset:0 lds
v_mfma_f32_16x16x32_bf16 v[180:183], a[240:243], a[196:199], v[180:183]
ds_read_b128 a[236:239], v248 offset:52224
v_fma_f32 v245, v245, s35, s35
v_mfma_f32_16x16x32_bf16 v[180:183], a[244:247], a[212:215], v[180:183]
v_fma_f32 v246, v246, s35, s35
v_fma_f32 v247, v247, s35, s35
v_mfma_f32_16x16x32_bf16 v[184:187], a[240:243], a[200:203], v[184:187]
v_rcp_f32 v244, v244
v_mfma_f32_16x16x32_bf16 v[184:187], a[244:247], a[216:219], v[184:187]
v_rcp_f32 v245, v245
v_mfma_f32_16x16x32_bf16 v[188:191], a[240:243], a[204:207], v[188:191]
buffer_load_dwordx4 v252, s[8:11], s25 offen offset:1024 lds
v_mfma_f32_16x16x32_bf16 v[188:191], a[244:247], a[220:223], v[188:191]
s_waitcnt lgkmcnt(2)
v_rcp_f32 v246, v246
v_mfma_f32_16x16x32_bf16 v[192:195], a[224:227], a[0:3], 0
ds_read_b128 a[240:243], v248 offset:53248
v_mul_f32 v244, v212, v244
v_mfma_f32_16x16x32_bf16 v[192:195], a[228:231], a[16:19], v[192:195]
s_add_u32 s24, s24, 24576
v_rcp_f32 v247, v247
v_mfma_f32_16x16x32_bf16 v[196:199], a[224:227], a[4:7], 0
s_add_u32 s25, s25, 24576
ds_read_b128 a[244:247], v248 offset:54272
v_mul_f32 v245, v213, v245
v_mfma_f32_16x16x32_bf16 v[196:199], a[228:231], a[20:23], v[196:199]
v_mul_f32 v246, v214, v246
v_mul_f32 v247, v215, v247
v_mfma_f32_16x16x32_bf16 v[200:203], a[224:227], a[8:11], 0
s_add_u32 m0, s26, 0x0
v_cvt_pk_bf16_f32 v230, v244, v245
v_cvt_pk_bf16_f32 v231, v246, v247
v_mfma_f32_16x16x32_bf16 v[200:203], a[228:231], a[24:27], v[200:203]
buffer_load_dwordx4 v252, s[8:11], s24 offen offset:0 lds
v_mfma_f32_16x16x32_bf16 v[204:207], a[224:227], a[12:15], 0
ds_write_b128 v250, v[228:231] offset:1024
v_mfma_f32_16x16x32_bf16 v[204:207], a[228:231], a[28:31], v[204:207]
s_waitcnt lgkmcnt(3)
v_fma_f32 v242, v218, v218, s27
v_fma_f32 v243, v219, v219, s27
v_mfma_f32_16x16x32_bf16 v[192:195], a[232:235], a[32:35], v[192:195]
ds_read_b128 a[224:227], v248 offset:55296
v_mul_f32_e64 v240, -v216, v240
v_mfma_f32_16x16x32_bf16 v[192:195], a[236:239], a[48:51], v[192:195]
v_mul_f32_e64 v241, -v217, v241
v_mul_f32_e64 v242, -v218, v242
v_mfma_f32_16x16x32_bf16 v[196:199], a[232:235], a[36:39], v[196:199]
ds_read_b128 a[228:231], v248 offset:56320
v_mul_f32_e64 v243, -v219, v243
v_mfma_f32_16x16x32_bf16 v[196:199], a[236:239], a[52:55], v[196:199]
v_exp_f32 v240, v240
v_mfma_f32_16x16x32_bf16 v[200:203], a[232:235], a[40:43], v[200:203]
v_exp_f32 v241, v241
v_mfma_f32_16x16x32_bf16 v[200:203], a[236:239], a[56:59], v[200:203]
buffer_load_dwordx4 v252, s[8:11], s24 offen offset:1024 lds
v_mfma_f32_16x16x32_bf16 v[204:207], a[232:235], a[44:47], v[204:207]
v_exp_f32 v242, v242
v_mfma_f32_16x16x32_bf16 v[204:207], a[236:239], a[60:63], v[204:207]
s_waitcnt lgkmcnt(3)
v_exp_f32 v243, v243
v_mfma_f32_16x16x32_bf16 v[192:195], a[240:243], a[64:67], v[192:195]
ds_read_b128 a[232:235], v248 offset:57344
v_fma_f32 v240, v240, s35, s35
v_mfma_f32_16x16x32_bf16 v[192:195], a[244:247], a[80:83], v[192:195]
v_fma_f32 v241, v241, s35, s35
v_fma_f32 v242, v242, s35, s35
v_mfma_f32_16x16x32_bf16 v[196:199], a[240:243], a[68:71], v[196:199]
ds_read_b128 a[236:239], v248 offset:58368
v_fma_f32 v243, v243, s35, s35
v_mfma_f32_16x16x32_bf16 v[196:199], a[244:247], a[84:87], v[196:199]
v_rcp_f32 v240, v240
v_mfma_f32_16x16x32_bf16 v[200:203], a[240:243], a[72:75], v[200:203]
v_rcp_f32 v241, v241
v_mfma_f32_16x16x32_bf16 v[200:203], a[244:247], a[88:91], v[200:203]
buffer_load_dwordx4 v252, s[8:11], s24 offen offset:2048 lds
v_mfma_f32_16x16x32_bf16 v[204:207], a[240:243], a[76:79], v[204:207]
v_rcp_f32 v242, v242
v_mfma_f32_16x16x32_bf16 v[204:207], a[244:247], a[92:95], v[204:207]
s_waitcnt lgkmcnt(2)
v_rcp_f32 v243, v243
v_mfma_f32_16x16x32_bf16 v[192:195], a[224:227], a[96:99], v[192:195]
ds_read_b128 a[240:243], v248 offset:59392
v_mul_f32 v240, v216, v240
v_mfma_f32_16x16x32_bf16 v[192:195], a[228:231], a[112:115], v[192:195]
v_mul_f32 v241, v217, v241
v_mul_f32 v242, v218, v242
v_mfma_f32_16x16x32_bf16 v[196:199], a[224:227], a[100:103], v[196:199]
ds_read_b128 a[244:247], v248 offset:60416
v_mul_f32 v243, v219, v243
v_mfma_f32_16x16x32_bf16 v[196:199], a[228:231], a[116:119], v[196:199]
v_cvt_pk_bf16_f32 v234, v240, v241
v_cvt_pk_bf16_f32 v235, v242, v243
v_mfma_f32_16x16x32_bf16 v[200:203], a[224:227], a[104:107], v[200:203]
ds_write_b128 v250, v[232:235] offset:2048
v_mfma_f32_16x16x32_bf16 v[200:203], a[228:231], a[120:123], v[200:203]
buffer_load_dwordx4 v252, s[8:11], s24 offen offset:3072 lds
v_mfma_f32_16x16x32_bf16 v[204:207], a[224:227], a[108:111], v[204:207]
v_fma_f32 v244, v220, v220, s27
v_fma_f32 v245, v221, v221, s27
v_mfma_f32_16x16x32_bf16 v[204:207], a[228:231], a[124:127], v[204:207]
s_waitcnt lgkmcnt(3)
v_fma_f32 v246, v222, v222, s27
v_fma_f32 v247, v223, v223, s27
v_mfma_f32_16x16x32_bf16 v[192:195], a[232:235], a[128:131], v[192:195]
ds_read_b128 a[224:227], v249 offset:0
v_mul_f32_e64 v244, -v220, v244
v_mfma_f32_16x16x32_bf16 v[192:195], a[236:239], a[144:147], v[192:195]
v_mul_f32_e64 v245, -v221, v245
v_mul_f32_e64 v246, -v222, v246
v_mfma_f32_16x16x32_bf16 v[196:199], a[232:235], a[132:135], v[196:199]
ds_read_b128 a[228:231], v249 offset:1024
v_mul_f32_e64 v247, -v223, v247
v_mfma_f32_16x16x32_bf16 v[196:199], a[236:239], a[148:151], v[196:199]
v_exp_f32 v244, v244
v_mfma_f32_16x16x32_bf16 v[200:203], a[232:235], a[136:139], v[200:203]
s_add_u32 m0, s26, 0x1000
v_exp_f32 v245, v245
v_mfma_f32_16x16x32_bf16 v[200:203], a[236:239], a[152:155], v[200:203]
buffer_load_dwordx4 v252, s[8:11], s25 offen offset:0 lds
v_mfma_f32_16x16x32_bf16 v[204:207], a[232:235], a[140:143], v[204:207]
v_exp_f32 v246, v246
v_mfma_f32_16x16x32_bf16 v[204:207], a[236:239], a[156:159], v[204:207]
s_waitcnt lgkmcnt(3)
v_exp_f32 v247, v247
v_mfma_f32_16x16x32_bf16 v[192:195], a[240:243], a[160:163], v[192:195]
ds_read_b128 a[232:235], v249 offset:2048
v_fma_f32 v244, v244, s35, s35
v_mfma_f32_16x16x32_bf16 v[192:195], a[244:247], a[176:179], v[192:195]
v_fma_f32 v245, v245, s35, s35
v_fma_f32 v246, v246, s35, s35
v_mfma_f32_16x16x32_bf16 v[196:199], a[240:243], a[164:167], v[196:199]
ds_read_b128 a[236:239], v249 offset:3072
v_fma_f32 v247, v247, s35, s35
v_mfma_f32_16x16x32_bf16 v[196:199], a[244:247], a[180:183], v[196:199]
v_rcp_f32 v244, v244
v_mfma_f32_16x16x32_bf16 v[200:203], a[240:243], a[168:171], v[200:203]
v_rcp_f32 v245, v245
v_mfma_f32_16x16x32_bf16 v[200:203], a[244:247], a[184:187], v[200:203]
buffer_load_dwordx4 v252, s[8:11], s25 offen offset:1024 lds
v_mfma_f32_16x16x32_bf16 v[204:207], a[240:243], a[172:175], v[204:207]
v_rcp_f32 v246, v246
v_mfma_f32_16x16x32_bf16 v[204:207], a[244:247], a[188:191], v[204:207]
s_waitcnt lgkmcnt(2)
v_rcp_f32 v247, v247
v_mfma_f32_16x16x32_bf16 v[208:211], a[224:227], a[0:3], 0
ds_read_b128 a[240:243], v249 offset:4096
v_mul_f32 v244, v220, v244
v_mfma_f32_16x16x32_bf16 v[208:211], a[228:231], a[16:19], v[208:211]
s_add_u32 s24, s24, 24576
v_mul_f32 v245, v221, v245
v_mul_f32 v246, v222, v246
v_mfma_f32_16x16x32_bf16 v[212:215], a[224:227], a[4:7], 0
s_add_u32 s25, s25, 24576
ds_read_b128 a[244:247], v249 offset:5120
v_mul_f32 v247, v223, v247
v_mfma_f32_16x16x32_bf16 v[212:215], a[228:231], a[20:23], v[212:215]
v_cvt_pk_bf16_f32 v238, v244, v245
v_cvt_pk_bf16_f32 v239, v246, v247
v_mfma_f32_16x16x32_bf16 v[216:219], a[224:227], a[8:11], 0
ds_write_b128 v250, v[236:239] offset:3072
v_mfma_f32_16x16x32_bf16 v[216:219], a[228:231], a[24:27], v[216:219]
v_fma_f32 v240, v192, v192, s27
v_fma_f32 v241, v193, v193, s27
v_mfma_f32_16x16x32_bf16 v[220:223], a[224:227], a[12:15], 0
v_fma_f32 v242, v194, v194, s27
v_fma_f32 v243, v195, v195, s27
v_mfma_f32_16x16x32_bf16 v[220:223], a[228:231], a[28:31], v[220:223]
s_waitcnt lgkmcnt(3)
v_mul_f32_e64 v240, -v192, v240
v_mul_f32_e64 v241, -v193, v241
v_mfma_f32_16x16x32_bf16 v[208:211], a[232:235], a[32:35], v[208:211]
ds_read_b128 a[224:227], v249 offset:6144
v_mul_f32_e64 v242, -v194, v242
v_mfma_f32_16x16x32_bf16 v[208:211], a[236:239], a[48:51], v[208:211]
v_mul_f32_e64 v243, -v195, v243
v_fma_f32 v244, v196, v196, s27
v_mfma_f32_16x16x32_bf16 v[212:215], a[232:235], a[36:39], v[212:215]
ds_read_b128 a[228:231], v249 offset:7168
v_fma_f32 v245, v197, v197, s27
v_mfma_f32_16x16x32_bf16 v[212:215], a[236:239], a[52:55], v[212:215]
v_exp_f32 v240, v240
v_mfma_f32_16x16x32_bf16 v[216:219], a[232:235], a[40:43], v[216:219]
v_exp_f32 v241, v241
v_mfma_f32_16x16x32_bf16 v[216:219], a[236:239], a[56:59], v[216:219]
v_exp_f32 v242, v242
v_mfma_f32_16x16x32_bf16 v[220:223], a[232:235], a[44:47], v[220:223]
v_exp_f32 v243, v243
v_mfma_f32_16x16x32_bf16 v[220:223], a[236:239], a[60:63], v[220:223]
s_waitcnt lgkmcnt(3)
v_fma_f32 v240, v240, s35, s35
v_fma_f32 v241, v241, s35, s35
v_mfma_f32_16x16x32_bf16 v[208:211], a[240:243], a[64:67], v[208:211]
ds_read_b128 a[232:235], v249 offset:8192
v_fma_f32 v242, v242, s35, s35
v_mfma_f32_16x16x32_bf16 v[208:211], a[244:247], a[80:83], v[208:211]
v_fma_f32 v243, v243, s35, s35
v_fma_f32 v246, v198, v198, s27
v_mfma_f32_16x16x32_bf16 v[212:215], a[240:243], a[68:71], v[212:215]
ds_read_b128 a[236:239], v249 offset:9216
v_fma_f32 v247, v199, v199, s27
v_mfma_f32_16x16x32_bf16 v[212:215], a[244:247], a[84:87], v[212:215]
v_rcp_f32 v240, v240
v_mfma_f32_16x16x32_bf16 v[216:219], a[240:243], a[72:75], v[216:219]
v_rcp_f32 v241, v241
v_mfma_f32_16x16x32_bf16 v[216:219], a[244:247], a[88:91], v[216:219]
v_rcp_f32 v242, v242
v_mfma_f32_16x16x32_bf16 v[220:223], a[240:243], a[76:79], v[220:223]
v_rcp_f32 v243, v243
v_mfma_f32_16x16x32_bf16 v[220:223], a[244:247], a[92:95], v[220:223]
s_waitcnt vmcnt(6) lgkmcnt(2)
s_barrier
v_mul_f32 v240, v192, v240
v_mul_f32 v241, v193, v241
v_mfma_f32_16x16x32_bf16 v[208:211], a[224:227], a[96:99], v[208:211]
s_add_u32 m0, s26, 0x6000
ds_read_b128 a[240:243], v249 offset:10240
v_mul_f32 v242, v194, v242
v_mfma_f32_16x16x32_bf16 v[208:211], a[228:231], a[112:115], v[208:211]
buffer_load_dwordx4 v252, s[8:11], s24 offen offset:0 lds
v_mfma_f32_16x16x32_bf16 v[212:215], a[224:227], a[100:103], v[212:215]
ds_read_b128 a[244:247], v249 offset:11264
v_mul_f32 v243, v195, v243
v_mfma_f32_16x16x32_bf16 v[212:215], a[228:231], a[116:119], v[212:215]
buffer_load_dwordx4 v252, s[8:11], s24 offen offset:1024 lds
v_mfma_f32_16x16x32_bf16 v[216:219], a[224:227], a[104:107], v[216:219]
ds_read_b128 a[192:195], v251 offset:0
v_cvt_pk_bf16_f32 v224, v240, v241
v_mfma_f32_16x16x32_bf16 v[216:219], a[228:231], a[120:123], v[216:219]
ds_read_b128 a[196:199], v251 offset:1024
v_cvt_pk_bf16_f32 v225, v242, v243
v_mfma_f32_16x16x32_bf16 v[220:223], a[224:227], a[108:111], v[220:223]
buffer_load_dwordx4 v252, s[8:11], s24 offen offset:2048 lds
v_mfma_f32_16x16x32_bf16 v[220:223], a[228:231], a[124:127], v[220:223]
s_waitcnt lgkmcnt(4)
v_mul_f32_e64 v244, -v196, v244
v_mul_f32_e64 v245, -v197, v245
v_mfma_f32_16x16x32_bf16 v[208:211], a[232:235], a[128:131], v[208:211]
ds_read_b128 a[224:227], v249 offset:24576
v_mul_f32_e64 v246, -v198, v246
v_mfma_f32_16x16x32_bf16 v[208:211], a[236:239], a[144:147], v[208:211]
ds_read_b128 a[200:203], v251 offset:2048
v_mul_f32_e64 v247, -v199, v247
v_mfma_f32_16x16x32_bf16 v[212:215], a[232:235], a[132:135], v[212:215]
ds_read_b128 a[228:231], v249 offset:25600
v_fma_f32 v240, v200, v200, s27
v_mfma_f32_16x16x32_bf16 v[212:215], a[236:239], a[148:151], v[212:215]
v_exp_f32 v244, v244
v_mfma_f32_16x16x32_bf16 v[216:219], a[232:235], a[136:139], v[216:219]
ds_read_b128 a[204:207], v251 offset:3072
v_fma_f32 v244, v244, s35, s35
v_mfma_f32_16x16x32_bf16 v[216:219], a[236:239], a[152:155], v[216:219]
ds_read_b128 a[208:211], v251 offset:4096
v_fma_f32 v241, v201, v201, s27
v_mfma_f32_16x16x32_bf16 v[220:223], a[232:235], a[140:143], v[220:223]
buffer_load_dwordx4 v252, s[8:11], s24 offen offset:3072 lds
v_mfma_f32_16x16x32_bf16 v[220:223], a[236:239], a[156:159], v[220:223]
s_waitcnt lgkmcnt(7)
v_exp_f32 v245, v245
v_mfma_f32_16x16x32_bf16 v[208:211], a[240:243], a[160:163], v[208:211]
ds_read_b128 a[232:235], v249 offset:26624
v_fma_f32 v245, v245, s35, s35
v_mfma_f32_16x16x32_bf16 v[208:211], a[244:247], a[176:179], v[208:211]
ds_read_b128 a[212:215], v251 offset:5120
v_fma_f32 v242, v202, v202, s27
v_mfma_f32_16x16x32_bf16 v[212:215], a[240:243], a[164:167], v[212:215]
s_add_u32 m0, s26, 0x7000
ds_read_b128 a[236:239], v249 offset:27648
v_fma_f32 v243, v203, v203, s27
v_mfma_f32_16x16x32_bf16 v[212:215], a[244:247], a[180:183], v[212:215]
buffer_load_dwordx4 v252, s[8:11], s25 offen offset:0 lds
v_mfma_f32_16x16x32_bf16 v[216:219], a[240:243], a[168:171], v[216:219]
ds_read_b128 a[216:219], v251 offset:6144
v_mul_f32_e64 v240, -v200, v240
v_mfma_f32_16x16x32_bf16 v[216:219], a[244:247], a[184:187], v[216:219]
ds_read_b128 a[220:223], v251 offset:7168
v_mul_f32_e64 v241, -v201, v241
v_mfma_f32_16x16x32_bf16 v[220:223], a[240:243], a[172:175], v[220:223]
buffer_load_dwordx4 v252, s[8:11], s25 offen offset:1024 lds
v_mfma_f32_16x16x32_bf16 v[220:223], a[244:247], a[188:191], v[220:223]
s_waitcnt lgkmcnt(0)
v_exp_f32 v246, v246
v_mfma_f32_16x16x32_bf16 v[0:3], a[224:227], a[192:195], v[0:3]
ds_read_b128 a[240:243], v249 offset:28672
v_fma_f32 v246, v246, s35, s35
v_mfma_f32_16x16x32_bf16 v[0:3], a[228:231], a[208:211], v[0:3]
s_add_u32 s24, s24, 24576
v_exp_f32 v247, v247
v_mfma_f32_16x16x32_bf16 v[4:7], a[224:227], a[196:199], v[4:7]
s_add_u32 s25, s25, 24576
ds_read_b128 a[244:247], v249 offset:29696
v_fma_f32 v247, v247, s35, s35
v_mfma_f32_16x16x32_bf16 v[4:7], a[228:231], a[212:215], v[4:7]
v_rcp_f32 v244, v244
v_mfma_f32_16x16x32_bf16 v[8:11], a[224:227], a[200:203], v[8:11]
s_add_u32 m0, s26, 0xc000
v_rcp_f32 v245, v245
v_mfma_f32_16x16x32_bf16 v[8:11], a[228:231], a[216:219], v[8:11]
buffer_load_dwordx4 v252, s[8:11], s24 offen offset:0 lds
v_mfma_f32_16x16x32_bf16 v[12:15], a[224:227], a[204:207], v[12:15]
v_rcp_f32 v246, v246
v_mfma_f32_16x16x32_bf16 v[12:15], a[228:231], a[220:223], v[12:15]
v_rcp_f32 v247, v247
v_mfma_f32_16x16x32_bf16 v[16:19], a[232:235], a[192:195], v[16:19]
ds_read_b128 a[224:227], v249 offset:30720
v_mul_f32 v244, v196, v244
v_mfma_f32_16x16x32_bf16 v[16:19], a[236:239], a[208:211], v[16:19]
v_mul_f32 v245, v197, v245
v_mul_f32 v246, v198, v246
v_mfma_f32_16x16x32_bf16 v[20:23], a[232:235], a[196:199], v[20:23]
ds_read_b128 a[228:231], v249 offset:31744
v_mul_f32 v247, v199, v247
v_mfma_f32_16x16x32_bf16 v[20:23], a[236:239], a[212:215], v[20:23]
v_cvt_pk_bf16_f32 v228, v244, v245
v_cvt_pk_bf16_f32 v229, v246, v247
v_mfma_f32_16x16x32_bf16 v[24:27], a[232:235], a[200:203], v[24:27]
v_mul_f32_e64 v242, -v202, v242
v_mul_f32_e64 v243, -v203, v243
v_mfma_f32_16x16x32_bf16 v[24:27], a[236:239], a[216:219], v[24:27]
buffer_load_dwordx4 v252, s[8:11], s24 offen offset:1024 lds
v_mfma_f32_16x16x32_bf16 v[28:31], a[232:235], a[204:207], v[28:31]
v_exp_f32 v240, v240
v_mfma_f32_16x16x32_bf16 v[28:31], a[236:239], a[220:223], v[28:31]
s_waitcnt lgkmcnt(2)
v_exp_f32 v241, v241
v_mfma_f32_16x16x32_bf16 v[32:35], a[240:243], a[192:195], v[32:35]
ds_read_b128 a[232:235], v249 offset:32768
v_fma_f32 v240, v240, s35, s35
v_mfma_f32_16x16x32_bf16 v[32:35], a[244:247], a[208:211], v[32:35]
v_exp_f32 v242, v242
v_mfma_f32_16x16x32_bf16 v[36:39], a[240:243], a[196:199], v[36:39]
ds_read_b128 a[236:239], v249 offset:33792
v_fma_f32 v241, v241, s35, s35
v_mfma_f32_16x16x32_bf16 v[36:39], a[244:247], a[212:215], v[36:39]
v_exp_f32 v243, v243
v_mfma_f32_16x16x32_bf16 v[40:43], a[240:243], a[200:203], v[40:43]
v_fma_f32 v242, v242, s35, s35
v_fma_f32 v243, v243, s35, s35
v_mfma_f32_16x16x32_bf16 v[40:43], a[244:247], a[216:219], v[40:43]
buffer_load_dwordx4 v252, s[8:11], s24 offen offset:2048 lds
v_mfma_f32_16x16x32_bf16 v[44:47], a[240:243], a[204:207], v[44:47]
v_rcp_f32 v240, v240
v_mfma_f32_16x16x32_bf16 v[44:47], a[244:247], a[220:223], v[44:47]
s_waitcnt lgkmcnt(2)
v_rcp_f32 v241, v241
v_mfma_f32_16x16x32_bf16 v[48:51], a[224:227], a[192:195], v[48:51]
ds_read_b128 a[240:243], v249 offset:34816
v_mul_f32 v240, v200, v240
v_mfma_f32_16x16x32_bf16 v[48:51], a[228:231], a[208:211], v[48:51]
v_rcp_f32 v242, v242
v_mfma_f32_16x16x32_bf16 v[52:55], a[224:227], a[196:199], v[52:55]
ds_read_b128 a[244:247], v249 offset:35840
v_mul_f32 v241, v201, v241
v_mfma_f32_16x16x32_bf16 v[52:55], a[228:231], a[212:215], v[52:55]
v_rcp_f32 v243, v243
v_mfma_f32_16x16x32_bf16 v[56:59], a[224:227], a[200:203], v[56:59]
v_mul_f32 v242, v202, v242
v_mul_f32 v243, v203, v243
v_mfma_f32_16x16x32_bf16 v[56:59], a[228:231], a[216:219], v[56:59]
buffer_load_dwordx4 v252, s[8:11], s24 offen offset:3072 lds
v_mfma_f32_16x16x32_bf16 v[60:63], a[224:227], a[204:207], v[60:63]
v_cvt_pk_bf16_f32 v232, v240, v241
v_cvt_pk_bf16_f32 v233, v242, v243
v_mfma_f32_16x16x32_bf16 v[60:63], a[228:231], a[220:223], v[60:63]
s_waitcnt lgkmcnt(2)
v_fma_f32 v244, v204, v204, s27
v_fma_f32 v245, v205, v205, s27
v_mfma_f32_16x16x32_bf16 v[64:67], a[232:235], a[192:195], v[64:67]
ds_read_b128 a[224:227], v249 offset:49152
v_fma_f32 v246, v206, v206, s27
v_mfma_f32_16x16x32_bf16 v[64:67], a[236:239], a[208:211], v[64:67]
v_fma_f32 v247, v207, v207, s27
v_mul_f32_e64 v244, -v204, v244
v_mfma_f32_16x16x32_bf16 v[68:71], a[232:235], a[196:199], v[68:71]
ds_read_b128 a[228:231], v249 offset:50176
v_mul_f32_e64 v245, -v205, v245
v_mfma_f32_16x16x32_bf16 v[68:71], a[236:239], a[212:215], v[68:71]
v_mul_f32_e64 v246, -v206, v246
v_mul_f32_e64 v247, -v207, v247
v_mfma_f32_16x16x32_bf16 v[72:75], a[232:235], a[200:203], v[72:75]
s_add_u32 m0, s26, 0xd000
v_exp_f32 v244, v244
v_mfma_f32_16x16x32_bf16 v[72:75], a[236:239], a[216:219], v[72:75]
buffer_load_dwordx4 v252, s[8:11], s25 offen offset:0 lds
v_mfma_f32_16x16x32_bf16 v[76:79], a[232:235], a[204:207], v[76:79]
v_exp_f32 v245, v245
v_mfma_f32_16x16x32_bf16 v[76:79], a[236:239], a[220:223], v[76:79]
s_waitcnt lgkmcnt(2)
v_exp_f32 v246, v246
v_mfma_f32_16x16x32_bf16 v[80:83], a[240:243], a[192:195], v[80:83]
ds_read_b128 a[232:235], v249 offset:51200
v_fma_f32 v244, v244, s35, s35
v_mfma_f32_16x16x32_bf16 v[80:83], a[244:247], a[208:211], v[80:83]
v_exp_f32 v247, v247
v_mfma_f32_16x16x32_bf16 v[84:87], a[240:243], a[196:199], v[84:87]
ds_read_b128 a[236:239], v249 offset:52224
v_fma_f32 v245, v245, s35, s35
v_mfma_f32_16x16x32_bf16 v[84:87], a[244:247], a[212:215], v[84:87]
v_fma_f32 v246, v246, s35, s35
v_fma_f32 v247, v247, s35, s35
v_mfma_f32_16x16x32_bf16 v[88:91], a[240:243], a[200:203], v[88:91]
v_rcp_f32 v244, v244
v_mfma_f32_16x16x32_bf16 v[88:91], a[244:247], a[216:219], v[88:91]
buffer_load_dwordx4 v252, s[8:11], s25 offen offset:1024 lds
v_mfma_f32_16x16x32_bf16 v[92:95], a[240:243], a[204:207], v[92:95]
v_rcp_f32 v245, v245
v_mfma_f32_16x16x32_bf16 v[92:95], a[244:247], a[220:223], v[92:95]
s_waitcnt lgkmcnt(2)
v_rcp_f32 v246, v246
v_mfma_f32_16x16x32_bf16 v[96:99], a[224:227], a[192:195], v[96:99]
ds_read_b128 a[240:243], v249 offset:53248
v_mul_f32 v244, v204, v244
v_mfma_f32_16x16x32_bf16 v[96:99], a[228:231], a[208:211], v[96:99]
s_add_u32 s24, s24, 24576
v_rcp_f32 v247, v247
v_mfma_f32_16x16x32_bf16 v[100:103], a[224:227], a[196:199], v[100:103]
s_add_u32 s25, s25, 24576
ds_read_b128 a[244:247], v249 offset:54272
v_mul_f32 v245, v205, v245
v_mfma_f32_16x16x32_bf16 v[100:103], a[228:231], a[212:215], v[100:103]
v_mul_f32 v246, v206, v246
v_mul_f32 v247, v207, v247
v_mfma_f32_16x16x32_bf16 v[104:107], a[224:227], a[200:203], v[104:107]
v_cvt_pk_bf16_f32 v236, v244, v245
v_cvt_pk_bf16_f32 v237, v246, v247
v_mfma_f32_16x16x32_bf16 v[104:107], a[228:231], a[216:219], v[104:107]
v_fma_f32 v240, v208, v208, s27
v_fma_f32 v241, v209, v209, s27
v_mfma_f32_16x16x32_bf16 v[108:111], a[224:227], a[204:207], v[108:111]
v_fma_f32 v242, v210, v210, s27
v_fma_f32 v243, v211, v211, s27
v_mfma_f32_16x16x32_bf16 v[108:111], a[228:231], a[220:223], v[108:111]
s_waitcnt lgkmcnt(2)
v_mul_f32_e64 v240, -v208, v240
v_mul_f32_e64 v241, -v209, v241
v_mfma_f32_16x16x32_bf16 v[112:115], a[232:235], a[192:195], v[112:115]
ds_read_b128 a[224:227], v249 offset:55296
v_mul_f32_e64 v242, -v210, v242
v_mfma_f32_16x16x32_bf16 v[112:115], a[236:239], a[208:211], v[112:115]
v_mul_f32_e64 v243, -v211, v243
v_fma_f32 v244, v212, v212, s27
v_mfma_f32_16x16x32_bf16 v[116:119], a[232:235], a[196:199], v[116:119]
ds_read_b128 a[228:231], v249 offset:56320
v_fma_f32 v245, v213, v213, s27
v_mfma_f32_16x16x32_bf16 v[116:119], a[236:239], a[212:215], v[116:119]
v_exp_f32 v240, v240
v_mfma_f32_16x16x32_bf16 v[120:123], a[232:235], a[200:203], v[120:123]
v_exp_f32 v241, v241
v_mfma_f32_16x16x32_bf16 v[120:123], a[236:239], a[216:219], v[120:123]
v_exp_f32 v242, v242
v_mfma_f32_16x16x32_bf16 v[124:127], a[232:235], a[204:207], v[124:127]
v_exp_f32 v243, v243
v_mfma_f32_16x16x32_bf16 v[124:127], a[236:239], a[220:223], v[124:127]
s_waitcnt vmcnt(6) lgkmcnt(2)
s_barrier
v_fma_f32 v240, v240, s35, s35
v_fma_f32 v241, v241, s35, s35
v_mfma_f32_16x16x32_bf16 v[128:131], a[240:243], a[192:195], v[128:131]
ds_read_b128 a[232:235], v249 offset:57344
v_fma_f32 v242, v242, s35, s35
v_mfma_f32_16x16x32_bf16 v[128:131], a[244:247], a[208:211], v[128:131]
v_fma_f32 v243, v243, s35, s35
v_fma_f32 v246, v214, v214, s27
v_mfma_f32_16x16x32_bf16 v[132:135], a[240:243], a[196:199], v[132:135]
s_add_u32 m0, s26, 0x12000
ds_read_b128 a[236:239], v249 offset:58368
v_fma_f32 v247, v215, v215, s27
v_mfma_f32_16x16x32_bf16 v[132:135], a[244:247], a[212:215], v[132:135]
buffer_load_dwordx4 v252, s[8:11], s24 offen offset:0 lds
v_mfma_f32_16x16x32_bf16 v[136:139], a[240:243], a[200:203], v[136:139]
v_rcp_f32 v240, v240
v_mfma_f32_16x16x32_bf16 v[136:139], a[244:247], a[216:219], v[136:139]
v_rcp_f32 v241, v241
v_mfma_f32_16x16x32_bf16 v[140:143], a[240:243], a[204:207], v[140:143]
v_rcp_f32 v242, v242
v_mfma_f32_16x16x32_bf16 v[140:143], a[244:247], a[220:223], v[140:143]
s_waitcnt lgkmcnt(2)
v_rcp_f32 v243, v243
v_mfma_f32_16x16x32_bf16 v[144:147], a[224:227], a[192:195], v[144:147]
ds_read_b128 a[240:243], v249 offset:59392
v_mul_f32 v240, v208, v240
v_mfma_f32_16x16x32_bf16 v[144:147], a[228:231], a[208:211], v[144:147]
buffer_load_dwordx4 v252, s[8:11], s24 offen offset:1024 lds
v_mfma_f32_16x16x32_bf16 v[148:151], a[224:227], a[196:199], v[148:151]
ds_read_b128 a[244:247], v249 offset:60416
v_mul_f32 v241, v209, v241
v_mfma_f32_16x16x32_bf16 v[148:151], a[228:231], a[212:215], v[148:151]
v_mul_f32 v242, v210, v242
v_mul_f32 v243, v211, v243
v_mfma_f32_16x16x32_bf16 v[152:155], a[224:227], a[200:203], v[152:155]
v_cvt_pk_bf16_f32 v226, v240, v241
v_cvt_pk_bf16_f32 v227, v242, v243
v_mfma_f32_16x16x32_bf16 v[152:155], a[228:231], a[216:219], v[152:155]
ds_write_b128 v250, v[224:227] offset:0
v_mfma_f32_16x16x32_bf16 v[156:159], a[224:227], a[204:207], v[156:159]
buffer_load_dwordx4 v252, s[8:11], s24 offen offset:2048 lds
v_mfma_f32_16x16x32_bf16 v[156:159], a[228:231], a[220:223], v[156:159]
s_waitcnt lgkmcnt(3)
v_mul_f32_e64 v244, -v212, v244
v_mul_f32_e64 v245, -v213, v245
v_mfma_f32_16x16x32_bf16 v[160:163], a[232:235], a[192:195], v[160:163]
ds_read_b128 a[224:227], v248 offset:0
v_mul_f32_e64 v246, -v214, v246
v_mfma_f32_16x16x32_bf16 v[160:163], a[236:239], a[208:211], v[160:163]
v_mul_f32_e64 v247, -v215, v247
v_fma_f32 v240, v216, v216, s27
v_mfma_f32_16x16x32_bf16 v[164:167], a[232:235], a[196:199], v[164:167]
ds_read_b128 a[228:231], v248 offset:1024
v_fma_f32 v241, v217, v217, s27
v_mfma_f32_16x16x32_bf16 v[164:167], a[236:239], a[212:215], v[164:167]
buffer_load_dwordx4 v252, s[8:11], s24 offen offset:3072 lds
v_mfma_f32_16x16x32_bf16 v[168:171], a[232:235], a[200:203], v[168:171]
v_exp_f32 v244, v244
v_mfma_f32_16x16x32_bf16 v[168:171], a[236:239], a[216:219], v[168:171]
v_exp_f32 v245, v245
v_mfma_f32_16x16x32_bf16 v[172:175], a[232:235], a[204:207], v[172:175]
v_exp_f32 v246, v246
v_mfma_f32_16x16x32_bf16 v[172:175], a[236:239], a[220:223], v[172:175]
s_waitcnt lgkmcnt(3)
v_exp_f32 v247, v247
v_mfma_f32_16x16x32_bf16 v[176:179], a[240:243], a[192:195], v[176:179]
s_add_u32 m0, s26, 0x13000
ds_read_b128 a[232:235], v248 offset:2048
v_fma_f32 v244, v244, s35, s35
v_mfma_f32_16x16x32_bf16 v[176:179], a[244:247], a[208:211], v[176:179]
buffer_load_dwordx4 v252, s[8:11], s25 offen offset:0 lds
v_mfma_f32_16x16x32_bf16 v[180:183], a[240:243], a[196:199], v[180:183]
ds_read_b128 a[236:239], v248 offset:3072
v_fma_f32 v245, v245, s35, s35
v_mfma_f32_16x16x32_bf16 v[180:183], a[244:247], a[212:215], v[180:183]
v_fma_f32 v246, v246, s35, s35
v_fma_f32 v247, v247, s35, s35
v_mfma_f32_16x16x32_bf16 v[184:187], a[240:243], a[200:203], v[184:187]
v_rcp_f32 v244, v244
v_mfma_f32_16x16x32_bf16 v[184:187], a[244:247], a[216:219], v[184:187]
v_rcp_f32 v245, v245
v_mfma_f32_16x16x32_bf16 v[188:191], a[240:243], a[204:207], v[188:191]
buffer_load_dwordx4 v252, s[8:11], s25 offen offset:1024 lds
v_mfma_f32_16x16x32_bf16 v[188:191], a[244:247], a[220:223], v[188:191]
s_waitcnt lgkmcnt(2)
v_rcp_f32 v246, v246
s_sub_u32 s28, s28, 1
s_cmp_lg_u32 s28, 0
s_cbranch_scc1 L_loop
L_tail:
s_mov_b32 s96, 2376704
s_mov_b32 s97, 2380800
s_cmp_eq_u32 s32, 1
s_cbranch_scc1 L_last
v_mfma_f32_16x16x32_bf16 v[192:195], a[224:227], a[0:3], 0
ds_read_b128 a[240:243], v248 offset:4096
v_mul_f32 v244, v212, v244
v_mfma_f32_16x16x32_bf16 v[192:195], a[228:231], a[16:19], v[192:195]
s_add_u32 s24, s24, 24576
v_rcp_f32 v247, v247
v_mfma_f32_16x16x32_bf16 v[196:199], a[224:227], a[4:7], 0
s_add_u32 s25, s25, 24576
ds_read_b128 a[244:247], v248 offset:5120
v_mul_f32 v245, v213, v245
v_mfma_f32_16x16x32_bf16 v[196:199], a[228:231], a[20:23], v[196:199]
v_mul_f32 v246, v214, v246
v_mul_f32 v247, v215, v247
v_mfma_f32_16x16x32_bf16 v[200:203], a[224:227], a[8:11], 0
s_add_u32 m0, s26, 0x18000
v_cvt_pk_bf16_f32 v230, v244, v245
v_cvt_pk_bf16_f32 v231, v246, v247
v_mfma_f32_16x16x32_bf16 v[200:203], a[228:231], a[24:27], v[200:203]
buffer_load_dwordx4 v252, s[8:11], s24 offen offset:0 lds
v_mfma_f32_16x16x32_bf16 v[204:207], a[224:227], a[12:15], 0
ds_write_b128 v250, v[228:231] offset:1024
v_mfma_f32_16x16x32_bf16 v[204:207], a[228:231], a[28:31], v[204:207]
s_waitcnt lgkmcnt(3)
v_fma_f32 v242, v218, v218, s27
v_fma_f32 v243, v219, v219, s27
v_mfma_f32_16x16x32_bf16 v[192:195], a[232:235], a[32:35], v[192:195]
ds_read_b128 a[224:227], v248 offset:6144
v_mul_f32_e64 v240, -v216, v240
v_mfma_f32_16x16x32_bf16 v[192:195], a[236:239], a[48:51], v[192:195]
v_mul_f32_e64 v241, -v217, v241
v_mul_f32_e64 v242, -v218, v242
v_mfma_f32_16x16x32_bf16 v[196:199], a[232:235], a[36:39], v[196:199]
ds_read_b128 a[228:231], v248 offset:7168
v_mul_f32_e64 v243, -v219, v243
v_mfma_f32_16x16x32_bf16 v[196:199], a[236:239], a[52:55], v[196:199]
v_exp_f32 v240, v240
v_mfma_f32_16x16x32_bf16 v[200:203], a[232:235], a[40:43], v[200:203]
v_exp_f32 v241, v241
v_mfma_f32_16x16x32_bf16 v[200:203], a[236:239], a[56:59], v[200:203]
buffer_load_dwordx4 v252, s[8:11], s24 offen offset:1024 lds
v_mfma_f32_16x16x32_bf16 v[204:207], a[232:235], a[44:47], v[204:207]
v_exp_f32 v242, v242
v_mfma_f32_16x16x32_bf16 v[204:207], a[236:239], a[60:63], v[204:207]
s_waitcnt lgkmcnt(3)
v_exp_f32 v243, v243
v_mfma_f32_16x16x32_bf16 v[192:195], a[240:243], a[64:67], v[192:195]
ds_read_b128 a[232:235], v248 offset:8192
v_fma_f32 v240, v240, s35, s35
v_mfma_f32_16x16x32_bf16 v[192:195], a[244:247], a[80:83], v[192:195]
v_fma_f32 v241, v241, s35, s35
v_fma_f32 v242, v242, s35, s35
v_mfma_f32_16x16x32_bf16 v[196:199], a[240:243], a[68:71], v[196:199]
ds_read_b128 a[236:239], v248 offset:9216
v_fma_f32 v243, v243, s35, s35
v_mfma_f32_16x16x32_bf16 v[196:199], a[244:247], a[84:87], v[196:199]
v_rcp_f32 v240, v240
v_mfma_f32_16x16x32_bf16 v[200:203], a[240:243], a[72:75], v[200:203]
v_rcp_f32 v241, v241
v_mfma_f32_16x16x32_bf16 v[200:203], a[244:247], a[88:91], v[200:203]
buffer_load_dwordx4 v252, s[8:11], s24 offen offset:2048 lds
v_mfma_f32_16x16x32_bf16 v[204:207], a[240:243], a[76:79], v[204:207]
v_rcp_f32 v242, v242
v_mfma_f32_16x16x32_bf16 v[204:207], a[244:247], a[92:95], v[204:207]
s_waitcnt lgkmcnt(2)
v_rcp_f32 v243, v243
v_mfma_f32_16x16x32_bf16 v[192:195], a[224:227], a[96:99], v[192:195]
ds_read_b128 a[240:243], v248 offset:10240
v_mul_f32 v240, v216, v240
v_mfma_f32_16x16x32_bf16 v[192:195], a[228:231], a[112:115], v[192:195]
v_mul_f32 v241, v217, v241
v_mul_f32 v242, v218, v242
v_mfma_f32_16x16x32_bf16 v[196:199], a[224:227], a[100:103], v[196:199]
ds_read_b128 a[244:247], v248 offset:11264
v_mul_f32 v243, v219, v243
v_mfma_f32_16x16x32_bf16 v[196:199], a[228:231], a[116:119], v[196:199]
v_cvt_pk_bf16_f32 v234, v240, v241
v_cvt_pk_bf16_f32 v235, v242, v243
v_mfma_f32_16x16x32_bf16 v[200:203], a[224:227], a[104:107], v[200:203]
ds_write_b128 v250, v[232:235] offset:2048
v_mfma_f32_16x16x32_bf16 v[200:203], a[228:231], a[120:123], v[200:203]
buffer_load_dwordx4 v252, s[8:11], s24 offen offset:3072 lds
v_mfma_f32_16x16x32_bf16 v[204:207], a[224:227], a[108:111], v[204:207]
v_fma_f32 v244, v220, v220, s27
v_fma_f32 v245, v221, v221, s27
v_mfma_f32_16x16x32_bf16 v[204:207], a[228:231], a[124:127], v[204:207]
s_waitcnt lgkmcnt(3)
v_fma_f32 v246, v222, v222, s27
v_fma_f32 v247, v223, v223, s27
v_mfma_f32_16x16x32_bf16 v[192:195], a[232:235], a[128:131], v[192:195]
ds_read_b128 a[224:227], v248 offset:24576
v_mul_f32_e64 v244, -v220, v244
v_mfma_f32_16x16x32_bf16 v[192:195], a[236:239], a[144:147], v[192:195]
v_mul_f32_e64 v245, -v221, v245
v_mul_f32_e64 v246, -v222, v246
v_mfma_f32_16x16x32_bf16 v[196:199], a[232:235], a[132:135], v[196:199]
ds_read_b128 a[228:231], v248 offset:25600
v_mul_f32_e64 v247, -v223, v247
v_mfma_f32_16x16x32_bf16 v[196:199], a[236:239], a[148:151], v[196:199]
v_exp_f32 v244, v244
v_mfma_f32_16x16x32_bf16 v[200:203], a[232:235], a[136:139], v[200:203]
s_add_u32 m0, s26, 0x19000
v_exp_f32 v245, v245
v_mfma_f32_16x16x32_bf16 v[200:203], a[236:239], a[152:155], v[200:203]
buffer_load_dwordx4 v252, s[8:11], s25 offen offset:0 lds
v_mfma_f32_16x16x32_bf16 v[204:207], a[232:235], a[140:143], v[204:207]
v_exp_f32 v246, v246
v_mfma_f32_16x16x32_bf16 v[204:207], a[236:239], a[156:159], v[204:207]
s_waitcnt lgkmcnt(3)
v_exp_f32 v247, v247
v_mfma_f32_16x16x32_bf16 v[192:195], a[240:243], a[160:163], v[192:195]
ds_read_b128 a[232:235], v248 offset:26624
v_fma_f32 v244, v244, s35, s35
v_mfma_f32_16x16x32_bf16 v[192:195], a[244:247], a[176:179], v[192:195]
v_fma_f32 v245, v245, s35, s35
v_fma_f32 v246, v246, s35, s35
v_mfma_f32_16x16x32_bf16 v[196:199], a[240:243], a[164:167], v[196:199]
ds_read_b128 a[236:239], v248 offset:27648
v_fma_f32 v247, v247, s35, s35
v_mfma_f32_16x16x32_bf16 v[196:199], a[244:247], a[180:183], v[196:199]
v_rcp_f32 v244, v244
v_mfma_f32_16x16x32_bf16 v[200:203], a[240:243], a[168:171], v[200:203]
v_rcp_f32 v245, v245
v_mfma_f32_16x16x32_bf16 v[200:203], a[244:247], a[184:187], v[200:203]
buffer_load_dwordx4 v252, s[8:11], s25 offen offset:1024 lds
v_mfma_f32_16x16x32_bf16 v[204:207], a[240:243], a[172:175], v[204:207]
v_rcp_f32 v246, v246
v_mfma_f32_16x16x32_bf16 v[204:207], a[244:247], a[188:191], v[204:207]
s_waitcnt lgkmcnt(2)
v_rcp_f32 v247, v247
v_mfma_f32_16x16x32_bf16 v[208:211], a[224:227], a[0:3], 0
ds_read_b128 a[240:243], v248 offset:28672
v_mul_f32 v244, v220, v244
v_mfma_f32_16x16x32_bf16 v[208:211], a[228:231], a[16:19], v[208:211]
s_add_u32 s24, s24, 24576
v_mul_f32 v245, v221, v245
v_mul_f32 v246, v222, v246
v_mfma_f32_16x16x32_bf16 v[212:215], a[224:227], a[4:7], 0
s_add_u32 s25, s25, 24576
ds_read_b128 a[244:247], v248 offset:29696
v_mul_f32 v247, v223, v247
v_mfma_f32_16x16x32_bf16 v[212:215], a[228:231], a[20:23], v[212:215]
v_cvt_pk_bf16_f32 v238, v244, v245
v_cvt_pk_bf16_f32 v239, v246, v247
v_mfma_f32_16x16x32_bf16 v[216:219], a[224:227], a[8:11], 0
ds_write_b128 v250, v[236:239] offset:3072
v_mfma_f32_16x16x32_bf16 v[216:219], a[228:231], a[24:27], v[216:219]
v_fma_f32 v240, v192, v192, s27
v_fma_f32 v241, v193, v193, s27
v_mfma_f32_16x16x32_bf16 v[220:223], a[224:227], a[12:15], 0
v_fma_f32 v242, v194, v194, s27
v_fma_f32 v243, v195, v195, s27
v_mfma_f32_16x16x32_bf16 v[220:223], a[228:231], a[28:31], v[220:223]
s_waitcnt lgkmcnt(3)
v_mul_f32_e64 v240, -v192, v240
v_mul_f32_e64 v241, -v193, v241
v_mfma_f32_16x16x32_bf16 v[208:211], a[232:235], a[32:35], v[208:211]
ds_read_b128 a[224:227], v248 offset:30720
v_mul_f32_e64 v242, -v194, v242
v_mfma_f32_16x16x32_bf16 v[208:211], a[236:239], a[48:51], v[208:211]
v_mul_f32_e64 v243, -v195, v243
v_fma_f32 v244, v196, v196, s27
v_mfma_f32_16x16x32_bf16 v[212:215], a[232:235], a[36:39], v[212:215]
ds_read_b128 a[228:231], v248 offset:31744
v_fma_f32 v245, v197, v197, s27
v_mfma_f32_16x16x32_bf16 v[212:215], a[236:239], a[52:55], v[212:215]
v_exp_f32 v240, v240
v_mfma_f32_16x16x32_bf16 v[216:219], a[232:235], a[40:43], v[216:219]
v_exp_f32 v241, v241
v_mfma_f32_16x16x32_bf16 v[216:219], a[236:239], a[56:59], v[216:219]
v_exp_f32 v242, v242
v_mfma_f32_16x16x32_bf16 v[220:223], a[232:235], a[44:47], v[220:223]
v_exp_f32 v243, v243
v_mfma_f32_16x16x32_bf16 v[220:223], a[236:239], a[60:63], v[220:223]
s_waitcnt lgkmcnt(3)
v_fma_f32 v240, v240, s35, s35
v_fma_f32 v241, v241, s35, s35
v_mfma_f32_16x16x32_bf16 v[208:211], a[240:243], a[64:67], v[208:211]
ds_read_b128 a[232:235], v248 offset:32768
v_fma_f32 v242, v242, s35, s35
v_mfma_f32_16x16x32_bf16 v[208:211], a[244:247], a[80:83], v[208:211]
v_fma_f32 v243, v243, s35, s35
v_fma_f32 v246, v198, v198, s27
v_mfma_f32_16x16x32_bf16 v[212:215], a[240:243], a[68:71], v[212:215]
ds_read_b128 a[236:239], v248 offset:33792
v_fma_f32 v247, v199, v199, s27
v_mfma_f32_16x16x32_bf16 v[212:215], a[244:247], a[84:87], v[212:215]
v_rcp_f32 v240, v240
v_mfma_f32_16x16x32_bf16 v[216:219], a[240:243], a[72:75], v[216:219]
v_rcp_f32 v241, v241
v_mfma_f32_16x16x32_bf16 v[216:219], a[244:247], a[88:91], v[216:219]
v_rcp_f32 v242, v242
v_mfma_f32_16x16x32_bf16 v[220:223], a[240:243], a[76:79], v[220:223]
v_rcp_f32 v243, v243
v_mfma_f32_16x16x32_bf16 v[220:223], a[244:247], a[92:95], v[220:223]
s_waitcnt vmcnt(6) lgkmcnt(2)
s_barrier
v_mul_f32 v240, v192, v240
v_mul_f32 v241, v193, v241
v_mfma_f32_16x16x32_bf16 v[208:211], a[224:227], a[96:99], v[208:211]
s_add_u32 m0, s26, 0x1e000
ds_read_b128 a[240:243], v248 offset:34816
v_mul_f32 v242, v194, v242
v_mfma_f32_16x16x32_bf16 v[208:211], a[228:231], a[112:115], v[208:211]
buffer_load_dwordx4 v252, s[8:11], s24 offen offset:0 lds
v_mfma_f32_16x16x32_bf16 v[212:215], a[224:227], a[100:103], v[212:215]
ds_read_b128 a[244:247], v248 offset:35840
v_mul_f32 v243, v195, v243
v_mfma_f32_16x16x32_bf16 v[212:215], a[228:231], a[116:119], v[212:215]
buffer_load_dwordx4 v252, s[8:11], s24 offen offset:1024 lds
v_mfma_f32_16x16x32_bf16 v[216:219], a[224:227], a[104:107], v[216:219]
ds_read_b128 a[192:195], v251 offset:0
v_cvt_pk_bf16_f32 v224, v240, v241
v_mfma_f32_16x16x32_bf16 v[216:219], a[228:231], a[120:123], v[216:219]
ds_read_b128 a[196:199], v251 offset:1024
v_cvt_pk_bf16_f32 v225, v242, v243
v_mfma_f32_16x16x32_bf16 v[220:223], a[224:227], a[108:111], v[220:223]
buffer_load_dwordx4 v252, s[8:11], s24 offen offset:2048 lds
v_mfma_f32_16x16x32_bf16 v[220:223], a[228:231], a[124:127], v[220:223]
s_waitcnt lgkmcnt(4)
v_mul_f32_e64 v244, -v196, v244
v_mul_f32_e64 v245, -v197, v245
v_mfma_f32_16x16x32_bf16 v[208:211], a[232:235], a[128:131], v[208:211]
ds_read_b128 a[224:227], v248 offset:49152
v_mul_f32_e64 v246, -v198, v246
v_mfma_f32_16x16x32_bf16 v[208:211], a[236:239], a[144:147], v[208:211]
ds_read_b128 a[200:203], v251 offset:2048
v_mul_f32_e64 v247, -v199, v247
v_mfma_f32_16x16x32_bf16 v[212:215], a[232:235], a[132:135], v[212:215]
ds_read_b128 a[228:231], v248 offset:50176
v_fma_f32 v240, v200, v200, s27
v_mfma_f32_16x16x32_bf16 v[212:215], a[236:239], a[148:151], v[212:215]
v_exp_f32 v244, v244
v_mfma_f32_16x16x32_bf16 v[216:219], a[232:235], a[136:139], v[216:219]
ds_read_b128 a[204:207], v251 offset:3072
v_fma_f32 v244, v244, s35, s35
v_mfma_f32_16x16x32_bf16 v[216:219], a[236:239], a[152:155], v[216:219]
ds_read_b128 a[208:211], v251 offset:4096
v_fma_f32 v241, v201, v201, s27
v_mfma_f32_16x16x32_bf16 v[220:223], a[232:235], a[140:143], v[220:223]
buffer_load_dwordx4 v252, s[8:11], s24 offen offset:3072 lds
v_mfma_f32_16x16x32_bf16 v[220:223], a[236:239], a[156:159], v[220:223]
s_waitcnt lgkmcnt(7)
v_exp_f32 v245, v245
v_mfma_f32_16x16x32_bf16 v[208:211], a[240:243], a[160:163], v[208:211]
ds_read_b128 a[232:235], v248 offset:51200
v_fma_f32 v245, v245, s35, s35
v_mfma_f32_16x16x32_bf16 v[208:211], a[244:247], a[176:179], v[208:211]
ds_read_b128 a[212:215], v251 offset:5120
v_fma_f32 v242, v202, v202, s27
v_mfma_f32_16x16x32_bf16 v[212:215], a[240:243], a[164:167], v[212:215]
s_add_u32 m0, s26, 0x1f000
ds_read_b128 a[236:239], v248 offset:52224
v_fma_f32 v243, v203, v203, s27
v_mfma_f32_16x16x32_bf16 v[212:215], a[244:247], a[180:183], v[212:215]
buffer_load_dwordx4 v252, s[8:11], s25 offen offset:0 lds
v_mfma_f32_16x16x32_bf16 v[216:219], a[240:243], a[168:171], v[216:219]
ds_read_b128 a[216:219], v251 offset:6144
v_mul_f32_e64 v240, -v200, v240
v_mfma_f32_16x16x32_bf16 v[216:219], a[244:247], a[184:187], v[216:219]
ds_read_b128 a[220:223], v251 offset:7168
v_mul_f32_e64 v241, -v201, v241
v_mfma_f32_16x16x32_bf16 v[220:223], a[240:243], a[172:175], v[220:223]
buffer_load_dwordx4 v252, s[8:11], s25 offen offset:1024 lds
v_mfma_f32_16x16x32_bf16 v[220:223], a[244:247], a[188:191], v[220:223]
s_waitcnt lgkmcnt(0)
v_exp_f32 v246, v246
v_mfma_f32_16x16x32_bf16 v[0:3], a[224:227], a[192:195], v[0:3]
ds_read_b128 a[240:243], v248 offset:53248
v_fma_f32 v246, v246, s35, s35
v_mfma_f32_16x16x32_bf16 v[0:3], a[228:231], a[208:211], v[0:3]
buffer_load_dwordx4 a[0:3], v254, s[16:19], s60 offen offset:0
v_mfma_f32_16x16x32_bf16 v[4:7], a[224:227], a[196:199], v[4:7]
ds_read_b128 a[244:247], v248 offset:54272
v_mul_f32_e64 v242, -v202, v242
v_mfma_f32_16x16x32_bf16 v[4:7], a[228:231], a[212:215], v[4:7]
v_exp_f32 v247, v247
v_mfma_f32_16x16x32_bf16 v[8:11], a[224:227], a[200:203], v[8:11]
v_fma_f32 v247, v247, s35, s35
v_mul_f32_e64 v243, -v203, v243
v_mfma_f32_16x16x32_bf16 v[8:11], a[228:231], a[216:219], v[8:11]
v_rcp_f32 v244, v244
v_mfma_f32_16x16x32_bf16 v[12:15], a[224:227], a[204:207], v[12:15]
buffer_load_dwordx4 a[4:7], v254, s[16:19], s61 offen offset:0
v_mfma_f32_16x16x32_bf16 v[12:15], a[228:231], a[220:223], v[12:15]
v_rcp_f32 v245, v245
v_mfma_f32_16x16x32_bf16 v[16:19], a[232:235], a[192:195], v[16:19]
ds_read_b128 a[224:227], v248 offset:55296
v_mul_f32 v244, v196, v244
v_mfma_f32_16x16x32_bf16 v[16:19], a[236:239], a[208:211], v[16:19]
buffer_load_dwordx4 a[8:11], v254, s[16:19], s62 offen offset:0
v_mfma_f32_16x16x32_bf16 v[20:23], a[232:235], a[196:199], v[20:23]
ds_read_b128 a[228:231], v248 offset:56320
v_mul_f32 v245, v197, v245
v_mfma_f32_16x16x32_bf16 v[20:23], a[236:239], a[212:215], v[20:23]
v_rcp_f32 v246, v246
v_mfma_f32_16x16x32_bf16 v[24:27], a[232:235], a[200:203], v[24:27]
v_rcp_f32 v247, v247
v_mfma_f32_16x16x32_bf16 v[24:27], a[236:239], a[216:219], v[24:27]
v_mul_f32 v246, v198, v246
v_mul_f32 v247, v199, v247
v_mfma_f32_16x16x32_bf16 v[28:31], a[232:235], a[204:207], v[28:31]
buffer_load_dwordx4 a[12:15], v254, s[16:19], s63 offen offset:0
v_mfma_f32_16x16x32_bf16 v[28:31], a[236:239], a[220:223], v[28:31]
s_waitcnt lgkmcnt(2)
v_cvt_pk_bf16_f32 v228, v244, v245
v_cvt_pk_bf16_f32 v229, v246, v247
v_mfma_f32_16x16x32_bf16 v[32:35], a[240:243], a[192:195], v[32:35]
ds_read_b128 a[232:235], v248 offset:57344
v_fma_f32 v244, v204, v204, s27
v_exp_f32 v240, v240
v_exp_f32 v241, v241
v_exp_f32 v242, v242
v_exp_f32 v243, v243
v_mfma_f32_16x16x32_bf16 v[32:35], a[244:247], a[208:211], v[32:35]
buffer_load_dwordx4 a[16:19], v254, s[16:19], s64 offen offset:0
v_fma_f32 v240, v240, s35, s35
v_fma_f32 v241, v241, s35, s35
v_fma_f32 v242, v242, s35, s35
v_fma_f32 v243, v243, s35, s35
v_mfma_f32_16x16x32_bf16 v[36:39], a[240:243], a[196:199], v[36:39]
ds_read_b128 a[236:239], v248 offset:58368
v_fma_f32 v245, v205, v205, s27
v_rcp_f32 v240, v240
v_rcp_f32 v241, v241
v_rcp_f32 v242, v242
v_rcp_f32 v243, v243
v_mfma_f32_16x16x32_bf16 v[36:39], a[244:247], a[212:215], v[36:39]
v_mul_f32 v240, v200, v240
v_mul_f32 v241, v201, v241
v_mul_f32 v242, v202, v242
v_mul_f32 v243, v203, v243
v_mfma_f32_16x16x32_bf16 v[40:43], a[240:243], a[200:203], v[40:43]
v_cvt_pk_bf16_f32 v232, v240, v241
v_cvt_pk_bf16_f32 v233, v242, v243
v_fma_f32 v246, v206, v206, s27
v_fma_f32 v247, v207, v207, s27
v_mfma_f32_16x16x32_bf16 v[40:43], a[244:247], a[216:219], v[40:43]
v_mul_f32_e64 v244, -v204, v244
v_mul_f32_e64 v245, -v205, v245
v_mul_f32_e64 v246, -v206, v246
v_mul_f32_e64 v247, -v207, v247
v_mfma_f32_16x16x32_bf16 v[44:47], a[240:243], a[204:207], v[44:47]
buffer_load_dwordx4 a[20:23], v254, s[16:19], s65 offen offset:0
v_exp_f32 v244, v244
v_exp_f32 v245, v245
v_exp_f32 v246, v246
v_exp_f32 v247, v247
v_mfma_f32_16x16x32_bf16 v[44:47], a[244:247], a[220:223], v[44:47]
s_waitcnt lgkmcnt(2)
v_fma_f32 v244, v244, s35, s35
v_fma_f32 v245, v245, s35, s35
v_fma_f32 v246, v246, s35, s35
v_fma_f32 v247, v247, s35, s35
v_mfma_f32_16x16x32_bf16 v[48:51], a[224:227], a[192:195], v[48:51]
ds_read_b128 a[240:243], v248 offset:59392
v_fma_f32 v240, v208, v208, s27
v_rcp_f32 v244, v244
v_rcp_f32 v245, v245
v_rcp_f32 v246, v246
v_rcp_f32 v247, v247
v_mfma_f32_16x16x32_bf16 v[48:51], a[228:231], a[208:211], v[48:51]
buffer_load_dwordx4 a[24:27], v255, s[16:19], s66 offen offset:0
v_mul_f32 v244, v204, v244
v_mul_f32 v245, v205, v245
v_mul_f32 v246, v206, v246
v_mul_f32 v247, v207, v247
v_mfma_f32_16x16x32_bf16 v[52:55], a[224:227], a[196:199], v[52:55]
ds_read_b128 a[244:247], v248 offset:60416
v_cvt_pk_bf16_f32 v236, v244, v245
v_mfma_f32_16x16x32_bf16 v[52:55], a[228:231], a[212:215], v[52:55]
v_cvt_pk_bf16_f32 v237, v246, v247
v_fma_f32 v241, v209, v209, s27
v_mfma_f32_16x16x32_bf16 v[56:59], a[224:227], a[200:203], v[56:59]
v_fma_f32 v242, v210, v210, s27
v_fma_f32 v243, v211, v211, s27
v_mfma_f32_16x16x32_bf16 v[56:59], a[228:231], a[216:219], v[56:59]
v_mul_f32_e64 v240, -v208, v240
v_mul_f32_e64 v241, -v209, v241
v_mfma_f32_16x16x32_bf16 v[60:63], a[224:227], a[204:207], v[60:63]
buffer_load_dwordx4 a[28:31], v255, s[16:19], s67 offen offset:0
v_mfma_f32_16x16x32_bf16 v[60:63], a[228:231], a[220:223], v[60:63]
s_waitcnt lgkmcnt(2)
v_mul_f32_e64 v242, -v210, v242
v_mul_f32_e64 v243, -v211, v243
v_mfma_f32_16x16x32_bf16 v[64:67], a[232:235], a[192:195], v[64:67]
ds_read_b128 a[224:227], v249 offset:0
v_fma_f32 v244, v212, v212, s27
v_mfma_f32_16x16x32_bf16 v[64:67], a[236:239], a[208:211], v[64:67]
buffer_load_dwordx4 a[32:35], v254, s[16:19], s60 offen offset:128
v_mfma_f32_16x16x32_bf16 v[68:71], a[232:235], a[196:199], v[68:71]
ds_read_b128 a[228:231], v249 offset:1024
v_fma_f32 v245, v213, v213, s27
v_mfma_f32_16x16x32_bf16 v[68:71], a[236:239], a[212:215], v[68:71]
v_exp_f32 v240, v240
v_mfma_f32_16x16x32_bf16 v[72:75], a[232:235], a[200:203], v[72:75]
v_exp_f32 v241, v241
v_mfma_f32_16x16x32_bf16 v[72:75], a[236:239], a[216:219], v[72:75]
v_exp_f32 v242, v242
v_mfma_f32_16x16x32_bf16 v[76:79], a[232:235], a[204:207], v[76:79]
buffer_load_dwordx4 a[36:39], v254, s[16:19], s61 offen offset:128
v_mfma_f32_16x16x32_bf16 v[76:79], a[236:239], a[220:223], v[76:79]
s_waitcnt lgkmcnt(2)
v_exp_f32 v243, v243
v_mfma_f32_16x16x32_bf16 v[80:83], a[240:243], a[192:195], v[80:83]
ds_read_b128 a[232:235], v249 offset:2048
v_fma_f32 v240, v240, s35, s35
v_mfma_f32_16x16x32_bf16 v[80:83], a[244:247], a[208:211], v[80:83]
buffer_load_dwordx4 a[40:43], v254, s[16:19], s62 offen offset:128
v_mfma_f32_16x16x32_bf16 v[84:87], a[240:243], a[196:199], v[84:87]
ds_read_b128 a[236:239], v249 offset:3072
v_fma_f32 v241, v241, s35, s35
v_mfma_f32_16x16x32_bf16 v[84:87], a[244:247], a[212:215], v[84:87]
v_fma_f32 v242, v242, s35, s35
v_fma_f32 v243, v243, s35, s35
v_mfma_f32_16x16x32_bf16 v[88:91], a[240:243], a[200:203], v[88:91]
v_rcp_f32 v240, v240
v_mfma_f32_16x16x32_bf16 v[88:91], a[244:247], a[216:219], v[88:91]
v_rcp_f32 v241, v241
v_mfma_f32_16x16x32_bf16 v[92:95], a[240:243], a[204:207], v[92:95]
buffer_load_dwordx4 a[44:47], v254, s[16:19], s63 offen offset:128
v_mfma_f32_16x16x32_bf16 v[92:95], a[244:247], a[220:223], v[92:95]
s_waitcnt lgkmcnt(2)
v_rcp_f32 v242, v242
v_mfma_f32_16x16x32_bf16 v[96:99], a[224:227], a[192:195], v[96:99]
ds_read_b128 a[240:243], v249 offset:4096
v_mul_f32 v240, v208, v240
v_mfma_f32_16x16x32_bf16 v[96:99], a[228:231], a[208:211], v[96:99]
buffer_load_dwordx4 a[48:51], v254, s[16:19], s64 offen offset:128
v_mfma_f32_16x16x32_bf16 v[100:103], a[224:227], a[196:199], v[100:103]
ds_read_b128 a[244:247], v249 offset:5120
v_mul_f32 v241, v209, v241
v_mfma_f32_16x16x32_bf16 v[100:103], a[228:231], a[212:215], v[100:103]
v_rcp_f32 v243, v243
v_mfma_f32_16x16x32_bf16 v[104:107], a[224:227], a[200:203], v[104:107]
v_mul_f32 v242, v210, v242
v_mul_f32 v243, v211, v243
v_mfma_f32_16x16x32_bf16 v[104:107], a[228:231], a[216:219], v[104:107]
v_cvt_pk_bf16_f32 v226, v240, v241
v_cvt_pk_bf16_f32 v227, v242, v243
v_mfma_f32_16x16x32_bf16 v[108:111], a[224:227], a[204:207], v[108:111]
buffer_load_dwordx4 a[52:55], v254, s[16:19], s65 offen offset:128
v_mfma_f32_16x16x32_bf16 v[108:111], a[228:231], a[220:223], v[108:111]
s_waitcnt lgkmcnt(2)
v_fma_f32 v246, v214, v214, s27
v_fma_f32 v247, v215, v215, s27
v_mfma_f32_16x16x32_bf16 v[112:115], a[232:235], a[192:195], v[112:115]
ds_read_b128 a[224:227], v249 offset:6144
v_mul_f32_e64 v244, -v212, v244
v_mul_f32_e64 v245, -v213, v245
v_mul_f32_e64 v246, -v214, v246
v_mul_f32_e64 v247, -v215, v247
v_mfma_f32_16x16x32_bf16 v[112:115], a[236:239], a[208:211], v[112:115]
buffer_load_dwordx4 a[56:59], v255, s[16:19], s66 offen offset:128
v_exp_f32 v244, v244
v_exp_f32 v245, v245
v_exp_f32 v246, v246
v_exp_f32 v247, v247
v_mfma_f32_16x16x32_bf16 v[116:119], a[232:235], a[196:199], v[116:119]
ds_read_b128 a[228:231], v249 offset:7168
v_fma_f32 v244, v244, s35, s35
v_fma_f32 v245, v245, s35, s35
v_fma_f32 v246, v246, s35, s35
v_fma_f32 v247, v247, s35, s35
v_mfma_f32_16x16x32_bf16 v[116:119], a[236:239], a[212:215], v[116:119]
v_rcp_f32 v244, v244
v_rcp_f32 v245, v245
v_rcp_f32 v246, v246
v_rcp_f32 v247, v247
v_mfma_f32_16x16x32_bf16 v[120:123], a[232:235], a[200:203], v[120:123]
v_mul_f32 v244, v212, v244
v_mul_f32 v245, v213, v245
v_mul_f32 v246, v214, v246
v_mul_f32 v247, v215, v247
v_mfma_f32_16x16x32_bf16 v[120:123], a[236:239], a[216:219], v[120:123]
v_cvt_pk_bf16_f32 v230, v244, v245
v_cvt_pk_bf16_f32 v231, v246, v247
v_mfma_f32_16x16x32_bf16 v[124:127], a[232:235], a[204:207], v[124:127]
buffer_load_dwordx4 a[60:63], v255, s[16:19], s67 offen offset:128
v_fma_f32 v240, v216, v216, s27
v_fma_f32 v241, v217, v217, s27
v_fma_f32 v242, v218, v218, s27
v_fma_f32 v243, v219, v219, s27
v_mfma_f32_16x16x32_bf16 v[124:127], a[236:239], a[220:223], v[124:127]
s_waitcnt vmcnt(16) lgkmcnt(2)
s_barrier
v_mul_f32_e64 v240, -v216, v240
v_mul_f32_e64 v241, -v217, v241
v_mul_f32_e64 v242, -v218, v242
v_mul_f32_e64 v243, -v219, v243
v_mfma_f32_16x16x32_bf16 v[128:131], a[240:243], a[192:195], v[128:131]
ds_read_b128 a[232:235], v249 offset:8192
v_fma_f32 v244, v220, v220, s27
v_exp_f32 v240, v240
v_exp_f32 v241, v241
v_exp_f32 v242, v242
v_exp_f32 v243, v243
v_mfma_f32_16x16x32_bf16 v[128:131], a[244:247], a[208:211], v[128:131]
ds_write_b128 v250, v[224:227] offset:0
v_fma_f32 v240, v240, s35, s35
v_fma_f32 v241, v241, s35, s35
v_fma_f32 v242, v242, s35, s35
v_fma_f32 v243, v243, s35, s35
v_mfma_f32_16x16x32_bf16 v[132:135], a[240:243], a[196:199], v[132:135]
ds_read_b128 a[236:239], v249 offset:9216
v_fma_f32 v245, v221, v221, s27
v_rcp_f32 v240, v240
v_rcp_f32 v241, v241
v_rcp_f32 v242, v242
v_rcp_f32 v243, v243
v_mfma_f32_16x16x32_bf16 v[132:135], a[244:247], a[212:215], v[132:135]
ds_write_b128 v250, v[228:231] offset:1024
v_mul_f32 v240, v216, v240
v_mul_f32 v241, v217, v241
v_mul_f32 v242, v218, v242
v_mul_f32 v243, v219, v243
v_mfma_f32_16x16x32_bf16 v[136:139], a[240:243], a[200:203], v[136:139]
v_cvt_pk_bf16_f32 v234, v240, v241
v_cvt_pk_bf16_f32 v235, v242, v243
v_mfma_f32_16x16x32_bf16 v[136:139], a[244:247], a[216:219], v[136:139]
ds_write_b128 v250, v[232:235] offset:2048
v_fma_f32 v246, v222, v222, s27
v_fma_f32 v247, v223, v223, s27
v_mfma_f32_16x16x32_bf16 v[140:143], a[240:243], a[204:207], v[140:143]
v_mul_f32_e64 v244, -v220, v244
v_mul_f32_e64 v245, -v221, v245
v_mul_f32_e64 v246, -v222, v246
v_mul_f32_e64 v247, -v223, v247
v_mfma_f32_16x16x32_bf16 v[140:143], a[244:247], a[220:223], v[140:143]
s_waitcnt lgkmcnt(5)
v_exp_f32 v244, v244
v_exp_f32 v245, v245
v_exp_f32 v246, v246
v_exp_f32 v247, v247
v_mfma_f32_16x16x32_bf16 v[144:147], a[224:227], a[192:195], v[144:147]
ds_read_b128 a[240:243], v249 offset:10240
v_fma_f32 v244, v244, s35, s35
v_fma_f32 v245, v245, s35, s35
v_fma_f32 v246, v246, s35, s35
v_fma_f32 v247, v247, s35, s35
v_mfma_f32_16x16x32_bf16 v[144:147], a[228:231], a[208:211], v[144:147]
v_rcp_f32 v244, v244
v_rcp_f32 v245, v245
v_rcp_f32 v246, v246
v_rcp_f32 v247, v247
v_mfma_f32_16x16x32_bf16 v[148:151], a[224:227], a[196:199], v[148:151]
ds_read_b128 a[244:247], v249 offset:11264
v_mul_f32 v244, v220, v244
v_mul_f32 v245, v221, v245
v_mul_f32 v246, v222, v246
v_mul_f32 v247, v223, v247
v_mfma_f32_16x16x32_bf16 v[148:151], a[228:231], a[212:215], v[148:151]
v_cvt_pk_bf16_f32 v238, v244, v245
v_cvt_pk_bf16_f32 v239, v246, v247
v_mfma_f32_16x16x32_bf16 v[152:155], a[224:227], a[200:203], v[152:155]
ds_write_b128 v250, v[236:239] offset:3072
v_mfma_f32_16x16x32_bf16 v[152:155], a[228:231], a[216:219], v[152:155]
v_mfma_f32_16x16x32_bf16 v[156:159], a[224:227], a[204:207], v[156:159]
v_mfma_f32_16x16x32_bf16 v[156:159], a[228:231], a[220:223], v[156:159]
s_waitcnt lgkmcnt(5)
v_mfma_f32_16x16x32_bf16 v[160:163], a[232:235], a[192:195], v[160:163]
ds_read_b128 a[224:227], v249 offset:24576
v_mfma_f32_16x16x32_bf16 v[160:163], a[236:239], a[208:211], v[160:163]
v_mfma_f32_16x16x32_bf16 v[164:167], a[232:235], a[196:199], v[164:167]
ds_read_b128 a[228:231], v249 offset:25600
v_mfma_f32_16x16x32_bf16 v[164:167], a[236:239], a[212:215], v[164:167]
buffer_load_dwordx4 v[240:243], v252, s[8:11], s96 offen offset:0
v_mfma_f32_16x16x32_bf16 v[168:171], a[232:235], a[200:203], v[168:171]
buffer_load_dwordx4 v[244:247], v252, s[8:11], s96 offen offset:1024
v_mfma_f32_16x16x32_bf16 v[168:171], a[236:239], a[216:219], v[168:171]
buffer_load_dwordx4 v[236:239], v252, s[8:11], s96 offen offset:2048
v_mfma_f32_16x16x32_bf16 v[172:175], a[232:235], a[204:207], v[172:175]
buffer_load_dwordx4 v[212:215], v252, s[8:11], s97 offen offset:0
v_mfma_f32_16x16x32_bf16 v[172:175], a[236:239], a[220:223], v[172:175]
s_waitcnt lgkmcnt(2)
s_barrier
buffer_load_dword v216, v252, s[8:11], s96 offen offset:3080
v_mfma_f32_16x16x32_bf16 v[176:179], a[240:243], a[192:195], v[176:179]
ds_read_b128 a[232:235], v249 offset:26624
ds_read_b128 a[160:163], v251 offset:0
v_mfma_f32_16x16x32_bf16 v[176:179], a[244:247], a[208:211], v[176:179]
ds_read_b128 a[164:167], v251 offset:1024
v_mfma_f32_16x16x32_bf16 v[180:183], a[240:243], a[196:199], v[180:183]
ds_read_b128 a[236:239], v249 offset:27648
ds_read_b128 a[168:171], v251 offset:2048
v_mfma_f32_16x16x32_bf16 v[180:183], a[244:247], a[212:215], v[180:183]
ds_read_b128 a[172:175], v251 offset:3072
v_mfma_f32_16x16x32_bf16 v[184:187], a[240:243], a[200:203], v[184:187]
ds_read_b128 a[176:179], v251 offset:4096
v_mfma_f32_16x16x32_bf16 v[184:187], a[244:247], a[216:219], v[184:187]
ds_read_b128 a[180:183], v251 offset:5120
ds_read_b128 a[184:187], v251 offset:6144
v_mfma_f32_16x16x32_bf16 v[188:191], a[240:243], a[204:207], v[188:191]
ds_read_b128 a[188:191], v251 offset:7168
v_mfma_f32_16x16x32_bf16 v[188:191], a[244:247], a[220:223], v[188:191]
s_waitcnt lgkmcnt(0)
buffer_load_dword v253, v252, s[8:11], s96 offen offset:3072
v_mfma_f32_16x16x32_bf16 v[0:3], a[224:227], a[160:163], v[0:3]
ds_read_b128 a[240:243], v249 offset:28672
v_mfma_f32_16x16x32_bf16 v[0:3], a[228:231], a[176:179], v[0:3]
buffer_load_dword v251, v252, s[8:11], s96 offen offset:3076
v_mfma_f32_16x16x32_bf16 v[4:7], a[224:227], a[164:167], v[4:7]
ds_read_b128 a[244:247], v249 offset:29696
v_mfma_f32_16x16x32_bf16 v[4:7], a[228:231], a[180:183], v[4:7]
v_mfma_f32_16x16x32_bf16 v[8:11], a[224:227], a[168:171], v[8:11]
v_mfma_f32_16x16x32_bf16 v[8:11], a[228:231], a[184:187], v[8:11]
v_mfma_f32_16x16x32_bf16 v[12:15], a[224:227], a[172:175], v[12:15]
v_mfma_f32_16x16x32_bf16 v[12:15], a[228:231], a[188:191], v[12:15]
v_mfma_f32_16x16x32_bf16 v[16:19], a[232:235], a[160:163], v[16:19]
ds_read_b128 a[224:227], v249 offset:30720
v_mfma_f32_16x16x32_bf16 v[16:19], a[236:239], a[176:179], v[16:19]
v_mfma_f32_16x16x32_bf16 v[20:23], a[232:235], a[164:167], v[20:23]
ds_read_b128 a[228:231], v249 offset:31744
v_mfma_f32_16x16x32_bf16 v[20:23], a[236:239], a[180:183], v[20:23]
s_waitcnt vmcnt(0)
s_lshl_b32 s73, s29, 10
s_add_u32 m0, s73, 147456
s_mov_b32 s72, 0
s_mov_b64 exec, s[98:99]
buffer_load_dwordx4 v216, s[48:51], s72 offen lds
s_mov_b64 exec, -1
s_cmp_eq_u32 s29, 1
s_cbranch_scc0 L_noct0
s_mov_b32 s72, 2366464
s_mov_b32 exec_lo, 0
s_mov_b32 exec_hi, 0xff
buffer_load_dwordx4 v216, s[8:11], s72 offen lds
s_mov_b64 exec, -1
L_noct0:
v_mfma_f32_16x16x32_bf16 v[24:27], a[232:235], a[168:171], v[24:27]
v_mfma_f32_16x16x32_bf16 v[24:27], a[236:239], a[184:187], v[24:27]
s_lshl_b32 s73, s29, 10
s_add_u32 m0, s73, 151552
s_mov_b32 s72, 128
s_mov_b64 exec, s[98:99]
buffer_load_dwordx4 v216, s[48:51], s72 offen lds
s_mov_b64 exec, -1
s_cmp_eq_u32 s29, 1
s_cbranch_scc0 L_noct1
s_mov_b32 s72, 2366592
s_mov_b32 exec_lo, 0
s_mov_b32 exec_hi, 0xff
buffer_load_dwordx4 v216, s[8:11], s72 offen lds
s_mov_b64 exec, -1
L_noct1:
v_mfma_f32_16x16x32_bf16 v[28:31], a[232:235], a[172:175], v[28:31]
ds_write_b64 v245, a[0:1] offset:0
v_mfma_f32_16x16x32_bf16 v[28:31], a[236:239], a[188:191], v[28:31]
s_waitcnt lgkmcnt(3)
ds_write_b64 v245, a[2:3] offset:1936
v_mfma_f32_16x16x32_bf16 v[32:35], a[240:243], a[160:163], v[32:35]
ds_read_b128 a[232:235], v249 offset:32768
v_mfma_f32_16x16x32_bf16 v[32:35], a[244:247], a[176:179], v[32:35]
s_lshl_b32 s73, s29, 10
s_add_u32 m0, s73, 155648
s_mov_b32 s72, 256
s_mov_b64 exec, s[98:99]
buffer_load_dwordx4 v216, s[48:51], s72 offen lds
s_mov_b64 exec, -1
s_cmp_eq_u32 s29, 1
s_cbranch_scc0 L_noct2
s_mov_b32 s72, 2366720
s_mov_b32 exec_lo, 0
s_mov_b32 exec_hi, 0xff
buffer_load_dwordx4 v216, s[8:11], s72 offen lds
s_mov_b64 exec, -1
L_noct2:
v_mfma_f32_16x16x32_bf16 v[36:39], a[240:243], a[164:167], v[36:39]
ds_read_b128 a[236:239], v249 offset:33792
v_mfma_f32_16x16x32_bf16 v[36:39], a[244:247], a[180:183], v[36:39]
s_lshl_b32 s73, s29, 10
s_add_u32 m0, s73, 159744
s_mov_b32 s72, 384
s_mov_b64 exec, s[98:99]
buffer_load_dwordx4 v216, s[48:51], s72 offen lds
s_mov_b64 exec, -1
s_cmp_eq_u32 s29, 1
s_cbranch_scc0 L_noct3
s_mov_b32 s72, 2366848
s_mov_b32 exec_lo, 0
s_mov_b32 exec_hi, 0xff
buffer_load_dwordx4 v216, s[8:11], s72 offen lds
s_mov_b64 exec, -1
L_noct3:
v_mfma_f32_16x16x32_bf16 v[40:43], a[240:243], a[168:171], v[40:43]
ds_write_b64 v245, a[4:5] offset:64
v_mfma_f32_16x16x32_bf16 v[40:43], a[244:247], a[184:187], v[40:43]
ds_write_b64 v245, a[6:7] offset:2000
v_mfma_f32_16x16x32_bf16 v[44:47], a[240:243], a[172:175], v[44:47]
ds_write_b64 v245, a[8:9] offset:160
v_mfma_f32_16x16x32_bf16 v[44:47], a[244:247], a[188:191], v[44:47]
s_waitcnt lgkmcnt(7)
ds_write_b64 v245, a[10:11] offset:2096
v_mfma_f32_16x16x32_bf16 v[48:51], a[224:227], a[160:163], v[48:51]
ds_read_b128 a[240:243], v249 offset:34816
v_cvt_pk_bf16_f32 v0, v0, v1
v_mfma_f32_16x16x32_bf16 v[48:51], a[228:231], a[176:179], v[48:51]
ds_write_b64 v245, a[12:13] offset:224
v_mfma_f32_16x16x32_bf16 v[52:55], a[224:227], a[164:167], v[52:55]
ds_read_b128 a[244:247], v249 offset:35840
v_cvt_pk_bf16_f32 v1, v2, v3
v_mfma_f32_16x16x32_bf16 v[52:55], a[228:231], a[180:183], v[52:55]
ds_write_b64 v245, a[14:15] offset:2160
v_mfma_f32_16x16x32_bf16 v[56:59], a[224:227], a[168:171], v[56:59]
ds_write_b64 v245, a[16:17] offset:320
v_mfma_f32_16x16x32_bf16 v[56:59], a[228:231], a[184:187], v[56:59]
ds_write_b64 v245, a[18:19] offset:2256
v_mfma_f32_16x16x32_bf16 v[60:63], a[224:227], a[172:175], v[60:63]
ds_write_b64 v245, a[20:21] offset:384
v_mfma_f32_16x16x32_bf16 v[60:63], a[228:231], a[188:191], v[60:63]
s_waitcnt lgkmcnt(11)
ds_write_b64 v245, a[22:23] offset:2320
v_mfma_f32_16x16x32_bf16 v[64:67], a[232:235], a[160:163], v[64:67]
ds_read_b128 a[224:227], v249 offset:49152
v_cvt_pk_bf16_f32 v2, v16, v17
v_mfma_f32_16x16x32_bf16 v[64:67], a[236:239], a[176:179], v[64:67]
ds_write_b64 v246, a[24:25] offset:0
v_mfma_f32_16x16x32_bf16 v[68:71], a[232:235], a[164:167], v[68:71]
ds_read_b128 a[228:231], v249 offset:50176
v_cvt_pk_bf16_f32 v3, v18, v19
v_mfma_f32_16x16x32_bf16 v[68:71], a[236:239], a[180:183], v[68:71]
ds_write_b64 v246, a[26:27] offset:1936
v_mfma_f32_16x16x32_bf16 v[72:75], a[232:235], a[168:171], v[72:75]
s_mov_b64 exec, 0xffffffff
ds_write_b64 v246, a[28:29] offset:320
s_mov_b64 exec, -1
v_mfma_f32_16x16x32_bf16 v[72:75], a[236:239], a[184:187], v[72:75]
s_mov_b64 exec, 0xffffffff
ds_write_b64 v246, a[30:31] offset:2256
s_mov_b64 exec, -1
v_mfma_f32_16x16x32_bf16 v[76:79], a[232:235], a[172:175], v[76:79]
buffer_load_dwordx4 a[64:67], v254, s[16:19], s60 offen offset:256
v_mfma_f32_16x16x32_bf16 v[76:79], a[236:239], a[188:191], v[76:79]
s_waitcnt lgkmcnt(11)
buffer_load_dwordx4 a[68:71], v254, s[16:19], s61 offen offset:256
v_mfma_f32_16x16x32_bf16 v[80:83], a[240:243], a[160:163], v[80:83]
ds_read_b128 a[232:235], v249 offset:51200
v_cvt_pk_bf16_f32 v32, v32, v33
v_mfma_f32_16x16x32_bf16 v[80:83], a[244:247], a[176:179], v[80:83]
buffer_load_dwordx4 a[72:75], v254, s[16:19], s62 offen offset:256
v_mfma_f32_16x16x32_bf16 v[84:87], a[240:243], a[164:167], v[84:87]
ds_read_b128 a[236:239], v249 offset:52224
v_cvt_pk_bf16_f32 v33, v34, v35
v_mfma_f32_16x16x32_bf16 v[84:87], a[244:247], a[180:183], v[84:87]
buffer_load_dwordx4 a[76:79], v254, s[16:19], s63 offen offset:256
v_mfma_f32_16x16x32_bf16 v[88:91], a[240:243], a[168:171], v[88:91]
buffer_load_dwordx4 a[80:83], v254, s[16:19], s64 offen offset:256
v_mfma_f32_16x16x32_bf16 v[88:91], a[244:247], a[184:187], v[88:91]
buffer_load_dwordx4 a[84:87], v254, s[16:19], s65 offen offset:256
v_mfma_f32_16x16x32_bf16 v[92:95], a[240:243], a[172:175], v[92:95]
buffer_load_dwordx4 a[88:91], v255, s[16:19], s66 offen offset:256
v_mfma_f32_16x16x32_bf16 v[92:95], a[244:247], a[188:191], v[92:95]
s_waitcnt lgkmcnt(5)
buffer_load_dwordx4 a[92:95], v255, s[16:19], s67 offen offset:256
v_mfma_f32_16x16x32_bf16 v[96:99], a[224:227], a[160:163], v[96:99]
ds_read_b128 a[240:243], v249 offset:53248
v_cvt_pk_bf16_f32 v34, v48, v49
v_mfma_f32_16x16x32_bf16 v[96:99], a[228:231], a[176:179], v[96:99]
ds_write_b128 v236, v[0:3] offset:0
v_mfma_f32_16x16x32_bf16 v[100:103], a[224:227], a[164:167], v[100:103]
ds_read_b128 a[244:247], v249 offset:54272
v_cvt_pk_bf16_f32 v35, v50, v51
v_mfma_f32_16x16x32_bf16 v[100:103], a[228:231], a[180:183], v[100:103]
ds_write_b128 v237, v[32:35] offset:1024
v_mfma_f32_16x16x32_bf16 v[104:107], a[224:227], a[168:171], v[104:107]
ds_read_b128 v[0:3], v238 offset:0
ds_read_b128 v[32:35], v239 offset:0
v_mfma_f32_16x16x32_bf16 v[104:107], a[228:231], a[184:187], v[104:107]
v_cvt_pk_bf16_f32 v4, v4, v5
v_cvt_pk_bf16_f32 v5, v6, v7
v_mfma_f32_16x16x32_bf16 v[108:111], a[224:227], a[172:175], v[108:111]
v_cvt_pk_bf16_f32 v6, v20, v21
v_cvt_pk_bf16_f32 v7, v22, v23
v_mfma_f32_16x16x32_bf16 v[108:111], a[228:231], a[188:191], v[108:111]
s_waitcnt lgkmcnt(6)
ds_write_b128 v236, v[4:7] offset:2048
v_mfma_f32_16x16x32_bf16 v[112:115], a[232:235], a[160:163], v[112:115]
ds_read_b128 a[224:227], v249 offset:55296
v_cvt_pk_bf16_f32 v36, v36, v37
v_mfma_f32_16x16x32_bf16 v[112:115], a[236:239], a[176:179], v[112:115]
v_cvt_pk_bf16_f32 v37, v38, v39
v_cvt_pk_bf16_f32 v38, v52, v53
v_mfma_f32_16x16x32_bf16 v[116:119], a[232:235], a[164:167], v[116:119]
ds_read_b128 a[228:231], v249 offset:56320
v_cvt_pk_bf16_f32 v39, v54, v55
v_mfma_f32_16x16x32_bf16 v[116:119], a[236:239], a[180:183], v[116:119]
ds_write_b128 v237, v[36:39] offset:3072
v_mfma_f32_16x16x32_bf16 v[120:123], a[232:235], a[168:171], v[120:123]
ds_read_b128 v[4:7], v238 offset:2048
ds_read_b128 v[36:39], v239 offset:2048
v_mfma_f32_16x16x32_bf16 v[120:123], a[236:239], a[184:187], v[120:123]
v_cvt_pk_bf16_f32 v8, v8, v9
v_cvt_pk_bf16_f32 v9, v10, v11
v_mfma_f32_16x16x32_bf16 v[124:127], a[232:235], a[172:175], v[124:127]
v_cvt_pk_bf16_f32 v10, v24, v25
v_cvt_pk_bf16_f32 v11, v26, v27
v_mfma_f32_16x16x32_bf16 v[124:127], a[236:239], a[188:191], v[124:127]
s_waitcnt lgkmcnt(9)
s_barrier
ds_write_b128 v236, v[8:11] offset:0
v_mfma_f32_16x16x32_bf16 v[128:131], a[240:243], a[160:163], v[128:131]
ds_read_b128 a[232:235], v249 offset:57344
v_cvt_pk_bf16_f32 v40, v40, v41
v_mfma_f32_16x16x32_bf16 v[128:131], a[244:247], a[176:179], v[128:131]
v_cvt_pk_bf16_f32 v41, v42, v43
v_cvt_pk_bf16_f32 v42, v56, v57
v_mfma_f32_16x16x32_bf16 v[132:135], a[240:243], a[164:167], v[132:135]
ds_read_b128 a[236:239], v249 offset:58368
v_cvt_pk_bf16_f32 v43, v58, v59
v_mfma_f32_16x16x32_bf16 v[132:135], a[244:247], a[180:183], v[132:135]
ds_write_b128 v237, v[40:43] offset:1024
v_mfma_f32_16x16x32_bf16 v[136:139], a[240:243], a[168:171], v[136:139]
ds_read_b128 v[8:11], v238 offset:0
ds_read_b128 v[40:43], v239 offset:0
v_mfma_f32_16x16x32_bf16 v[136:139], a[244:247], a[184:187], v[136:139]
v_cvt_pk_bf16_f32 v12, v12, v13
v_cvt_pk_bf16_f32 v13, v14, v15
v_mfma_f32_16x16x32_bf16 v[140:143], a[240:243], a[172:175], v[140:143]
v_cvt_pk_bf16_f32 v14, v28, v29
v_cvt_pk_bf16_f32 v15, v30, v31
v_mfma_f32_16x16x32_bf16 v[140:143], a[244:247], a[188:191], v[140:143]
s_waitcnt lgkmcnt(9)
ds_write_b128 v236, v[12:15] offset:2048
v_mfma_f32_16x16x32_bf16 v[144:147], a[224:227], a[160:163], v[144:147]
ds_read_b128 a[240:243], v249 offset:59392
v_cvt_pk_bf16_f32 v44, v44, v45
v_mfma_f32_16x16x32_bf16 v[144:147], a[228:231], a[176:179], v[144:147]
v_cvt_pk_bf16_f32 v45, v46, v47
v_cvt_pk_bf16_f32 v46, v60, v61
v_mfma_f32_16x16x32_bf16 v[148:151], a[224:227], a[164:167], v[148:151]
ds_read_b128 a[244:247], v249 offset:60416
v_cvt_pk_bf16_f32 v47, v62, v63
v_mfma_f32_16x16x32_bf16 v[148:151], a[228:231], a[180:183], v[148:151]
ds_write_b128 v237, v[44:47] offset:3072
v_mfma_f32_16x16x32_bf16 v[152:155], a[224:227], a[168:171], v[152:155]
ds_read_b128 v[12:15], v238 offset:2048
ds_read_b128 v[44:47], v239 offset:2048
v_mfma_f32_16x16x32_bf16 v[152:155], a[228:231], a[184:187], v[152:155]
v_cvt_pk_bf16_f32 v64, v64, v65
v_cvt_pk_bf16_f32 v65, v66, v67
v_mfma_f32_16x16x32_bf16 v[156:159], a[224:227], a[172:175], v[156:159]
v_cvt_pk_bf16_f32 v66, v80, v81
v_cvt_pk_bf16_f32 v67, v82, v83
v_mfma_f32_16x16x32_bf16 v[156:159], a[228:231], a[188:191], v[156:159]
s_waitcnt lgkmcnt(9)
ds_write_b128 v236, v[64:67] offset:0
v_mfma_f32_16x16x32_bf16 v[160:163], a[232:235], a[160:163], v[160:163]
v_cvt_pk_bf16_f32 v96, v96, v97
v_cvt_pk_bf16_f32 v97, v98, v99
v_mfma_f32_16x16x32_bf16 v[160:163], a[236:239], a[176:179], v[160:163]
v_cvt_pk_bf16_f32 v98, v112, v113
v_cvt_pk_bf16_f32 v99, v114, v115
v_mfma_f32_16x16x32_bf16 v[164:167], a[232:235], a[164:167], v[164:167]
ds_write_b128 v237, v[96:99] offset:1024
v_mfma_f32_16x16x32_bf16 v[164:167], a[236:239], a[180:183], v[164:167]
ds_read_b128 v[64:67], v238 offset:0
ds_read_b128 v[96:99], v239 offset:0
v_mfma_f32_16x16x32_bf16 v[168:171], a[232:235], a[168:171], v[168:171]
v_cvt_pk_bf16_f32 v68, v68, v69
v_cvt_pk_bf16_f32 v69, v70, v71
v_mfma_f32_16x16x32_bf16 v[168:171], a[236:239], a[184:187], v[168:171]
v_cvt_pk_bf16_f32 v70, v84, v85
v_cvt_pk_bf16_f32 v71, v86, v87
v_mfma_f32_16x16x32_bf16 v[172:175], a[232:235], a[172:175], v[172:175]
ds_write_b128 v236, v[68:71] offset:2048
v_mfma_f32_16x16x32_bf16 v[172:175], a[236:239], a[188:191], v[172:175]
s_waitcnt lgkmcnt(8)
v_cvt_pk_bf16_f32 v100, v100, v101
v_cvt_pk_bf16_f32 v101, v102, v103
v_mfma_f32_16x16x32_bf16 v[176:179], a[240:243], a[160:163], v[176:179]
v_cvt_pk_bf16_f32 v102, v116, v117
v_cvt_pk_bf16_f32 v103, v118, v119
v_mfma_f32_16x16x32_bf16 v[176:179], a[244:247], a[176:179], v[176:179]
ds_write_b128 v237, v[100:103] offset:3072
v_mfma_f32_16x16x32_bf16 v[180:183], a[240:243], a[164:167], v[180:183]
ds_read_b128 v[68:71], v238 offset:2048
ds_read_b128 v[100:103], v239 offset:2048
v_mfma_f32_16x16x32_bf16 v[180:183], a[244:247], a[180:183], v[180:183]
v_cvt_pk_bf16_f32 v72, v72, v73
v_cvt_pk_bf16_f32 v73, v74, v75
v_mfma_f32_16x16x32_bf16 v[184:187], a[240:243], a[168:171], v[184:187]
v_cvt_pk_bf16_f32 v74, v88, v89
v_cvt_pk_bf16_f32 v75, v90, v91
v_mfma_f32_16x16x32_bf16 v[184:187], a[244:247], a[184:187], v[184:187]
ds_write_b128 v236, v[72:75] offset:0
v_mfma_f32_16x16x32_bf16 v[188:191], a[240:243], a[172:175], v[188:191]
v_cvt_pk_bf16_f32 v104, v104, v105
v_cvt_pk_bf16_f32 v105, v106, v107
v_mfma_f32_16x16x32_bf16 v[188:191], a[244:247], a[188:191], v[188:191]
v_cvt_pk_bf16_f32 v106, v120, v121
v_cvt_pk_bf16_f32 v107, v122, v123
s_nop 4
ds_write_b128 v237, v[104:107] offset:1024
ds_read_b128 v[72:75], v238 offset:0
ds_read_b128 v[104:107], v239 offset:0
v_cvt_pk_bf16_f32 v76, v76, v77
v_cvt_pk_bf16_f32 v77, v78, v79
v_cvt_pk_bf16_f32 v78, v92, v93
v_cvt_pk_bf16_f32 v79, v94, v95
v_cvt_pk_bf16_f32 v108, v108, v109
v_cvt_pk_bf16_f32 v109, v110, v111
v_cvt_pk_bf16_f32 v110, v124, v125
v_cvt_pk_bf16_f32 v111, v126, v127
ds_write_b128 v236, v[76:79] offset:2048
ds_write_b128 v237, v[108:111] offset:3072
ds_read_b128 v[76:79], v238 offset:2048
ds_read_b128 v[108:111], v239 offset:2048
v_cvt_pk_bf16_f32 v128, v128, v129
v_cvt_pk_bf16_f32 v129, v130, v131
v_cvt_pk_bf16_f32 v130, v144, v145
v_cvt_pk_bf16_f32 v131, v146, v147
v_cvt_pk_bf16_f32 v160, v160, v161
v_cvt_pk_bf16_f32 v161, v162, v163
v_cvt_pk_bf16_f32 v162, v176, v177
v_cvt_pk_bf16_f32 v163, v178, v179
ds_write_b128 v236, v[128:131] offset:0
ds_write_b128 v237, v[160:163] offset:1024
ds_read_b128 v[128:131], v238 offset:0
ds_read_b128 v[160:163], v239 offset:0
v_cvt_pk_bf16_f32 v132, v132, v133
v_cvt_pk_bf16_f32 v133, v134, v135
v_cvt_pk_bf16_f32 v134, v148, v149
v_cvt_pk_bf16_f32 v135, v150, v151
v_cvt_pk_bf16_f32 v164, v164, v165
v_cvt_pk_bf16_f32 v165, v166, v167
v_cvt_pk_bf16_f32 v166, v180, v181
v_cvt_pk_bf16_f32 v167, v182, v183
ds_write_b128 v236, v[132:135] offset:2048
ds_write_b128 v237, v[164:167] offset:3072
ds_read_b128 v[132:135], v238 offset:2048
ds_read_b128 v[164:167], v239 offset:2048
v_cvt_pk_bf16_f32 v136, v136, v137
v_cvt_pk_bf16_f32 v137, v138, v139
v_cvt_pk_bf16_f32 v138, v152, v153
v_cvt_pk_bf16_f32 v139, v154, v155
v_cvt_pk_bf16_f32 v168, v168, v169
v_cvt_pk_bf16_f32 v169, v170, v171
v_cvt_pk_bf16_f32 v170, v184, v185
v_cvt_pk_bf16_f32 v171, v186, v187
ds_write_b128 v236, v[136:139] offset:0
ds_write_b128 v237, v[168:171] offset:1024
ds_read_b128 v[136:139], v238 offset:0
ds_read_b128 v[168:171], v239 offset:0
v_cvt_pk_bf16_f32 v140, v140, v141
v_cvt_pk_bf16_f32 v141, v142, v143
v_cvt_pk_bf16_f32 v142, v156, v157
v_cvt_pk_bf16_f32 v143, v158, v159
v_cvt_pk_bf16_f32 v172, v172, v173
v_cvt_pk_bf16_f32 v173, v174, v175
v_cvt_pk_bf16_f32 v174, v188, v189
v_cvt_pk_bf16_f32 v175, v190, v191
ds_write_b128 v236, v[140:143] offset:2048
ds_write_b128 v237, v[172:175] offset:3072
ds_read_b128 v[140:143], v238 offset:2048
ds_read_b128 v[172:175], v239 offset:2048
s_waitcnt vmcnt(8) lgkmcnt(0)
s_barrier
s_mov_b32 s41, s34
s_mov_b32 s32, 1
ds_read_u16 v192, v212 offset:36096
ds_read_u16 v193, v214 offset:36096
ds_read_u16 v194, v212 offset:36736
ds_read_u16 v195, v214 offset:36736
ds_read_u16 v196, v212 offset:37376
ds_read_u16 v197, v214 offset:37376
ds_read_u16 v198, v212 offset:38016
ds_read_u16 v199, v214 offset:38016
ds_read_u16 v200, v212 offset:38656
ds_read_u16 v201, v214 offset:38656
ds_read_b128 a[192:195], v244 offset:0
ds_read_b128 a[196:199], v244 offset:160
ds_read_b128 a[200:203], v244 offset:320
ds_read_b128 a[204:207], v244 offset:480
ds_read_b128 a[208:211], v244 offset:640
ds_read_b128 a[212:215], v244 offset:800
s_lshl_b32 s73, s29, 10
s_add_u32 m0, s73, 111360
s_mov_b32 s72, 512
s_mov_b64 exec, s[98:99]
buffer_load_dwordx4 v216, s[48:51], s72 offen lds
s_mov_b64 exec, -1
s_cmp_eq_u32 s29, 1
s_cbranch_scc0 L_nocn4
s_mov_b32 s72, 2366976
s_mov_b32 exec_lo, 0
s_mov_b32 exec_hi, 0xff
buffer_load_dwordx4 v216, s[8:11], s72 offen lds
s_mov_b64 exec, -1
L_nocn4:
s_add_u32 m0, s73, 115456
s_mov_b32 s72, 640
s_mov_b64 exec, s[98:99]
buffer_load_dwordx4 v216, s[48:51], s72 offen lds
s_mov_b64 exec, -1
s_cmp_eq_u32 s29, 1
s_cbranch_scc0 L_nocn5
s_mov_b32 s72, 2367104
s_mov_b32 exec_lo, 0
s_mov_b32 exec_hi, 0xff
buffer_load_dwordx4 v216, s[8:11], s72 offen lds
s_mov_b64 exec, -1
L_nocn5:
s_waitcnt lgkmcnt(14)
v_perm_b32 v232, v193, v192, v240
v_perm_b32 v233, v193, v192, v241
v_perm_b32 v234, v193, v192, v242
v_perm_b32 v235, v193, v192, v243
s_nop 1
s_waitcnt lgkmcnt(0)
v_mfma_f32_16x16x32_bf16 v[16:19], v[232:235], a[192:195], 0
ds_read_u16 v202, v212 offset:36104
ds_read_u16 v203, v214 offset:36104
v_perm_b32 v236, v195, v194, v240
v_perm_b32 v237, v195, v194, v241
v_perm_b32 v238, v195, v194, v242
v_perm_b32 v239, v195, v194, v243
v_mfma_f32_16x16x32_bf16 v[20:23], v[232:235], a[196:199], 0
ds_read_b128 a[216:219], v244 offset:1936
ds_read_b128 a[220:223], v244 offset:2096
ds_read_b128 a[224:227], v244 offset:2256
v_mfma_f32_16x16x32_bf16 v[16:19], v[236:239], a[196:199], v[16:19]
ds_read_b128 a[228:231], v244 offset:2416
v_perm_b32 v232, v197, v196, v240
v_perm_b32 v233, v197, v196, v241
v_perm_b32 v234, v197, v196, v242
v_perm_b32 v235, v197, v196, v243
v_mfma_f32_16x16x32_bf16 v[20:23], v[236:239], a[200:203], v[20:23]
ds_read_b128 a[232:235], v244 offset:2576
ds_read_b128 a[236:239], v244 offset:2736
ds_read_u16 v204, v212 offset:36744
v_mfma_f32_16x16x32_bf16 v[16:19], v[232:235], a[200:203], v[16:19]
ds_read_u16 v205, v214 offset:36744
v_perm_b32 v236, v199, v198, v240
v_perm_b32 v237, v199, v198, v241
v_perm_b32 v238, v199, v198, v242
v_perm_b32 v239, v199, v198, v243
v_mfma_f32_16x16x32_bf16 v[20:23], v[232:235], a[204:207], v[20:23]
ds_read_u16 v206, v212 offset:37384
ds_read_u16 v207, v214 offset:37384
ds_write_b64 v245, a[32:33] offset:30992
v_mfma_f32_16x16x32_bf16 v[16:19], v[236:239], a[204:207], v[16:19]
ds_read_u16 v208, v212 offset:38024
v_perm_b32 v232, v201, v200, v240
v_perm_b32 v233, v201, v200, v241
v_perm_b32 v234, v201, v200, v242
v_perm_b32 v235, v201, v200, v243
v_mfma_f32_16x16x32_bf16 v[20:23], v[236:239], a[208:211], v[20:23]
ds_read_u16 v209, v214 offset:38024
ds_read_u16 v210, v212 offset:38664
ds_read_u16 v211, v214 offset:38664
ds_write_b64 v245, a[34:35] offset:32928
v_mfma_f32_16x16x32_bf16 v[16:19], v[232:235], a[208:211], v[16:19]
s_waitcnt lgkmcnt(15)
ds_write_b64 v245, a[36:37] offset:31056
v_perm_b32 v236, v203, v202, v240
v_perm_b32 v237, v203, v202, v241
v_perm_b32 v238, v203, v202, v242
v_perm_b32 v239, v203, v202, v243
v_mfma_f32_16x16x32_bf16 v[20:23], v[232:235], a[212:215], v[20:23]
ds_write_b64 v245, a[38:39] offset:32992
ds_write_b64 v245, a[40:41] offset:31152
ds_write_b64 v245, a[42:43] offset:33088
s_waitcnt lgkmcnt(14)
v_mfma_f32_16x16x32_bf16 v[24:27], v[236:239], a[216:219], 0
s_waitcnt lgkmcnt(12)
ds_read_u16 v192, v213 offset:36096
ds_read_u16 v193, v215 offset:36096
v_perm_b32 v232, v205, v204, v240
v_perm_b32 v233, v205, v204, v241
v_perm_b32 v234, v205, v204, v242
v_perm_b32 v235, v205, v204, v243
v_mfma_f32_16x16x32_bf16 v[28:31], v[236:239], a[220:223], 0
ds_read_b128 a[192:195], v244 offset:3872
ds_read_b128 a[196:199], v244 offset:4032
ds_read_b128 a[200:203], v244 offset:4192
s_cmp_eq_u32 s31, 0
s_cbranch_scc0 L_noresn0
ds_read_b128 a[0:3], v251 offset:0
ds_read_b128 a[4:7], v251 offset:16
ds_read_b128 a[8:11], v251 offset:1936
ds_read_b128 a[12:15], v251 offset:1952
ds_read_b128 a[16:19], v251 offset:15504
ds_read_b128 a[20:23], v251 offset:15520
ds_read_b128 a[24:27], v251 offset:17440
ds_read_b128 a[28:31], v251 offset:17456
L_noresn0:
v_mfma_f32_16x16x32_bf16 v[24:27], v[232:235], a[220:223], v[24:27]
s_waitcnt lgkmcnt(15)
ds_read_b128 a[204:207], v244 offset:4352
v_perm_b32 v236, v207, v206, v240
v_perm_b32 v237, v207, v206, v241
v_perm_b32 v238, v207, v206, v242
v_perm_b32 v239, v207, v206, v243
v_mfma_f32_16x16x32_bf16 v[28:31], v[232:235], a[224:227], v[28:31]
buffer_load_dwordx4 a[96:99], v254, s[16:19], s60 offen offset:384
ds_read_b128 a[208:211], v244 offset:4512
ds_read_b128 a[212:215], v244 offset:4672
ds_read_u16 v194, v213 offset:36736
v_mfma_f32_16x16x32_bf16 v[24:27], v[236:239], a[224:227], v[24:27]
s_waitcnt lgkmcnt(15)
ds_read_u16 v195, v215 offset:36736
v_perm_b32 v232, v209, v208, v240
v_perm_b32 v233, v209, v208, v241
v_perm_b32 v234, v209, v208, v242
v_perm_b32 v235, v209, v208, v243
v_mfma_f32_16x16x32_bf16 v[28:31], v[236:239], a[228:231], v[28:31]
buffer_load_dwordx4 a[100:103], v254, s[16:19], s61 offen offset:384
ds_read_u16 v196, v213 offset:37376
ds_read_u16 v197, v215 offset:37376
ds_write_b64 v245, a[44:45] offset:31216
v_mfma_f32_16x16x32_bf16 v[24:27], v[232:235], a[228:231], v[24:27]
s_waitcnt lgkmcnt(15)
ds_read_u16 v198, v213 offset:38016
v_perm_b32 v236, v211, v210, v240
v_perm_b32 v237, v211, v210, v241
v_perm_b32 v238, v211, v210, v242
v_perm_b32 v239, v211, v210, v243
v_mfma_f32_16x16x32_bf16 v[28:31], v[232:235], a[232:235], v[28:31]
buffer_load_dwordx4 a[104:107], v254, s[16:19], s62 offen offset:384
ds_read_u16 v199, v215 offset:38016
ds_read_u16 v200, v213 offset:38656
ds_read_u16 v201, v215 offset:38656
ds_write_b64 v245, a[46:47] offset:33152
v_mfma_f32_16x16x32_bf16 v[24:27], v[236:239], a[232:235], v[24:27]
s_waitcnt lgkmcnt(15)
ds_write_b64 v245, a[48:49] offset:31312
v_perm_b32 v232, v193, v192, v240
v_perm_b32 v233, v193, v192, v241
v_perm_b32 v234, v193, v192, v242
v_perm_b32 v235, v193, v192, v243
v_mfma_f32_16x16x32_bf16 v[28:31], v[236:239], a[236:239], v[28:31]
ds_write_b64 v245, a[50:51] offset:33248
ds_write_b64 v245, a[52:53] offset:31376
s_waitcnt lgkmcnt(13)
v_mfma_f32_16x16x32_bf16 v[48:51], v[232:235], a[192:195], 0
s_waitcnt lgkmcnt(11)
ds_read_u16 v202, v213 offset:36104
ds_read_u16 v203, v215 offset:36104
v_perm_b32 v236, v195, v194, v240
v_perm_b32 v237, v195, v194, v241
v_perm_b32 v238, v195, v194, v242
v_perm_b32 v239, v195, v194, v243
v_mfma_f32_16x16x32_bf16 v[52:55], v[232:235], a[196:199], 0
ds_read_b128 a[216:219], v244 offset:5808
ds_read_b128 a[220:223], v244 offset:5968
ds_read_b128 a[224:227], v244 offset:6128
v_mfma_f32_16x16x32_bf16 v[48:51], v[236:239], a[196:199], v[48:51]
s_waitcnt lgkmcnt(14)
ds_read_b128 a[228:231], v244 offset:6288
v_perm_b32 v232, v197, v196, v240
v_perm_b32 v233, v197, v196, v241
v_perm_b32 v234, v197, v196, v242
v_perm_b32 v235, v197, v196, v243
v_mfma_f32_16x16x32_bf16 v[52:55], v[236:239], a[200:203], v[52:55]
buffer_load_dwordx4 a[108:111], v254, s[16:19], s63 offen offset:384
ds_read_b128 a[232:235], v244 offset:6448
ds_read_b128 a[236:239], v244 offset:6608
ds_read_u16 v204, v213 offset:36744
v_mfma_f32_16x16x32_bf16 v[48:51], v[232:235], a[200:203], v[48:51]
s_waitcnt lgkmcnt(15)
ds_read_u16 v205, v215 offset:36744
v_perm_b32 v236, v199, v198, v240
v_perm_b32 v237, v199, v198, v241
v_perm_b32 v238, v199, v198, v242
v_perm_b32 v239, v199, v198, v243
v_mfma_f32_16x16x32_bf16 v[52:55], v[232:235], a[204:207], v[52:55]
buffer_load_dwordx4 a[112:115], v254, s[16:19], s64 offen offset:384
ds_read_u16 v206, v213 offset:37384
ds_read_u16 v207, v215 offset:37384
ds_write_b64 v245, a[54:55] offset:33312
v_mfma_f32_16x16x32_bf16 v[48:51], v[236:239], a[204:207], v[48:51]
s_waitcnt lgkmcnt(15)
ds_read_u16 v208, v213 offset:38024
v_perm_b32 v232, v201, v200, v240
v_perm_b32 v233, v201, v200, v241
v_perm_b32 v234, v201, v200, v242
v_perm_b32 v235, v201, v200, v243
v_mfma_f32_16x16x32_bf16 v[52:55], v[236:239], a[208:211], v[52:55]
buffer_load_dwordx4 a[116:119], v254, s[16:19], s65 offen offset:384
ds_read_u16 v209, v215 offset:38024
ds_read_u16 v210, v213 offset:38664
ds_read_u16 v211, v215 offset:38664
ds_write_b64 v246, a[56:57] offset:30992
v_mfma_f32_16x16x32_bf16 v[48:51], v[232:235], a[208:211], v[48:51]
s_waitcnt lgkmcnt(15)
ds_write_b64 v246, a[58:59] offset:32928
v_perm_b32 v236, v203, v202, v240
v_perm_b32 v237, v203, v202, v241
v_perm_b32 v238, v203, v202, v242
v_perm_b32 v239, v203, v202, v243
v_mfma_f32_16x16x32_bf16 v[52:55], v[232:235], a[212:215], v[52:55]
s_mov_b64 exec, 0xffffffff
ds_write_b64 v246, a[60:61] offset:31312
s_mov_b64 exec, -1
s_mov_b64 exec, 0xffffffff
ds_write_b64 v246, a[62:63] offset:33248
s_mov_b64 exec, -1
s_waitcnt lgkmcnt(0)
s_barrier
v_mfma_f32_16x16x32_bf16 v[56:59], v[236:239], a[216:219], 0
ds_read_u16 v192, v212 offset:40192
ds_read_u16 v193, v214 offset:40192
v_perm_b32 v232, v205, v204, v240
v_perm_b32 v233, v205, v204, v241
v_perm_b32 v234, v205, v204, v242
v_perm_b32 v235, v205, v204, v243
v_mfma_f32_16x16x32_bf16 v[60:63], v[236:239], a[220:223], 0
ds_read_b128 a[192:195], v244 offset:30992
ds_read_b128 a[196:199], v244 offset:31152
ds_read_b128 a[200:203], v244 offset:31312
v_mfma_f32_16x16x32_bf16 v[56:59], v[232:235], a[220:223], v[56:59]
ds_read_b128 a[204:207], v244 offset:31472
v_perm_b32 v236, v207, v206, v240
v_perm_b32 v237, v207, v206, v241
v_perm_b32 v238, v207, v206, v242
v_perm_b32 v239, v207, v206, v243
v_mfma_f32_16x16x32_bf16 v[60:63], v[232:235], a[224:227], v[60:63]
buffer_load_dwordx4 a[120:123], v255, s[16:19], s66 offen offset:384
ds_read_b128 a[208:211], v244 offset:31632
ds_read_b128 a[212:215], v244 offset:31792
ds_read_u16 v194, v212 offset:40832
v_mfma_f32_16x16x32_bf16 v[56:59], v[236:239], a[224:227], v[56:59]
ds_read_u16 v195, v214 offset:40832
v_perm_b32 v232, v209, v208, v240
v_perm_b32 v233, v209, v208, v241
v_perm_b32 v234, v209, v208, v242
v_perm_b32 v235, v209, v208, v243
v_mfma_f32_16x16x32_bf16 v[60:63], v[236:239], a[228:231], v[60:63]
buffer_load_dwordx4 a[124:127], v255, s[16:19], s67 offen offset:384
ds_read_u16 v196, v212 offset:41472
ds_read_u16 v197, v214 offset:41472
v_mfma_f32_16x16x32_bf16 v[56:59], v[232:235], a[228:231], v[56:59]
ds_read_u16 v198, v212 offset:42112
v_perm_b32 v236, v211, v210, v240
v_perm_b32 v237, v211, v210, v241
v_perm_b32 v238, v211, v210, v242
v_perm_b32 v239, v211, v210, v243
v_mfma_f32_16x16x32_bf16 v[60:63], v[232:235], a[232:235], v[60:63]
ds_read_u16 v199, v214 offset:42112
ds_read_u16 v200, v212 offset:42752
ds_read_u16 v201, v214 offset:42752
v_mfma_f32_16x16x32_bf16 v[56:59], v[236:239], a[232:235], v[56:59]
s_waitcnt lgkmcnt(14)
v_perm_b32 v232, v193, v192, v240
v_perm_b32 v233, v193, v192, v241
v_perm_b32 v234, v193, v192, v242
v_perm_b32 v235, v193, v192, v243
v_mfma_f32_16x16x32_bf16 v[60:63], v[236:239], a[236:239], v[60:63]
s_nop 0
s_waitcnt lgkmcnt(8)
v_mfma_f32_16x16x32_bf16 v[80:83], v[232:235], a[192:195], 0
s_waitcnt lgkmcnt(6)
s_waitcnt vmcnt(10)
ds_read_u16 v202, v212 offset:40200
ds_read_u16 v203, v214 offset:40200
v_perm_b32 v236, v195, v194, v240
v_perm_b32 v237, v195, v194, v241
v_perm_b32 v238, v195, v194, v242
v_perm_b32 v239, v195, v194, v243
v_mfma_f32_16x16x32_bf16 v[84:87], v[232:235], a[196:199], 0
buffer_load_dwordx4 a[160:163], v254, s[16:19], s60 offen offset:640
ds_read_b128 a[216:219], v244 offset:32928
ds_read_b128 a[220:223], v244 offset:33088
ds_read_b128 a[224:227], v244 offset:33248
v_mfma_f32_16x16x32_bf16 v[80:83], v[236:239], a[196:199], v[80:83]
s_waitcnt lgkmcnt(9)
ds_read_b128 a[228:231], v244 offset:33408
v_perm_b32 v232, v197, v196, v240
v_perm_b32 v233, v197, v196, v241
v_perm_b32 v234, v197, v196, v242
v_perm_b32 v235, v197, v196, v243
v_mfma_f32_16x16x32_bf16 v[84:87], v[236:239], a[200:203], v[84:87]
buffer_load_dwordx4 a[168:171], v254, s[16:19], s62 offen offset:640
buffer_load_dwordx4 a[164:167], v254, s[16:19], s61 offen offset:640
ds_read_b128 a[232:235], v244 offset:33568
ds_read_b128 a[236:239], v244 offset:33728
ds_read_u16 v204, v212 offset:40840
v_mfma_f32_16x16x32_bf16 v[80:83], v[232:235], a[200:203], v[80:83]
s_waitcnt lgkmcnt(11)
ds_read_u16 v205, v214 offset:40840
v_perm_b32 v236, v199, v198, v240
v_perm_b32 v237, v199, v198, v241
v_perm_b32 v238, v199, v198, v242
v_perm_b32 v239, v199, v198, v243
v_mfma_f32_16x16x32_bf16 v[84:87], v[232:235], a[204:207], v[84:87]
buffer_load_dwordx4 a[172:175], v254, s[16:19], s63 offen offset:640
ds_read_u16 v206, v212 offset:41480
ds_read_u16 v207, v214 offset:41480
ds_write_b64 v245, a[64:65] offset:0
v_mfma_f32_16x16x32_bf16 v[80:83], v[236:239], a[204:207], v[80:83]
s_waitcnt lgkmcnt(13)
ds_read_u16 v208, v212 offset:42120
v_perm_b32 v232, v201, v200, v240
v_perm_b32 v233, v201, v200, v241
v_perm_b32 v234, v201, v200, v242
v_perm_b32 v235, v201, v200, v243
v_mfma_f32_16x16x32_bf16 v[84:87], v[236:239], a[208:211], v[84:87]
buffer_load_dwordx4 a[180:183], v254, s[16:19], s65 offen offset:640
buffer_load_dwordx4 a[176:179], v254, s[16:19], s64 offen offset:640
ds_read_u16 v209, v214 offset:42120
ds_read_u16 v210, v212 offset:42760
ds_read_u16 v211, v214 offset:42760
ds_write_b64 v245, a[66:67] offset:1936
v_mfma_f32_16x16x32_bf16 v[80:83], v[232:235], a[208:211], v[80:83]
s_waitcnt lgkmcnt(15)
ds_write_b64 v245, a[68:69] offset:64
v_perm_b32 v236, v203, v202, v240
v_perm_b32 v237, v203, v202, v241
v_perm_b32 v238, v203, v202, v242
v_perm_b32 v239, v203, v202, v243
v_mfma_f32_16x16x32_bf16 v[84:87], v[232:235], a[212:215], v[84:87]
buffer_load_dwordx4 a[188:191], v255, s[16:19], s67 offen offset:640
buffer_load_dwordx4 a[184:187], v255, s[16:19], s66 offen offset:640
ds_write_b64 v245, a[70:71] offset:2000
ds_write_b64 v245, a[72:73] offset:160
ds_write_b64 v245, a[74:75] offset:2096
s_waitcnt lgkmcnt(14)
v_mfma_f32_16x16x32_bf16 v[88:91], v[236:239], a[216:219], 0
s_waitcnt lgkmcnt(12)
ds_read_u16 v192, v213 offset:40192
ds_read_u16 v193, v215 offset:40192
v_perm_b32 v232, v205, v204, v240
v_perm_b32 v233, v205, v204, v241
v_perm_b32 v234, v205, v204, v242
v_perm_b32 v235, v205, v204, v243
v_mfma_f32_16x16x32_bf16 v[92:95], v[236:239], a[220:223], 0
ds_read_b128 a[192:195], v244 offset:34864
ds_read_b128 a[196:199], v244 offset:35024
ds_read_b128 a[200:203], v244 offset:35184
s_cmp_eq_u32 s31, 0
s_cbranch_scc0 L_noresn1
ds_read_b128 a[32:35], v251 offset:30992
ds_read_b128 a[36:39], v251 offset:31008
ds_read_b128 a[40:43], v251 offset:32928
ds_read_b128 a[44:47], v251 offset:32944
ds_read_b128 a[48:51], v251 offset:46496
ds_read_b128 a[52:55], v251 offset:46512
ds_read_b128 a[56:59], v251 offset:48432
ds_read_b128 a[60:63], v251 offset:48448
L_noresn1:
v_mfma_f32_16x16x32_bf16 v[88:91], v[232:235], a[220:223], v[88:91]
s_waitcnt lgkmcnt(15)
ds_read_b128 a[204:207], v244 offset:35344
v_perm_b32 v236, v207, v206, v240
v_perm_b32 v237, v207, v206, v241
v_perm_b32 v238, v207, v206, v242
v_perm_b32 v239, v207, v206, v243
v_mfma_f32_16x16x32_bf16 v[92:95], v[232:235], a[224:227], v[92:95]
buffer_load_dwordx4 a[128:131], v254, s[16:19], s60 offen offset:512
ds_read_b128 a[208:211], v244 offset:35504
ds_read_b128 a[212:215], v244 offset:35664
ds_read_u16 v194, v213 offset:40832
v_mfma_f32_16x16x32_bf16 v[88:91], v[236:239], a[224:227], v[88:91]
s_waitcnt lgkmcnt(15)
ds_read_u16 v195, v215 offset:40832
v_perm_b32 v232, v209, v208, v240
v_perm_b32 v233, v209, v208, v241
v_perm_b32 v234, v209, v208, v242
v_perm_b32 v235, v209, v208, v243
v_mfma_f32_16x16x32_bf16 v[92:95], v[236:239], a[228:231], v[92:95]
buffer_load_dwordx4 a[132:135], v254, s[16:19], s61 offen offset:512
ds_read_u16 v196, v213 offset:41472
ds_read_u16 v197, v215 offset:41472
ds_write_b64 v245, a[76:77] offset:224
v_mfma_f32_16x16x32_bf16 v[88:91], v[232:235], a[228:231], v[88:91]
s_waitcnt lgkmcnt(15)
ds_read_u16 v198, v213 offset:42112
v_perm_b32 v236, v211, v210, v240
v_perm_b32 v237, v211, v210, v241
v_perm_b32 v238, v211, v210, v242
v_perm_b32 v239, v211, v210, v243
v_mfma_f32_16x16x32_bf16 v[92:95], v[232:235], a[232:235], v[92:95]
buffer_load_dwordx4 a[136:139], v254, s[16:19], s62 offen offset:512
ds_read_u16 v199, v215 offset:42112
ds_read_u16 v200, v213 offset:42752
ds_read_u16 v201, v215 offset:42752
ds_write_b64 v245, a[78:79] offset:2160
v_mfma_f32_16x16x32_bf16 v[88:91], v[236:239], a[232:235], v[88:91]
s_waitcnt lgkmcnt(15)
ds_write_b64 v245, a[80:81] offset:320
v_perm_b32 v232, v193, v192, v240
v_perm_b32 v233, v193, v192, v241
v_perm_b32 v234, v193, v192, v242
v_perm_b32 v235, v193, v192, v243
v_mfma_f32_16x16x32_bf16 v[92:95], v[236:239], a[236:239], v[92:95]
ds_write_b64 v245, a[82:83] offset:2256
ds_write_b64 v245, a[84:85] offset:384
s_waitcnt lgkmcnt(13)
v_mfma_f32_16x16x32_bf16 v[112:115], v[232:235], a[192:195], 0
s_waitcnt lgkmcnt(11)
ds_read_u16 v202, v213 offset:40200
ds_read_u16 v203, v215 offset:40200
v_perm_b32 v236, v195, v194, v240
v_perm_b32 v237, v195, v194, v241
v_perm_b32 v238, v195, v194, v242
v_perm_b32 v239, v195, v194, v243
v_mfma_f32_16x16x32_bf16 v[116:119], v[232:235], a[196:199], 0
ds_read_b128 a[216:219], v244 offset:36800
ds_read_b128 a[220:223], v244 offset:36960
ds_read_b128 a[224:227], v244 offset:37120
v_mfma_f32_16x16x32_bf16 v[112:115], v[236:239], a[196:199], v[112:115]
s_waitcnt lgkmcnt(14)
ds_read_b128 a[228:231], v244 offset:37280
v_perm_b32 v232, v197, v196, v240
v_perm_b32 v233, v197, v196, v241
v_perm_b32 v234, v197, v196, v242
v_perm_b32 v235, v197, v196, v243
v_mfma_f32_16x16x32_bf16 v[116:119], v[236:239], a[200:203], v[116:119]
buffer_load_dwordx4 a[140:143], v254, s[16:19], s63 offen offset:512
ds_read_b128 a[232:235], v244 offset:37440
ds_read_b128 a[236:239], v244 offset:37600
ds_read_u16 v204, v213 offset:40840
v_mfma_f32_16x16x32_bf16 v[112:115], v[232:235], a[200:203], v[112:115]
s_waitcnt lgkmcnt(15)
ds_read_u16 v205, v215 offset:40840
v_perm_b32 v236, v199, v198, v240
v_perm_b32 v237, v199, v198, v241
v_perm_b32 v238, v199, v198, v242
v_perm_b32 v239, v199, v198, v243
v_mfma_f32_16x16x32_bf16 v[116:119], v[232:235], a[204:207], v[116:119]
buffer_load_dwordx4 a[144:147], v254, s[16:19], s64 offen offset:512
ds_read_u16 v206, v213 offset:41480
ds_read_u16 v207, v215 offset:41480
ds_write_b64 v245, a[86:87] offset:2320
v_mfma_f32_16x16x32_bf16 v[112:115], v[236:239], a[204:207], v[112:115]
s_waitcnt lgkmcnt(15)
ds_read_u16 v208, v213 offset:42120
v_perm_b32 v232, v201, v200, v240
v_perm_b32 v233, v201, v200, v241
v_perm_b32 v234, v201, v200, v242
v_perm_b32 v235, v201, v200, v243
v_mfma_f32_16x16x32_bf16 v[116:119], v[236:239], a[208:211], v[116:119]
buffer_load_dwordx4 a[148:151], v254, s[16:19], s65 offen offset:512
ds_read_u16 v209, v215 offset:42120
ds_read_u16 v210, v213 offset:42760
ds_read_u16 v211, v215 offset:42760
ds_write_b64 v246, a[88:89] offset:0
v_mfma_f32_16x16x32_bf16 v[112:115], v[232:235], a[208:211], v[112:115]
s_waitcnt lgkmcnt(15)
ds_write_b64 v246, a[90:91] offset:1936
v_perm_b32 v236, v203, v202, v240
v_perm_b32 v237, v203, v202, v241
v_perm_b32 v238, v203, v202, v242
v_perm_b32 v239, v203, v202, v243
v_mfma_f32_16x16x32_bf16 v[116:119], v[232:235], a[212:215], v[116:119]
s_mov_b64 exec, 0xffffffff
ds_write_b64 v246, a[92:93] offset:320
s_mov_b64 exec, -1
s_mov_b64 exec, 0xffffffff
ds_write_b64 v246, a[94:95] offset:2256
s_mov_b64 exec, -1
s_waitcnt vmcnt(22) lgkmcnt(0)
s_barrier
v_mfma_f32_16x16x32_bf16 v[120:123], v[236:239], a[216:219], 0
ds_read_u16 v192, v212 offset:44288
ds_read_u16 v193, v214 offset:44288
v_perm_b32 v232, v205, v204, v240
v_perm_b32 v233, v205, v204, v241
v_perm_b32 v234, v205, v204, v242
v_perm_b32 v235, v205, v204, v243
v_mfma_f32_16x16x32_bf16 v[124:127], v[236:239], a[220:223], 0
ds_read_b128 a[192:195], v244 offset:0
ds_read_b128 a[196:199], v244 offset:160
ds_read_b128 a[200:203], v244 offset:320
v_mfma_f32_16x16x32_bf16 v[120:123], v[232:235], a[220:223], v[120:123]
ds_read_b128 a[204:207], v244 offset:480
v_perm_b32 v236, v207, v206, v240
v_perm_b32 v237, v207, v206, v241
v_perm_b32 v238, v207, v206, v242
v_perm_b32 v239, v207, v206, v243
v_mfma_f32_16x16x32_bf16 v[124:127], v[232:235], a[224:227], v[124:127]
buffer_load_dwordx4 a[152:155], v255, s[16:19], s66 offen offset:512
ds_read_b128 a[208:211], v244 offset:640
ds_read_b128 a[212:215], v244 offset:800
ds_read_u16 v194, v212 offset:44928
v_mfma_f32_16x16x32_bf16 v[120:123], v[236:239], a[224:227], v[120:123]
ds_read_u16 v195, v214 offset:44928
v_perm_b32 v232, v209, v208, v240
v_perm_b32 v233, v209, v208, v241
v_perm_b32 v234, v209, v208, v242
v_perm_b32 v235, v209, v208, v243
v_mfma_f32_16x16x32_bf16 v[124:127], v[236:239], a[228:231], v[124:127]
buffer_load_dwordx4 a[156:159], v255, s[16:19], s67 offen offset:512
ds_read_u16 v196, v212 offset:45568
ds_read_u16 v197, v214 offset:45568
v_mfma_f32_16x16x32_bf16 v[120:123], v[232:235], a[228:231], v[120:123]
ds_read_u16 v198, v212 offset:46208
v_perm_b32 v236, v211, v210, v240
v_perm_b32 v237, v211, v210, v241
v_perm_b32 v238, v211, v210, v242
v_perm_b32 v239, v211, v210, v243
v_mfma_f32_16x16x32_bf16 v[124:127], v[232:235], a[232:235], v[124:127]
ds_read_u16 v199, v214 offset:46208
ds_read_u16 v200, v212 offset:46848
ds_read_u16 v201, v214 offset:46848
v_mfma_f32_16x16x32_bf16 v[120:123], v[236:239], a[232:235], v[120:123]
s_waitcnt lgkmcnt(14)
v_perm_b32 v232, v193, v192, v240
v_perm_b32 v233, v193, v192, v241
v_perm_b32 v234, v193, v192, v242
v_perm_b32 v235, v193, v192, v243
v_mfma_f32_16x16x32_bf16 v[124:127], v[236:239], a[236:239], v[124:127]
s_nop 0
s_waitcnt lgkmcnt(8)
v_mfma_f32_16x16x32_bf16 v[144:147], v[232:235], a[192:195], 0
s_waitcnt lgkmcnt(6)
s_waitcnt vmcnt(16)
ds_read_u16 v202, v212 offset:44296
ds_read_u16 v203, v214 offset:44296
v_perm_b32 v236, v195, v194, v240
v_perm_b32 v237, v195, v194, v241
v_perm_b32 v238, v195, v194, v242
v_perm_b32 v239, v195, v194, v243
v_mfma_f32_16x16x32_bf16 v[148:151], v[232:235], a[196:199], 0
ds_read_b128 a[216:219], v244 offset:1936
ds_read_b128 a[220:223], v244 offset:2096
ds_read_b128 a[224:227], v244 offset:2256
v_mfma_f32_16x16x32_bf16 v[144:147], v[236:239], a[196:199], v[144:147]
s_waitcnt lgkmcnt(9)
ds_read_b128 a[228:231], v244 offset:2416
v_perm_b32 v232, v197, v196, v240
v_perm_b32 v233, v197, v196, v241
v_perm_b32 v234, v197, v196, v242
v_perm_b32 v235, v197, v196, v243
v_mfma_f32_16x16x32_bf16 v[148:151], v[236:239], a[200:203], v[148:151]
ds_read_b128 a[232:235], v244 offset:2576
ds_read_b128 a[236:239], v244 offset:2736
ds_read_u16 v204, v212 offset:44936
v_mfma_f32_16x16x32_bf16 v[144:147], v[232:235], a[200:203], v[144:147]
s_waitcnt lgkmcnt(11)
ds_read_u16 v205, v214 offset:44936
v_perm_b32 v236, v199, v198, v240
v_perm_b32 v237, v199, v198, v241
v_perm_b32 v238, v199, v198, v242
v_perm_b32 v239, v199, v198, v243
v_mfma_f32_16x16x32_bf16 v[148:151], v[232:235], a[204:207], v[148:151]
ds_read_u16 v206, v212 offset:45576
ds_read_u16 v207, v214 offset:45576
ds_write_b64 v245, a[96:97] offset:30992
v_mfma_f32_16x16x32_bf16 v[144:147], v[236:239], a[204:207], v[144:147]
s_waitcnt lgkmcnt(13)
ds_read_u16 v208, v212 offset:46216
v_perm_b32 v232, v201, v200, v240
v_perm_b32 v233, v201, v200, v241
v_perm_b32 v234, v201, v200, v242
v_perm_b32 v235, v201, v200, v243
v_mfma_f32_16x16x32_bf16 v[148:151], v[236:239], a[208:211], v[148:151]
ds_read_u16 v209, v214 offset:46216
ds_read_u16 v210, v212 offset:46856
ds_read_u16 v211, v214 offset:46856
ds_write_b64 v245, a[98:99] offset:32928
v_mfma_f32_16x16x32_bf16 v[144:147], v[232:235], a[208:211], v[144:147]
s_waitcnt lgkmcnt(15)
ds_write_b64 v245, a[100:101] offset:31056
v_perm_b32 v236, v203, v202, v240
v_perm_b32 v237, v203, v202, v241
v_perm_b32 v238, v203, v202, v242
v_perm_b32 v239, v203, v202, v243
v_mfma_f32_16x16x32_bf16 v[148:151], v[232:235], a[212:215], v[148:151]
ds_write_b64 v245, a[102:103] offset:32992
ds_write_b64 v245, a[104:105] offset:31152
ds_write_b64 v245, a[106:107] offset:33088
buffer_store_dwordx4 v[0:3], v253, s[20:23], s41 offen offset:0
buffer_store_dwordx4 v[4:7], v253, s[20:23], s41 offen offset:768
s_waitcnt lgkmcnt(14)
v_mfma_f32_16x16x32_bf16 v[152:155], v[236:239], a[216:219], 0
s_waitcnt lgkmcnt(12)
ds_read_u16 v192, v213 offset:44288
ds_read_u16 v193, v215 offset:44288
v_perm_b32 v232, v205, v204, v240
v_perm_b32 v233, v205, v204, v241
v_perm_b32 v234, v205, v204, v242
v_perm_b32 v235, v205, v204, v243
v_mfma_f32_16x16x32_bf16 v[156:159], v[236:239], a[220:223], 0
ds_read_b128 a[192:195], v244 offset:3872
ds_read_b128 a[196:199], v244 offset:4032
ds_read_b128 a[200:203], v244 offset:4192
s_cmp_eq_u32 s31, 0
s_cbranch_scc0 L_noresn2
ds_read_b128 a[64:67], v251 offset:0
ds_read_b128 a[68:71], v251 offset:16
ds_read_b128 a[72:75], v251 offset:1936
ds_read_b128 a[76:79], v251 offset:1952
ds_read_b128 a[80:83], v251 offset:15504
ds_read_b128 a[84:87], v251 offset:15520
ds_read_b128 a[88:91], v251 offset:17440
ds_read_b128 a[92:95], v251 offset:17456
L_noresn2:
v_mfma_f32_16x16x32_bf16 v[152:155], v[232:235], a[220:223], v[152:155]
s_waitcnt lgkmcnt(15)
ds_read_b128 a[204:207], v244 offset:4352
v_perm_b32 v236, v207, v206, v240
v_perm_b32 v237, v207, v206, v241
v_perm_b32 v238, v207, v206, v242
v_perm_b32 v239, v207, v206, v243
v_mfma_f32_16x16x32_bf16 v[156:159], v[232:235], a[224:227], v[156:159]
ds_read_b128 a[208:211], v244 offset:4512
ds_read_b128 a[212:215], v244 offset:4672
ds_read_u16 v194, v213 offset:44928
v_mfma_f32_16x16x32_bf16 v[152:155], v[236:239], a[224:227], v[152:155]
s_waitcnt lgkmcnt(15)
ds_read_u16 v195, v215 offset:44928
v_perm_b32 v232, v209, v208, v240
v_perm_b32 v233, v209, v208, v241
v_perm_b32 v234, v209, v208, v242
v_perm_b32 v235, v209, v208, v243
v_mfma_f32_16x16x32_bf16 v[156:159], v[236:239], a[228:231], v[156:159]
ds_read_u16 v196, v213 offset:45568
ds_read_u16 v197, v215 offset:45568
ds_write_b64 v245, a[108:109] offset:31216
v_mfma_f32_16x16x32_bf16 v[152:155], v[232:235], a[228:231], v[152:155]
s_waitcnt lgkmcnt(15)
ds_read_u16 v198, v213 offset:46208
v_perm_b32 v236, v211, v210, v240
v_perm_b32 v237, v211, v210, v241
v_perm_b32 v238, v211, v210, v242
v_perm_b32 v239, v211, v210, v243
v_mfma_f32_16x16x32_bf16 v[156:159], v[232:235], a[232:235], v[156:159]
ds_read_u16 v199, v215 offset:46208
ds_read_u16 v200, v213 offset:46848
ds_read_u16 v201, v215 offset:46848
ds_write_b64 v245, a[110:111] offset:33152
v_mfma_f32_16x16x32_bf16 v[152:155], v[236:239], a[232:235], v[152:155]
s_waitcnt lgkmcnt(15)
ds_write_b64 v245, a[112:113] offset:31312
v_perm_b32 v232, v193, v192, v240
v_perm_b32 v233, v193, v192, v241
v_perm_b32 v234, v193, v192, v242
v_perm_b32 v235, v193, v192, v243
v_mfma_f32_16x16x32_bf16 v[156:159], v[236:239], a[236:239], v[156:159]
ds_write_b64 v245, a[114:115] offset:33248
ds_write_b64 v245, a[116:117] offset:31376
buffer_store_dwordx4 v[8:11], v253, s[20:23], s41 offen offset:1536
buffer_store_dwordx4 v[12:15], v253, s[20:23], s41 offen offset:2304
s_waitcnt lgkmcnt(13)
v_mfma_f32_16x16x32_bf16 v[176:179], v[232:235], a[192:195], 0
s_waitcnt lgkmcnt(11)
ds_read_u16 v202, v213 offset:44296
ds_read_u16 v203, v215 offset:44296
v_perm_b32 v236, v195, v194, v240
v_perm_b32 v237, v195, v194, v241
v_perm_b32 v238, v195, v194, v242
v_perm_b32 v239, v195, v194, v243
v_mfma_f32_16x16x32_bf16 v[180:183], v[232:235], a[196:199], 0
ds_read_b128 a[216:219], v244 offset:5808
ds_read_b128 a[220:223], v244 offset:5968
ds_read_b128 a[224:227], v244 offset:6128
v_mfma_f32_16x16x32_bf16 v[176:179], v[236:239], a[196:199], v[176:179]
s_waitcnt lgkmcnt(14)
ds_read_b128 a[228:231], v244 offset:6288
v_perm_b32 v232, v197, v196, v240
v_perm_b32 v233, v197, v196, v241
v_perm_b32 v234, v197, v196, v242
v_perm_b32 v235, v197, v196, v243
v_mfma_f32_16x16x32_bf16 v[180:183], v[236:239], a[200:203], v[180:183]
ds_read_b128 a[232:235], v244 offset:6448
ds_read_b128 a[236:239], v244 offset:6608
ds_read_u16 v204, v213 offset:44936
v_mfma_f32_16x16x32_bf16 v[176:179], v[232:235], a[200:203], v[176:179]
s_waitcnt lgkmcnt(15)
ds_read_u16 v205, v215 offset:44936
v_perm_b32 v236, v199, v198, v240
v_perm_b32 v237, v199, v198, v241
v_perm_b32 v238, v199, v198, v242
v_perm_b32 v239, v199, v198, v243
v_mfma_f32_16x16x32_bf16 v[180:183], v[232:235], a[204:207], v[180:183]
ds_read_u16 v206, v213 offset:45576
ds_read_u16 v207, v215 offset:45576
ds_write_b64 v245, a[118:119] offset:33312
v_mfma_f32_16x16x32_bf16 v[176:179], v[236:239], a[204:207], v[176:179]
s_waitcnt lgkmcnt(15)
ds_read_u16 v208, v213 offset:46216
v_perm_b32 v232, v201, v200, v240
v_perm_b32 v233, v201, v200, v241
v_perm_b32 v234, v201, v200, v242
v_perm_b32 v235, v201, v200, v243
v_mfma_f32_16x16x32_bf16 v[180:183], v[236:239], a[208:211], v[180:183]
ds_read_u16 v209, v215 offset:46216
ds_read_u16 v210, v213 offset:46856
ds_read_u16 v211, v215 offset:46856
ds_write_b64 v246, a[120:121] offset:30992
v_mfma_f32_16x16x32_bf16 v[176:179], v[232:235], a[208:211], v[176:179]
s_waitcnt lgkmcnt(15)
ds_write_b64 v246, a[122:123] offset:32928
v_perm_b32 v236, v203, v202, v240
v_perm_b32 v237, v203, v202, v241
v_perm_b32 v238, v203, v202, v242
v_perm_b32 v239, v203, v202, v243
v_mfma_f32_16x16x32_bf16 v[180:183], v[232:235], a[212:215], v[180:183]
s_mov_b64 exec, 0xffffffff
ds_write_b64 v246, a[124:125] offset:31312
s_mov_b64 exec, -1
s_mov_b64 exec, 0xffffffff
ds_write_b64 v246, a[126:127] offset:33248
s_mov_b64 exec, -1
buffer_store_dwordx4 v[32:35], v247, s[20:23], s41 offen offset:0
buffer_store_dwordx4 v[36:39], v247, s[20:23], s41 offen offset:768
s_waitcnt lgkmcnt(0)
s_barrier
v_mfma_f32_16x16x32_bf16 v[184:187], v[236:239], a[216:219], 0
ds_read_u16 v192, v212 offset:48384
ds_read_u16 v193, v214 offset:48384
v_perm_b32 v232, v205, v204, v240
v_perm_b32 v233, v205, v204, v241
v_perm_b32 v234, v205, v204, v242
v_perm_b32 v235, v205, v204, v243
v_mfma_f32_16x16x32_bf16 v[188:191], v[236:239], a[220:223], 0
ds_read_b128 a[192:195], v244 offset:30992
ds_read_b128 a[196:199], v244 offset:31152
ds_read_b128 a[200:203], v244 offset:31312
v_mfma_f32_16x16x32_bf16 v[184:187], v[232:235], a[220:223], v[184:187]
ds_read_b128 a[204:207], v244 offset:31472
v_perm_b32 v236, v207, v206, v240
v_perm_b32 v237, v207, v206, v241
v_perm_b32 v238, v207, v206, v242
v_perm_b32 v239, v207, v206, v243
v_mfma_f32_16x16x32_bf16 v[188:191], v[232:235], a[224:227], v[188:191]
ds_read_b128 a[208:211], v244 offset:31632
ds_read_b128 a[212:215], v244 offset:31792
ds_read_u16 v194, v212 offset:49024
v_mfma_f32_16x16x32_bf16 v[184:187], v[236:239], a[224:227], v[184:187]
ds_read_u16 v195, v214 offset:49024
v_perm_b32 v232, v209, v208, v240
v_perm_b32 v233, v209, v208, v241
v_perm_b32 v234, v209, v208, v242
v_perm_b32 v235, v209, v208, v243
v_mfma_f32_16x16x32_bf16 v[188:191], v[236:239], a[228:231], v[188:191]
ds_read_u16 v196, v212 offset:49664
ds_read_u16 v197, v214 offset:49664
v_mfma_f32_16x16x32_bf16 v[184:187], v[232:235], a[228:231], v[184:187]
ds_read_u16 v198, v212 offset:50304
v_perm_b32 v236, v211, v210, v240
v_perm_b32 v237, v211, v210, v241
v_perm_b32 v238, v211, v210, v242
v_perm_b32 v239, v211, v210, v243
v_mfma_f32_16x16x32_bf16 v[188:191], v[232:235], a[232:235], v[188:191]
ds_read_u16 v199, v214 offset:50304
ds_read_u16 v200, v212 offset:50944
ds_read_u16 v201, v214 offset:50944
v_mfma_f32_16x16x32_bf16 v[184:187], v[236:239], a[232:235], v[184:187]
s_waitcnt lgkmcnt(14)
v_perm_b32 v232, v193, v192, v240
v_perm_b32 v233, v193, v192, v241
v_perm_b32 v234, v193, v192, v242
v_perm_b32 v235, v193, v192, v243
v_mfma_f32_16x16x32_bf16 v[188:191], v[236:239], a[236:239], v[188:191]
buffer_store_dwordx4 v[40:43], v247, s[20:23], s41 offen offset:1536
buffer_store_dwordx4 v[44:47], v247, s[20:23], s41 offen offset:2304
s_waitcnt lgkmcnt(8)
v_mfma_f32_16x16x32_bf16 v[0:3], v[232:235], a[192:195], 0
s_waitcnt lgkmcnt(6)
s_waitcnt vmcnt(8)
ds_read_u16 v202, v212 offset:48392
ds_read_u16 v203, v214 offset:48392
v_perm_b32 v236, v195, v194, v240
v_perm_b32 v237, v195, v194, v241
v_perm_b32 v238, v195, v194, v242
v_perm_b32 v239, v195, v194, v243
v_mfma_f32_16x16x32_bf16 v[4:7], v[232:235], a[196:199], 0
ds_read_b128 a[216:219], v244 offset:32928
ds_read_b128 a[220:223], v244 offset:33088
ds_read_b128 a[224:227], v244 offset:33248
v_mfma_f32_16x16x32_bf16 v[0:3], v[236:239], a[196:199], v[0:3]
s_waitcnt lgkmcnt(9)
ds_read_b128 a[228:231], v244 offset:33408
v_perm_b32 v232, v197, v196, v240
v_perm_b32 v233, v197, v196, v241
v_perm_b32 v234, v197, v196, v242
v_perm_b32 v235, v197, v196, v243
v_mfma_f32_16x16x32_bf16 v[4:7], v[236:239], a[200:203], v[4:7]
ds_read_b128 a[232:235], v244 offset:33568
ds_read_b128 a[236:239], v244 offset:33728
ds_read_u16 v204, v212 offset:49032
v_mfma_f32_16x16x32_bf16 v[0:3], v[232:235], a[200:203], v[0:3]
s_waitcnt lgkmcnt(11)
ds_read_u16 v205, v214 offset:49032
v_perm_b32 v236, v199, v198, v240
v_perm_b32 v237, v199, v198, v241
v_perm_b32 v238, v199, v198, v242
v_perm_b32 v239, v199, v198, v243
v_mfma_f32_16x16x32_bf16 v[4:7], v[232:235], a[204:207], v[4:7]
ds_read_u16 v206, v212 offset:49672
ds_read_u16 v207, v214 offset:49672
ds_write_b64 v245, a[128:129] offset:0
v_mfma_f32_16x16x32_bf16 v[0:3], v[236:239], a[204:207], v[0:3]
s_waitcnt lgkmcnt(13)
ds_read_u16 v208, v212 offset:50312
v_perm_b32 v232, v201, v200, v240
v_perm_b32 v233, v201, v200, v241
v_perm_b32 v234, v201, v200, v242
v_perm_b32 v235, v201, v200, v243
v_mfma_f32_16x16x32_bf16 v[4:7], v[236:239], a[208:211], v[4:7]
ds_read_u16 v209, v214 offset:50312
ds_read_u16 v210, v212 offset:50952
ds_read_u16 v211, v214 offset:50952
ds_write_b64 v245, a[130:131] offset:1936
v_mfma_f32_16x16x32_bf16 v[0:3], v[232:235], a[208:211], v[0:3]
s_waitcnt lgkmcnt(15)
ds_write_b64 v245, a[132:133] offset:64
v_perm_b32 v236, v203, v202, v240
v_perm_b32 v237, v203, v202, v241
v_perm_b32 v238, v203, v202, v242
v_perm_b32 v239, v203, v202, v243
v_mfma_f32_16x16x32_bf16 v[4:7], v[232:235], a[212:215], v[4:7]
ds_write_b64 v245, a[134:135] offset:2000
ds_write_b64 v245, a[136:137] offset:160
ds_write_b64 v245, a[138:139] offset:2096
buffer_store_dwordx4 v[64:67], v253, s[20:23], s41 offen offset:128
buffer_store_dwordx4 v[68:71], v253, s[20:23], s41 offen offset:896
s_waitcnt lgkmcnt(14)
v_mfma_f32_16x16x32_bf16 v[8:11], v[236:239], a[216:219], 0
s_waitcnt lgkmcnt(12)
ds_read_u16 v192, v213 offset:48384
ds_read_u16 v193, v215 offset:48384
v_perm_b32 v232, v205, v204, v240
v_perm_b32 v233, v205, v204, v241
v_perm_b32 v234, v205, v204, v242
v_perm_b32 v235, v205, v204, v243
v_mfma_f32_16x16x32_bf16 v[12:15], v[236:239], a[220:223], 0
ds_read_b128 a[192:195], v244 offset:34864
ds_read_b128 a[196:199], v244 offset:35024
ds_read_b128 a[200:203], v244 offset:35184
s_cmp_eq_u32 s31, 1
s_cbranch_scc0 L_noresn3
ds_read_b128 a[0:3], v251 offset:30992
ds_read_b128 a[4:7], v251 offset:31008
ds_read_b128 a[8:11], v251 offset:32928
ds_read_b128 a[12:15], v251 offset:32944
ds_read_b128 a[16:19], v251 offset:46496
ds_read_b128 a[20:23], v251 offset:46512
ds_read_b128 a[24:27], v251 offset:48432
ds_read_b128 a[28:31], v251 offset:48448
L_noresn3:
v_mfma_f32_16x16x32_bf16 v[8:11], v[232:235], a[220:223], v[8:11]
s_waitcnt lgkmcnt(15)
ds_read_b128 a[204:207], v244 offset:35344
v_perm_b32 v236, v207, v206, v240
v_perm_b32 v237, v207, v206, v241
v_perm_b32 v238, v207, v206, v242
v_perm_b32 v239, v207, v206, v243
v_mfma_f32_16x16x32_bf16 v[12:15], v[232:235], a[224:227], v[12:15]
ds_read_b128 a[208:211], v244 offset:35504
ds_read_b128 a[212:215], v244 offset:35664
ds_read_u16 v194, v213 offset:49024
v_mfma_f32_16x16x32_bf16 v[8:11], v[236:239], a[224:227], v[8:11]
s_waitcnt lgkmcnt(15)
ds_read_u16 v195, v215 offset:49024
v_perm_b32 v232, v209, v208, v240
v_perm_b32 v233, v209, v208, v241
v_perm_b32 v234, v209, v208, v242
v_perm_b32 v235, v209, v208, v243
v_mfma_f32_16x16x32_bf16 v[12:15], v[236:239], a[228:231], v[12:15]
ds_read_u16 v196, v213 offset:49664
ds_read_u16 v197, v215 offset:49664
ds_write_b64 v245, a[140:141] offset:224
v_mfma_f32_16x16x32_bf16 v[8:11], v[232:235], a[228:231], v[8:11]
s_waitcnt lgkmcnt(15)
ds_read_u16 v198, v213 offset:50304
v_perm_b32 v236, v211, v210, v240
v_perm_b32 v237, v211, v210, v241
v_perm_b32 v238, v211, v210, v242
v_perm_b32 v239, v211, v210, v243
v_mfma_f32_16x16x32_bf16 v[12:15], v[232:235], a[232:235], v[12:15]
ds_read_u16 v199, v215 offset:50304
ds_read_u16 v200, v213 offset:50944
ds_read_u16 v201, v215 offset:50944
ds_write_b64 v245, a[142:143] offset:2160
v_mfma_f32_16x16x32_bf16 v[8:11], v[236:239], a[232:235], v[8:11]
s_waitcnt lgkmcnt(15)
ds_write_b64 v245, a[144:145] offset:320
v_perm_b32 v232, v193, v192, v240
v_perm_b32 v233, v193, v192, v241
v_perm_b32 v234, v193, v192, v242
v_perm_b32 v235, v193, v192, v243
v_mfma_f32_16x16x32_bf16 v[12:15], v[236:239], a[236:239], v[12:15]
ds_write_b64 v245, a[146:147] offset:2256
ds_write_b64 v245, a[148:149] offset:384
buffer_store_dwordx4 v[72:75], v253, s[20:23], s41 offen offset:1664
buffer_store_dwordx4 v[76:79], v253, s[20:23], s41 offen offset:2432
s_waitcnt lgkmcnt(13)
v_mfma_f32_16x16x32_bf16 v[32:35], v[232:235], a[192:195], 0
s_waitcnt lgkmcnt(11)
ds_read_u16 v202, v213 offset:48392
ds_read_u16 v203, v215 offset:48392
v_perm_b32 v236, v195, v194, v240
v_perm_b32 v237, v195, v194, v241
v_perm_b32 v238, v195, v194, v242
v_perm_b32 v239, v195, v194, v243
v_mfma_f32_16x16x32_bf16 v[36:39], v[232:235], a[196:199], 0
ds_read_b128 a[216:219], v244 offset:36800
ds_read_b128 a[220:223], v244 offset:36960
ds_read_b128 a[224:227], v244 offset:37120
v_mfma_f32_16x16x32_bf16 v[32:35], v[236:239], a[196:199], v[32:35]
s_waitcnt lgkmcnt(14)
ds_read_b128 a[228:231], v244 offset:37280
v_perm_b32 v232, v197, v196, v240
v_perm_b32 v233, v197, v196, v241
v_perm_b32 v234, v197, v196, v242
v_perm_b32 v235, v197, v196, v243
v_mfma_f32_16x16x32_bf16 v[36:39], v[236:239], a[200:203], v[36:39]
ds_read_b128 a[232:235], v244 offset:37440
ds_read_b128 a[236:239], v244 offset:37600
ds_read_u16 v204, v213 offset:49032
v_mfma_f32_16x16x32_bf16 v[32:35], v[232:235], a[200:203], v[32:35]
s_waitcnt lgkmcnt(15)
ds_read_u16 v205, v215 offset:49032
v_perm_b32 v236, v199, v198, v240
v_perm_b32 v237, v199, v198, v241
v_perm_b32 v238, v199, v198, v242
v_perm_b32 v239, v199, v198, v243
v_mfma_f32_16x16x32_bf16 v[36:39], v[232:235], a[204:207], v[36:39]
ds_read_u16 v206, v213 offset:49672
ds_read_u16 v207, v215 offset:49672
ds_write_b64 v245, a[150:151] offset:2320
v_mfma_f32_16x16x32_bf16 v[32:35], v[236:239], a[204:207], v[32:35]
s_waitcnt lgkmcnt(15)
ds_read_u16 v208, v213 offset:50312
v_perm_b32 v232, v201, v200, v240
v_perm_b32 v233, v201, v200, v241
v_perm_b32 v234, v201, v200, v242
v_perm_b32 v235, v201, v200, v243
v_mfma_f32_16x16x32_bf16 v[36:39], v[236:239], a[208:211], v[36:39]
ds_read_u16 v209, v215 offset:50312
ds_read_u16 v210, v213 offset:50952
ds_read_u16 v211, v215 offset:50952
ds_write_b64 v246, a[152:153] offset:0
v_mfma_f32_16x16x32_bf16 v[32:35], v[232:235], a[208:211], v[32:35]
s_waitcnt lgkmcnt(15)
ds_write_b64 v246, a[154:155] offset:1936
v_perm_b32 v236, v203, v202, v240
v_perm_b32 v237, v203, v202, v241
v_perm_b32 v238, v203, v202, v242
v_perm_b32 v239, v203, v202, v243
v_mfma_f32_16x16x32_bf16 v[36:39], v[232:235], a[212:215], v[36:39]
s_mov_b64 exec, 0xffffffff
ds_write_b64 v246, a[156:157] offset:320
s_mov_b64 exec, -1
s_mov_b64 exec, 0xffffffff
ds_write_b64 v246, a[158:159] offset:2256
s_mov_b64 exec, -1
buffer_store_dwordx4 v[96:99], v247, s[20:23], s41 offen offset:128
buffer_store_dwordx4 v[100:103], v247, s[20:23], s41 offen offset:896
s_waitcnt lgkmcnt(0)
s_barrier
v_mfma_f32_16x16x32_bf16 v[40:43], v[236:239], a[216:219], 0
ds_read_u16 v192, v212 offset:0
ds_read_u16 v193, v214 offset:0
v_perm_b32 v232, v205, v204, v240
v_perm_b32 v233, v205, v204, v241
v_perm_b32 v234, v205, v204, v242
v_perm_b32 v235, v205, v204, v243
v_mfma_f32_16x16x32_bf16 v[44:47], v[236:239], a[220:223], 0
ds_read_b128 a[192:195], v244 offset:0
ds_read_b128 a[196:199], v244 offset:160
ds_read_b128 a[200:203], v244 offset:320
v_mfma_f32_16x16x32_bf16 v[40:43], v[232:235], a[220:223], v[40:43]
ds_read_b128 a[204:207], v244 offset:480
v_perm_b32 v236, v207, v206, v240
v_perm_b32 v237, v207, v206, v241
v_perm_b32 v238, v207, v206, v242
v_perm_b32 v239, v207, v206, v243
v_mfma_f32_16x16x32_bf16 v[44:47], v[232:235], a[224:227], v[44:47]
ds_read_b128 a[208:211], v244 offset:640
ds_read_b128 a[212:215], v244 offset:800
ds_read_u16 v194, v212 offset:640
v_mfma_f32_16x16x32_bf16 v[40:43], v[236:239], a[224:227], v[40:43]
ds_read_u16 v195, v214 offset:640
v_perm_b32 v232, v209, v208, v240
v_perm_b32 v233, v209, v208, v241
v_perm_b32 v234, v209, v208, v242
v_perm_b32 v235, v209, v208, v243
v_mfma_f32_16x16x32_bf16 v[44:47], v[236:239], a[228:231], v[44:47]
ds_read_u16 v196, v212 offset:1280
ds_read_u16 v197, v214 offset:1280
v_mfma_f32_16x16x32_bf16 v[40:43], v[232:235], a[228:231], v[40:43]
ds_read_u16 v198, v212 offset:1920
v_perm_b32 v236, v211, v210, v240
v_perm_b32 v237, v211, v210, v241
v_perm_b32 v238, v211, v210, v242
v_perm_b32 v239, v211, v210, v243
v_mfma_f32_16x16x32_bf16 v[44:47], v[232:235], a[232:235], v[44:47]
ds_read_u16 v199, v214 offset:1920
ds_read_u16 v200, v212 offset:2560
ds_read_u16 v201, v214 offset:2560
v_mfma_f32_16x16x32_bf16 v[40:43], v[236:239], a[232:235], v[40:43]
s_waitcnt lgkmcnt(14)
v_perm_b32 v232, v193, v192, v240
v_perm_b32 v233, v193, v192, v241
v_perm_b32 v234, v193, v192, v242
v_perm_b32 v235, v193, v192, v243
v_mfma_f32_16x16x32_bf16 v[44:47], v[236:239], a[236:239], v[44:47]
buffer_store_dwordx4 v[104:107], v247, s[20:23], s41 offen offset:1664
buffer_store_dwordx4 v[108:111], v247, s[20:23], s41 offen offset:2432
s_waitcnt lgkmcnt(8)
v_mfma_f32_16x16x32_bf16 v[64:67], v[232:235], a[192:195], 0
s_waitcnt lgkmcnt(6)
ds_read_u16 v202, v212 offset:8
ds_read_u16 v203, v214 offset:8
v_perm_b32 v236, v195, v194, v240
v_perm_b32 v237, v195, v194, v241
v_perm_b32 v238, v195, v194, v242
v_perm_b32 v239, v195, v194, v243
v_mfma_f32_16x16x32_bf16 v[68:71], v[232:235], a[196:199], 0
ds_read_b128 a[216:219], v244 offset:1936
ds_read_b128 a[220:223], v244 offset:2096
ds_read_b128 a[224:227], v244 offset:2256
v_mfma_f32_16x16x32_bf16 v[64:67], v[236:239], a[196:199], v[64:67]
s_waitcnt lgkmcnt(9)
ds_read_b128 a[228:231], v244 offset:2416
v_perm_b32 v232, v197, v196, v240
v_perm_b32 v233, v197, v196, v241
v_perm_b32 v234, v197, v196, v242
v_perm_b32 v235, v197, v196, v243
v_mfma_f32_16x16x32_bf16 v[68:71], v[236:239], a[200:203], v[68:71]
ds_read_b128 a[232:235], v244 offset:2576
ds_read_b128 a[236:239], v244 offset:2736
ds_read_u16 v204, v212 offset:648
v_mfma_f32_16x16x32_bf16 v[64:67], v[232:235], a[200:203], v[64:67]
s_waitcnt lgkmcnt(11)
ds_read_u16 v205, v214 offset:648
v_perm_b32 v236, v199, v198, v240
v_perm_b32 v237, v199, v198, v241
v_perm_b32 v238, v199, v198, v242
v_perm_b32 v239, v199, v198, v243
v_mfma_f32_16x16x32_bf16 v[68:71], v[232:235], a[204:207], v[68:71]
ds_read_u16 v206, v212 offset:1288
ds_read_u16 v207, v214 offset:1288
ds_write_b64 v245, a[160:161] offset:30992
v_mfma_f32_16x16x32_bf16 v[64:67], v[236:239], a[204:207], v[64:67]
s_waitcnt lgkmcnt(13)
ds_read_u16 v208, v212 offset:1928
v_perm_b32 v232, v201, v200, v240
v_perm_b32 v233, v201, v200, v241
v_perm_b32 v234, v201, v200, v242
v_perm_b32 v235, v201, v200, v243
v_mfma_f32_16x16x32_bf16 v[68:71], v[236:239], a[208:211], v[68:71]
ds_read_u16 v209, v214 offset:1928
ds_read_u16 v210, v212 offset:2568
ds_read_u16 v211, v214 offset:2568
ds_write_b64 v245, a[162:163] offset:32928
v_mfma_f32_16x16x32_bf16 v[64:67], v[232:235], a[208:211], v[64:67]
s_waitcnt lgkmcnt(15)
ds_write_b64 v245, a[164:165] offset:31056
v_perm_b32 v236, v203, v202, v240
v_perm_b32 v237, v203, v202, v241
v_perm_b32 v238, v203, v202, v242
v_perm_b32 v239, v203, v202, v243
v_mfma_f32_16x16x32_bf16 v[68:71], v[232:235], a[212:215], v[68:71]
ds_write_b64 v245, a[166:167] offset:32992
ds_write_b64 v245, a[168:169] offset:31152
ds_write_b64 v245, a[170:171] offset:33088
buffer_store_dwordx4 v[128:131], v253, s[20:23], s41 offen offset:256
buffer_store_dwordx4 v[132:135], v253, s[20:23], s41 offen offset:1024
s_waitcnt lgkmcnt(14)
v_mfma_f32_16x16x32_bf16 v[72:75], v[236:239], a[216:219], 0
s_waitcnt lgkmcnt(12)
ds_read_u16 v192, v213 offset:0
ds_read_u16 v193, v215 offset:0
v_perm_b32 v232, v205, v204, v240
v_perm_b32 v233, v205, v204, v241
v_perm_b32 v234, v205, v204, v242
v_perm_b32 v235, v205, v204, v243
v_mfma_f32_16x16x32_bf16 v[76:79], v[236:239], a[220:223], 0
ds_read_b128 a[192:195], v244 offset:3872
ds_read_b128 a[196:199], v244 offset:4032
ds_read_b128 a[200:203], v244 offset:4192
s_cmp_eq_u32 s31, 1
s_cbranch_scc0 L_noresn4
ds_read_b128 a[32:35], v251 offset:0
ds_read_b128 a[36:39], v251 offset:16
ds_read_b128 a[40:43], v251 offset:1936
ds_read_b128 a[44:47], v251 offset:1952
ds_read_b128 a[48:51], v251 offset:15504
ds_read_b128 a[52:55], v251 offset:15520
ds_read_b128 a[56:59], v251 offset:17440
ds_read_b128 a[60:63], v251 offset:17456
L_noresn4:
v_mfma_f32_16x16x32_bf16 v[72:75], v[232:235], a[220:223], v[72:75]
s_waitcnt lgkmcnt(15)
ds_read_b128 a[204:207], v244 offset:4352
v_perm_b32 v236, v207, v206, v240
v_perm_b32 v237, v207, v206, v241
v_perm_b32 v238, v207, v206, v242
v_perm_b32 v239, v207, v206, v243
v_mfma_f32_16x16x32_bf16 v[76:79], v[232:235], a[224:227], v[76:79]
ds_read_b128 a[208:211], v244 offset:4512
ds_read_b128 a[212:215], v244 offset:4672
ds_read_u16 v194, v213 offset:640
v_mfma_f32_16x16x32_bf16 v[72:75], v[236:239], a[224:227], v[72:75]
s_waitcnt lgkmcnt(15)
ds_read_u16 v195, v215 offset:640
v_perm_b32 v232, v209, v208, v240
v_perm_b32 v233, v209, v208, v241
v_perm_b32 v234, v209, v208, v242
v_perm_b32 v235, v209, v208, v243
v_mfma_f32_16x16x32_bf16 v[76:79], v[236:239], a[228:231], v[76:79]
ds_read_u16 v196, v213 offset:1280
ds_read_u16 v197, v215 offset:1280
ds_write_b64 v245, a[172:173] offset:31216
v_mfma_f32_16x16x32_bf16 v[72:75], v[232:235], a[228:231], v[72:75]
s_waitcnt lgkmcnt(15)
ds_read_u16 v198, v213 offset:1920
v_perm_b32 v236, v211, v210, v240
v_perm_b32 v237, v211, v210, v241
v_perm_b32 v238, v211, v210, v242
v_perm_b32 v239, v211, v210, v243
v_mfma_f32_16x16x32_bf16 v[76:79], v[232:235], a[232:235], v[76:79]
ds_read_u16 v199, v215 offset:1920
ds_read_u16 v200, v213 offset:2560
ds_read_u16 v201, v215 offset:2560
ds_write_b64 v245, a[174:175] offset:33152
v_mfma_f32_16x16x32_bf16 v[72:75], v[236:239], a[232:235], v[72:75]
s_waitcnt lgkmcnt(15)
ds_write_b64 v245, a[176:177] offset:31312
v_perm_b32 v232, v193, v192, v240
v_perm_b32 v233, v193, v192, v241
v_perm_b32 v234, v193, v192, v242
v_perm_b32 v235, v193, v192, v243
v_mfma_f32_16x16x32_bf16 v[76:79], v[236:239], a[236:239], v[76:79]
ds_write_b64 v245, a[178:179] offset:33248
ds_write_b64 v245, a[180:181] offset:31376
buffer_store_dwordx4 v[136:139], v253, s[20:23], s41 offen offset:1792
buffer_store_dwordx4 v[140:143], v253, s[20:23], s41 offen offset:2560
s_waitcnt lgkmcnt(13)
v_mfma_f32_16x16x32_bf16 v[96:99], v[232:235], a[192:195], 0
s_waitcnt lgkmcnt(11)
ds_read_u16 v202, v213 offset:8
ds_read_u16 v203, v215 offset:8
v_perm_b32 v236, v195, v194, v240
v_perm_b32 v237, v195, v194, v241
v_perm_b32 v238, v195, v194, v242
v_perm_b32 v239, v195, v194, v243
v_mfma_f32_16x16x32_bf16 v[100:103], v[232:235], a[196:199], 0
ds_read_b128 a[216:219], v244 offset:5808
ds_read_b128 a[220:223], v244 offset:5968
ds_read_b128 a[224:227], v244 offset:6128
v_mfma_f32_16x16x32_bf16 v[96:99], v[236:239], a[196:199], v[96:99]
s_waitcnt lgkmcnt(14)
ds_read_b128 a[228:231], v244 offset:6288
v_perm_b32 v232, v197, v196, v240
v_perm_b32 v233, v197, v196, v241
v_perm_b32 v234, v197, v196, v242
v_perm_b32 v235, v197, v196, v243
v_mfma_f32_16x16x32_bf16 v[100:103], v[236:239], a[200:203], v[100:103]
ds_read_b128 a[232:235], v244 offset:6448
ds_read_b128 a[236:239], v244 offset:6608
ds_read_u16 v204, v213 offset:648
v_mfma_f32_16x16x32_bf16 v[96:99], v[232:235], a[200:203], v[96:99]
s_waitcnt lgkmcnt(15)
ds_read_u16 v205, v215 offset:648
v_perm_b32 v236, v199, v198, v240
v_perm_b32 v237, v199, v198, v241
v_perm_b32 v238, v199, v198, v242
v_perm_b32 v239, v199, v198, v243
v_mfma_f32_16x16x32_bf16 v[100:103], v[232:235], a[204:207], v[100:103]
ds_read_u16 v206, v213 offset:1288
ds_read_u16 v207, v215 offset:1288
ds_write_b64 v245, a[182:183] offset:33312
v_mfma_f32_16x16x32_bf16 v[96:99], v[236:239], a[204:207], v[96:99]
s_waitcnt lgkmcnt(15)
ds_read_u16 v208, v213 offset:1928
v_perm_b32 v232, v201, v200, v240
v_perm_b32 v233, v201, v200, v241
v_perm_b32 v234, v201, v200, v242
v_perm_b32 v235, v201, v200, v243
v_mfma_f32_16x16x32_bf16 v[100:103], v[236:239], a[208:211], v[100:103]
ds_read_u16 v209, v215 offset:1928
ds_read_u16 v210, v213 offset:2568
ds_read_u16 v211, v215 offset:2568
ds_write_b64 v246, a[184:185] offset:30992
v_mfma_f32_16x16x32_bf16 v[96:99], v[232:235], a[208:211], v[96:99]
s_waitcnt lgkmcnt(15)
ds_write_b64 v246, a[186:187] offset:32928
v_perm_b32 v236, v203, v202, v240
v_perm_b32 v237, v203, v202, v241
v_perm_b32 v238, v203, v202, v242
v_perm_b32 v239, v203, v202, v243
v_mfma_f32_16x16x32_bf16 v[100:103], v[232:235], a[212:215], v[100:103]
s_mov_b64 exec, 0xffffffff
ds_write_b64 v246, a[188:189] offset:31312
s_mov_b64 exec, -1
s_mov_b64 exec, 0xffffffff
ds_write_b64 v246, a[190:191] offset:33248
s_mov_b64 exec, -1
buffer_store_dwordx4 v[160:163], v247, s[20:23], s41 offen offset:256
buffer_store_dwordx4 v[164:167], v247, s[20:23], s41 offen offset:1024
s_waitcnt lgkmcnt(0)
s_barrier
v_mfma_f32_16x16x32_bf16 v[104:107], v[236:239], a[216:219], 0
ds_read_u16 v192, v212 offset:4096
ds_read_u16 v193, v214 offset:4096
v_perm_b32 v232, v205, v204, v240
v_perm_b32 v233, v205, v204, v241
v_perm_b32 v234, v205, v204, v242
v_perm_b32 v235, v205, v204, v243
v_mfma_f32_16x16x32_bf16 v[108:111], v[236:239], a[220:223], 0
ds_read_b128 a[192:195], v244 offset:30992
ds_read_b128 a[196:199], v244 offset:31152
ds_read_b128 a[200:203], v244 offset:31312
v_mfma_f32_16x16x32_bf16 v[104:107], v[232:235], a[220:223], v[104:107]
ds_read_b128 a[204:207], v244 offset:31472
v_perm_b32 v236, v207, v206, v240
v_perm_b32 v237, v207, v206, v241
v_perm_b32 v238, v207, v206, v242
v_perm_b32 v239, v207, v206, v243
v_mfma_f32_16x16x32_bf16 v[108:111], v[232:235], a[224:227], v[108:111]
ds_read_b128 a[208:211], v244 offset:31632
ds_read_b128 a[212:215], v244 offset:31792
ds_read_u16 v194, v212 offset:4736
v_mfma_f32_16x16x32_bf16 v[104:107], v[236:239], a[224:227], v[104:107]
ds_read_u16 v195, v214 offset:4736
v_perm_b32 v232, v209, v208, v240
v_perm_b32 v233, v209, v208, v241
v_perm_b32 v234, v209, v208, v242
v_perm_b32 v235, v209, v208, v243
v_mfma_f32_16x16x32_bf16 v[108:111], v[236:239], a[228:231], v[108:111]
ds_read_u16 v196, v212 offset:5376
ds_read_u16 v197, v214 offset:5376
v_mfma_f32_16x16x32_bf16 v[104:107], v[232:235], a[228:231], v[104:107]
ds_read_u16 v198, v212 offset:6016
v_perm_b32 v236, v211, v210, v240
v_perm_b32 v237, v211, v210, v241
v_perm_b32 v238, v211, v210, v242
v_perm_b32 v239, v211, v210, v243
v_mfma_f32_16x16x32_bf16 v[108:111], v[232:235], a[232:235], v[108:111]
ds_read_u16 v199, v214 offset:6016
ds_read_u16 v200, v212 offset:6656
ds_read_u16 v201, v214 offset:6656
v_mfma_f32_16x16x32_bf16 v[104:107], v[236:239], a[232:235], v[104:107]
s_waitcnt lgkmcnt(14)
v_perm_b32 v232, v193, v192, v240
v_perm_b32 v233, v193, v192, v241
v_perm_b32 v234, v193, v192, v242
v_perm_b32 v235, v193, v192, v243
v_mfma_f32_16x16x32_bf16 v[108:111], v[236:239], a[236:239], v[108:111]
buffer_store_dwordx4 v[168:171], v247, s[20:23], s41 offen offset:1792
buffer_store_dwordx4 v[172:175], v247, s[20:23], s41 offen offset:2560
s_waitcnt lgkmcnt(8)
v_mfma_f32_16x16x32_bf16 v[128:131], v[232:235], a[192:195], 0
s_waitcnt lgkmcnt(6)
ds_read_u16 v202, v212 offset:4104
ds_read_u16 v203, v214 offset:4104
v_perm_b32 v236, v195, v194, v240
v_perm_b32 v237, v195, v194, v241
v_perm_b32 v238, v195, v194, v242
v_perm_b32 v239, v195, v194, v243
v_mfma_f32_16x16x32_bf16 v[132:135], v[232:235], a[196:199], 0
ds_read_b128 a[216:219], v244 offset:32928
ds_read_b128 a[220:223], v244 offset:33088
ds_read_b128 a[224:227], v244 offset:33248
v_mfma_f32_16x16x32_bf16 v[128:131], v[236:239], a[196:199], v[128:131]
s_waitcnt lgkmcnt(9)
ds_read_b128 a[228:231], v244 offset:33408
v_perm_b32 v232, v197, v196, v240
v_perm_b32 v233, v197, v196, v241
v_perm_b32 v234, v197, v196, v242
v_perm_b32 v235, v197, v196, v243
v_mfma_f32_16x16x32_bf16 v[132:135], v[236:239], a[200:203], v[132:135]
ds_read_b128 a[232:235], v244 offset:33568
ds_read_b128 a[236:239], v244 offset:33728
ds_read_u16 v204, v212 offset:4744
v_mfma_f32_16x16x32_bf16 v[128:131], v[232:235], a[200:203], v[128:131]
s_waitcnt lgkmcnt(11)
ds_read_u16 v205, v214 offset:4744
v_perm_b32 v236, v199, v198, v240
v_perm_b32 v237, v199, v198, v241
v_perm_b32 v238, v199, v198, v242
v_perm_b32 v239, v199, v198, v243
v_mfma_f32_16x16x32_bf16 v[132:135], v[232:235], a[204:207], v[132:135]
ds_read_u16 v206, v212 offset:5384
ds_read_u16 v207, v214 offset:5384
v_mfma_f32_16x16x32_bf16 v[128:131], v[236:239], a[204:207], v[128:131]
s_waitcnt lgkmcnt(12)
ds_read_u16 v208, v212 offset:6024
v_perm_b32 v232, v201, v200, v240
v_perm_b32 v233, v201, v200, v241
v_perm_b32 v234, v201, v200, v242
v_perm_b32 v235, v201, v200, v243
v_mfma_f32_16x16x32_bf16 v[132:135], v[236:239], a[208:211], v[132:135]
ds_read_u16 v209, v214 offset:6024
ds_read_u16 v210, v212 offset:6664
ds_read_u16 v211, v214 offset:6664
v_mfma_f32_16x16x32_bf16 v[128:131], v[232:235], a[208:211], v[128:131]
s_waitcnt lgkmcnt(14)
v_perm_b32 v236, v203, v202, v240
v_perm_b32 v237, v203, v202, v241
v_perm_b32 v238, v203, v202, v242
v_perm_b32 v239, v203, v202, v243
v_mfma_f32_16x16x32_bf16 v[132:135], v[232:235], a[212:215], v[132:135]
s_nop 0
s_waitcnt lgkmcnt(8)
v_mfma_f32_16x16x32_bf16 v[136:139], v[236:239], a[216:219], 0
s_waitcnt lgkmcnt(6)
ds_read_u16 v192, v213 offset:4096
ds_read_u16 v193, v215 offset:4096
v_perm_b32 v232, v205, v204, v240
v_perm_b32 v233, v205, v204, v241
v_perm_b32 v234, v205, v204, v242
v_perm_b32 v235, v205, v204, v243
v_mfma_f32_16x16x32_bf16 v[140:143], v[236:239], a[220:223], 0
ds_read_b128 a[192:195], v244 offset:34864
ds_read_b128 a[196:199], v244 offset:35024
ds_read_b128 a[200:203], v244 offset:35184
s_cmp_eq_u32 s31, 1
s_cbranch_scc0 L_noresn5
ds_read_b128 a[64:67], v251 offset:30992
ds_read_b128 a[68:71], v251 offset:31008
ds_read_b128 a[72:75], v251 offset:32928
ds_read_b128 a[76:79], v251 offset:32944
ds_read_b128 a[80:83], v251 offset:46496
ds_read_b128 a[84:87], v251 offset:46512
ds_read_b128 a[88:91], v251 offset:48432
ds_read_b128 a[92:95], v251 offset:48448
L_noresn5:
v_mfma_f32_16x16x32_bf16 v[136:139], v[232:235], a[220:223], v[136:139]
s_waitcnt lgkmcnt(9)
ds_read_b128 a[204:207], v244 offset:35344
v_perm_b32 v236, v207, v206, v240
v_perm_b32 v237, v207, v206, v241
v_perm_b32 v238, v207, v206, v242
v_perm_b32 v239, v207, v206, v243
v_mfma_f32_16x16x32_bf16 v[140:143], v[232:235], a[224:227], v[140:143]
ds_read_b128 a[208:211], v244 offset:35504
ds_read_b128 a[212:215], v244 offset:35664
ds_read_u16 v194, v213 offset:4736
v_mfma_f32_16x16x32_bf16 v[136:139], v[236:239], a[224:227], v[136:139]
s_waitcnt lgkmcnt(11)
ds_read_u16 v195, v215 offset:4736
v_perm_b32 v232, v209, v208, v240
v_perm_b32 v233, v209, v208, v241
v_perm_b32 v234, v209, v208, v242
v_perm_b32 v235, v209, v208, v243
v_mfma_f32_16x16x32_bf16 v[140:143], v[236:239], a[228:231], v[140:143]
ds_read_u16 v196, v213 offset:5376
ds_read_u16 v197, v215 offset:5376
v_mfma_f32_16x16x32_bf16 v[136:139], v[232:235], a[228:231], v[136:139]
s_waitcnt lgkmcnt(12)
ds_read_u16 v198, v213 offset:6016
v_perm_b32 v236, v211, v210, v240
v_perm_b32 v237, v211, v210, v241
v_perm_b32 v238, v211, v210, v242
v_perm_b32 v239, v211, v210, v243
v_mfma_f32_16x16x32_bf16 v[140:143], v[232:235], a[232:235], v[140:143]
ds_read_u16 v199, v215 offset:6016
ds_read_u16 v200, v213 offset:6656
ds_read_u16 v201, v215 offset:6656
v_mfma_f32_16x16x32_bf16 v[136:139], v[236:239], a[232:235], v[136:139]
s_waitcnt lgkmcnt(14)
v_perm_b32 v232, v193, v192, v240
v_perm_b32 v233, v193, v192, v241
v_perm_b32 v234, v193, v192, v242
v_perm_b32 v235, v193, v192, v243
v_mfma_f32_16x16x32_bf16 v[140:143], v[236:239], a[236:239], v[140:143]
s_nop 0
s_waitcnt lgkmcnt(8)
v_mfma_f32_16x16x32_bf16 v[160:163], v[232:235], a[192:195], 0
s_waitcnt lgkmcnt(6)
ds_read_u16 v202, v213 offset:4104
ds_read_u16 v203, v215 offset:4104
v_perm_b32 v236, v195, v194, v240
v_perm_b32 v237, v195, v194, v241
v_perm_b32 v238, v195, v194, v242
v_perm_b32 v239, v195, v194, v243
v_mfma_f32_16x16x32_bf16 v[164:167], v[232:235], a[196:199], 0
ds_read_b128 a[216:219], v244 offset:36800
ds_read_b128 a[220:223], v244 offset:36960
ds_read_b128 a[224:227], v244 offset:37120
v_mfma_f32_16x16x32_bf16 v[160:163], v[236:239], a[196:199], v[160:163]
s_waitcnt lgkmcnt(9)
ds_read_b128 a[228:231], v244 offset:37280
v_perm_b32 v232, v197, v196, v240
v_perm_b32 v233, v197, v196, v241
v_perm_b32 v234, v197, v196, v242
v_perm_b32 v235, v197, v196, v243
v_mfma_f32_16x16x32_bf16 v[164:167], v[236:239], a[200:203], v[164:167]
ds_read_b128 a[232:235], v244 offset:37440
ds_read_b128 a[236:239], v244 offset:37600
ds_read_u16 v204, v213 offset:4744
v_mfma_f32_16x16x32_bf16 v[160:163], v[232:235], a[200:203], v[160:163]
s_waitcnt lgkmcnt(11)
ds_read_u16 v205, v215 offset:4744
v_perm_b32 v236, v199, v198, v240
v_perm_b32 v237, v199, v198, v241
v_perm_b32 v238, v199, v198, v242
v_perm_b32 v239, v199, v198, v243
v_mfma_f32_16x16x32_bf16 v[164:167], v[232:235], a[204:207], v[164:167]
ds_read_u16 v206, v213 offset:5384
ds_read_u16 v207, v215 offset:5384
v_mfma_f32_16x16x32_bf16 v[160:163], v[236:239], a[204:207], v[160:163]
s_waitcnt lgkmcnt(12)
ds_read_u16 v208, v213 offset:6024
v_perm_b32 v232, v201, v200, v240
v_perm_b32 v233, v201, v200, v241
v_perm_b32 v234, v201, v200, v242
v_perm_b32 v235, v201, v200, v243
v_mfma_f32_16x16x32_bf16 v[164:167], v[236:239], a[208:211], v[164:167]
ds_read_u16 v209, v215 offset:6024
ds_read_u16 v210, v213 offset:6664
ds_read_u16 v211, v215 offset:6664
v_mfma_f32_16x16x32_bf16 v[160:163], v[232:235], a[208:211], v[160:163]
s_waitcnt lgkmcnt(14)
v_perm_b32 v236, v203, v202, v240
v_perm_b32 v237, v203, v202, v241
v_perm_b32 v238, v203, v202, v242
v_perm_b32 v239, v203, v202, v243
v_mfma_f32_16x16x32_bf16 v[164:167], v[232:235], a[212:215], v[164:167]
s_nop 0
s_waitcnt lgkmcnt(0)
v_mfma_f32_16x16x32_bf16 v[168:171], v[236:239], a[216:219], 0
v_perm_b32 v232, v205, v204, v240
v_perm_b32 v233, v205, v204, v241
v_perm_b32 v234, v205, v204, v242
v_perm_b32 v235, v205, v204, v243
v_mfma_f32_16x16x32_bf16 v[172:175], v[236:239], a[220:223], 0
s_nop 0
v_mfma_f32_16x16x32_bf16 v[168:171], v[232:235], a[220:223], v[168:171]
v_perm_b32 v236, v207, v206, v240
v_perm_b32 v237, v207, v206, v241
v_perm_b32 v238, v207, v206, v242
v_perm_b32 v239, v207, v206, v243
v_mfma_f32_16x16x32_bf16 v[172:175], v[232:235], a[224:227], v[172:175]
s_nop 0
v_mfma_f32_16x16x32_bf16 v[168:171], v[236:239], a[224:227], v[168:171]
v_perm_b32 v232, v209, v208, v240
v_perm_b32 v233, v209, v208, v241
v_perm_b32 v234, v209, v208, v242
v_perm_b32 v235, v209, v208, v243
v_mfma_f32_16x16x32_bf16 v[172:175], v[236:239], a[228:231], v[172:175]
s_nop 0
v_mfma_f32_16x16x32_bf16 v[168:171], v[232:235], a[228:231], v[168:171]
v_perm_b32 v236, v211, v210, v240
v_perm_b32 v237, v211, v210, v241
v_perm_b32 v238, v211, v210, v242
v_perm_b32 v239, v211, v210, v243
v_mfma_f32_16x16x32_bf16 v[172:175], v[232:235], a[232:235], v[172:175]
s_nop 0
v_mfma_f32_16x16x32_bf16 v[168:171], v[236:239], a[232:235], v[168:171]
v_mfma_f32_16x16x32_bf16 v[172:175], v[236:239], a[236:239], v[172:175]
s_nop 0
s_branch L_mlp
L_last:
v_mfma_f32_16x16x32_bf16 v[192:195], a[224:227], a[0:3], 0
ds_read_b128 a[240:243], v248 offset:4096
v_mul_f32 v244, v212, v244
v_mfma_f32_16x16x32_bf16 v[192:195], a[228:231], a[16:19], v[192:195]
s_add_u32 s24, s24, 24576
v_rcp_f32 v247, v247
v_mfma_f32_16x16x32_bf16 v[196:199], a[224:227], a[4:7], 0
s_add_u32 s25, s25, 24576
ds_read_b128 a[244:247], v248 offset:5120
v_mul_f32 v245, v213, v245
v_mfma_f32_16x16x32_bf16 v[196:199], a[228:231], a[20:23], v[196:199]
v_mul_f32 v246, v214, v246
v_mul_f32 v247, v215, v247
v_mfma_f32_16x16x32_bf16 v[200:203], a[224:227], a[8:11], 0
s_add_u32 m0, s26, 0x18000
v_cvt_pk_bf16_f32 v230, v244, v245
v_cvt_pk_bf16_f32 v231, v246, v247
v_mfma_f32_16x16x32_bf16 v[200:203], a[228:231], a[24:27], v[200:203]
buffer_load_dwordx4 v252, s[8:11], s24 offen offset:0 lds
v_mfma_f32_16x16x32_bf16 v[204:207], a[224:227], a[12:15], 0
ds_write_b128 v250, v[228:231] offset:1024
v_mfma_f32_16x16x32_bf16 v[204:207], a[228:231], a[28:31], v[204:207]
s_waitcnt lgkmcnt(3)
v_fma_f32 v242, v218, v218, s27
v_fma_f32 v243, v219, v219, s27
v_mfma_f32_16x16x32_bf16 v[192:195], a[232:235], a[32:35], v[192:195]
ds_read_b128 a[224:227], v248 offset:6144
v_mul_f32_e64 v240, -v216, v240
v_mfma_f32_16x16x32_bf16 v[192:195], a[236:239], a[48:51], v[192:195]
v_mul_f32_e64 v241, -v217, v241
v_mul_f32_e64 v242, -v218, v242
v_mfma_f32_16x16x32_bf16 v[196:199], a[232:235], a[36:39], v[196:199]
ds_read_b128 a[228:231], v248 offset:7168
v_mul_f32_e64 v243, -v219, v243
v_mfma_f32_16x16x32_bf16 v[196:199], a[236:239], a[52:55], v[196:199]
v_exp_f32 v240, v240
v_mfma_f32_16x16x32_bf16 v[200:203], a[232:235], a[40:43], v[200:203]
v_exp_f32 v241, v241
v_mfma_f32_16x16x32_bf16 v[200:203], a[236:239], a[56:59], v[200:203]
buffer_load_dwordx4 v252, s[8:11], s24 offen offset:1024 lds
v_mfma_f32_16x16x32_bf16 v[204:207], a[232:235], a[44:47], v[204:207]
v_exp_f32 v242, v242
v_mfma_f32_16x16x32_bf16 v[204:207], a[236:239], a[60:63], v[204:207]
s_waitcnt lgkmcnt(3)
v_exp_f32 v243, v243
v_mfma_f32_16x16x32_bf16 v[192:195], a[240:243], a[64:67], v[192:195]
ds_read_b128 a[232:235], v248 offset:8192
v_fma_f32 v240, v240, s35, s35
v_mfma_f32_16x16x32_bf16 v[192:195], a[244:247], a[80:83], v[192:195]
v_fma_f32 v241, v241, s35, s35
v_fma_f32 v242, v242, s35, s35
v_mfma_f32_16x16x32_bf16 v[196:199], a[240:243], a[68:71], v[196:199]
ds_read_b128 a[236:239], v248 offset:9216
v_fma_f32 v243, v243, s35, s35
v_mfma_f32_16x16x32_bf16 v[196:199], a[244:247], a[84:87], v[196:199]
v_rcp_f32 v240, v240
v_mfma_f32_16x16x32_bf16 v[200:203], a[240:243], a[72:75], v[200:203]
v_rcp_f32 v241, v241
v_mfma_f32_16x16x32_bf16 v[200:203], a[244:247], a[88:91], v[200:203]
buffer_load_dwordx4 v252, s[8:11], s24 offen offset:2048 lds
v_mfma_f32_16x16x32_bf16 v[204:207], a[240:243], a[76:79], v[204:207]
v_rcp_f32 v242, v242
v_mfma_f32_16x16x32_bf16 v[204:207], a[244:247], a[92:95], v[204:207]
s_waitcnt lgkmcnt(2)
v_rcp_f32 v243, v243
v_mfma_f32_16x16x32_bf16 v[192:195], a[224:227], a[96:99], v[192:195]
ds_read_b128 a[240:243], v248 offset:10240
v_mul_f32 v240, v216, v240
v_mfma_f32_16x16x32_bf16 v[192:195], a[228:231], a[112:115], v[192:195]
v_mul_f32 v241, v217, v241
v_mul_f32 v242, v218, v242
v_mfma_f32_16x16x32_bf16 v[196:199], a[224:227], a[100:103], v[196:199]
ds_read_b128 a[244:247], v248 offset:11264
v_mul_f32 v243, v219, v243
v_mfma_f32_16x16x32_bf16 v[196:199], a[228:231], a[116:119], v[196:199]
v_cvt_pk_bf16_f32 v234, v240, v241
v_cvt_pk_bf16_f32 v235, v242, v243
v_mfma_f32_16x16x32_bf16 v[200:203], a[224:227], a[104:107], v[200:203]
ds_write_b128 v250, v[232:235] offset:2048
v_mfma_f32_16x16x32_bf16 v[200:203], a[228:231], a[120:123], v[200:203]
buffer_load_dwordx4 v252, s[8:11], s24 offen offset:3072 lds
v_mfma_f32_16x16x32_bf16 v[204:207], a[224:227], a[108:111], v[204:207]
v_fma_f32 v244, v220, v220, s27
v_fma_f32 v245, v221, v221, s27
v_mfma_f32_16x16x32_bf16 v[204:207], a[228:231], a[124:127], v[204:207]
s_waitcnt lgkmcnt(3)
v_fma_f32 v246, v222, v222, s27
v_fma_f32 v247, v223, v223, s27
v_mfma_f32_16x16x32_bf16 v[192:195], a[232:235], a[128:131], v[192:195]
ds_read_b128 a[224:227], v248 offset:24576
v_mul_f32_e64 v244, -v220, v244
v_mfma_f32_16x16x32_bf16 v[192:195], a[236:239], a[144:147], v[192:195]
v_mul_f32_e64 v245, -v221, v245
v_mul_f32_e64 v246, -v222, v246
v_mfma_f32_16x16x32_bf16 v[196:199], a[232:235], a[132:135], v[196:199]
ds_read_b128 a[228:231], v248 offset:25600
v_mul_f32_e64 v247, -v223, v247
v_mfma_f32_16x16x32_bf16 v[196:199], a[236:239], a[148:151], v[196:199]
v_exp_f32 v244, v244
v_mfma_f32_16x16x32_bf16 v[200:203], a[232:235], a[136:139], v[200:203]
s_add_u32 m0, s26, 0x19000
v_exp_f32 v245, v245
v_mfma_f32_16x16x32_bf16 v[200:203], a[236:239], a[152:155], v[200:203]
buffer_load_dwordx4 v252, s[8:11], s25 offen offset:0 lds
v_mfma_f32_16x16x32_bf16 v[204:207], a[232:235], a[140:143], v[204:207]
v_exp_f32 v246, v246
v_mfma_f32_16x16x32_bf16 v[204:207], a[236:239], a[156:159], v[204:207]
s_waitcnt lgkmcnt(3)
v_exp_f32 v247, v247
v_mfma_f32_16x16x32_bf16 v[192:195], a[240:243], a[160:163], v[192:195]
ds_read_b128 a[232:235], v248 offset:26624
v_fma_f32 v244, v244, s35, s35
v_mfma_f32_16x16x32_bf16 v[192:195], a[244:247], a[176:179], v[192:195]
v_fma_f32 v245, v245, s35, s35
v_fma_f32 v246, v246, s35, s35
v_mfma_f32_16x16x32_bf16 v[196:199], a[240:243], a[164:167], v[196:199]
ds_read_b128 a[236:239], v248 offset:27648
v_fma_f32 v247, v247, s35, s35
v_mfma_f32_16x16x32_bf16 v[196:199], a[244:247], a[180:183], v[196:199]
v_rcp_f32 v244, v244
v_mfma_f32_16x16x32_bf16 v[200:203], a[240:243], a[168:171], v[200:203]
v_rcp_f32 v245, v245
v_mfma_f32_16x16x32_bf16 v[200:203], a[244:247], a[184:187], v[200:203]
buffer_load_dwordx4 v252, s[8:11], s25 offen offset:1024 lds
v_mfma_f32_16x16x32_bf16 v[204:207], a[240:243], a[172:175], v[204:207]
v_rcp_f32 v246, v246
v_mfma_f32_16x16x32_bf16 v[204:207], a[244:247], a[188:191], v[204:207]
s_waitcnt lgkmcnt(2)
v_rcp_f32 v247, v247
v_mfma_f32_16x16x32_bf16 v[208:211], a[224:227], a[0:3], 0
ds_read_b128 a[240:243], v248 offset:28672
v_mul_f32 v244, v220, v244
v_mfma_f32_16x16x32_bf16 v[208:211], a[228:231], a[16:19], v[208:211]
s_add_u32 s24, s24, 24576
v_mul_f32 v245, v221, v245
v_mul_f32 v246, v222, v246
v_mfma_f32_16x16x32_bf16 v[212:215], a[224:227], a[4:7], 0
s_add_u32 s25, s25, 24576
ds_read_b128 a[244:247], v248 offset:29696
v_mul_f32 v247, v223, v247
v_mfma_f32_16x16x32_bf16 v[212:215], a[228:231], a[20:23], v[212:215]
v_cvt_pk_bf16_f32 v238, v244, v245
v_cvt_pk_bf16_f32 v239, v246, v247
v_mfma_f32_16x16x32_bf16 v[216:219], a[224:227], a[8:11], 0
ds_write_b128 v250, v[236:239] offset:3072
v_mfma_f32_16x16x32_bf16 v[216:219], a[228:231], a[24:27], v[216:219]
v_fma_f32 v240, v192, v192, s27
v_fma_f32 v241, v193, v193, s27
v_mfma_f32_16x16x32_bf16 v[220:223], a[224:227], a[12:15], 0
v_fma_f32 v242, v194, v194, s27
v_fma_f32 v243, v195, v195, s27
v_mfma_f32_16x16x32_bf16 v[220:223], a[228:231], a[28:31], v[220:223]
s_waitcnt lgkmcnt(3)
v_mul_f32_e64 v240, -v192, v240
v_mul_f32_e64 v241, -v193, v241
v_mfma_f32_16x16x32_bf16 v[208:211], a[232:235], a[32:35], v[208:211]
ds_read_b128 a[224:227], v248 offset:30720
v_mul_f32_e64 v242, -v194, v242
v_mfma_f32_16x16x32_bf16 v[208:211], a[236:239], a[48:51], v[208:211]
v_mul_f32_e64 v243, -v195, v243
v_fma_f32 v244, v196, v196, s27
v_mfma_f32_16x16x32_bf16 v[212:215], a[232:235], a[36:39], v[212:215]
ds_read_b128 a[228:231], v248 offset:31744
v_fma_f32 v245, v197, v197, s27
v_mfma_f32_16x16x32_bf16 v[212:215], a[236:239], a[52:55], v[212:215]
v_exp_f32 v240, v240
v_mfma_f32_16x16x32_bf16 v[216:219], a[232:235], a[40:43], v[216:219]
v_exp_f32 v241, v241
v_mfma_f32_16x16x32_bf16 v[216:219], a[236:239], a[56:59], v[216:219]
v_exp_f32 v242, v242
v_mfma_f32_16x16x32_bf16 v[220:223], a[232:235], a[44:47], v[220:223]
v_exp_f32 v243, v243
v_mfma_f32_16x16x32_bf16 v[220:223], a[236:239], a[60:63], v[220:223]
s_waitcnt lgkmcnt(3)
v_fma_f32 v240, v240, s35, s35
v_fma_f32 v241, v241, s35, s35
v_mfma_f32_16x16x32_bf16 v[208:211], a[240:243], a[64:67], v[208:211]
ds_read_b128 a[232:235], v248 offset:32768
v_fma_f32 v242, v242, s35, s35
v_mfma_f32_16x16x32_bf16 v[208:211], a[244:247], a[80:83], v[208:211]
v_fma_f32 v243, v243, s35, s35
v_fma_f32 v246, v198, v198, s27
v_mfma_f32_16x16x32_bf16 v[212:215], a[240:243], a[68:71], v[212:215]
ds_read_b128 a[236:239], v248 offset:33792
v_fma_f32 v247, v199, v199, s27
v_mfma_f32_16x16x32_bf16 v[212:215], a[244:247], a[84:87], v[212:215]
v_rcp_f32 v240, v240
v_mfma_f32_16x16x32_bf16 v[216:219], a[240:243], a[72:75], v[216:219]
v_rcp_f32 v241, v241
v_mfma_f32_16x16x32_bf16 v[216:219], a[244:247], a[88:91], v[216:219]
v_rcp_f32 v242, v242
v_mfma_f32_16x16x32_bf16 v[220:223], a[240:243], a[76:79], v[220:223]
v_rcp_f32 v243, v243
v_mfma_f32_16x16x32_bf16 v[220:223], a[244:247], a[92:95], v[220:223]
s_waitcnt vmcnt(6) lgkmcnt(2)
s_barrier
v_mul_f32 v240, v192, v240
v_mul_f32 v241, v193, v241
v_mfma_f32_16x16x32_bf16 v[208:211], a[224:227], a[96:99], v[208:211]
s_add_u32 m0, s26, 0x1e000
ds_read_b128 a[240:243], v248 offset:34816
v_mul_f32 v242, v194, v242
v_mfma_f32_16x16x32_bf16 v[208:211], a[228:231], a[112:115], v[208:211]
buffer_load_dwordx4 v252, s[8:11], s24 offen offset:0 lds
v_mfma_f32_16x16x32_bf16 v[212:215], a[224:227], a[100:103], v[212:215]
ds_read_b128 a[244:247], v248 offset:35840
v_mul_f32 v243, v195, v243
v_mfma_f32_16x16x32_bf16 v[212:215], a[228:231], a[116:119], v[212:215]
buffer_load_dwordx4 v252, s[8:11], s24 offen offset:1024 lds
v_mfma_f32_16x16x32_bf16 v[216:219], a[224:227], a[104:107], v[216:219]
ds_read_b128 a[192:195], v251 offset:0
v_cvt_pk_bf16_f32 v224, v240, v241
v_mfma_f32_16x16x32_bf16 v[216:219], a[228:231], a[120:123], v[216:219]
ds_read_b128 a[196:199], v251 offset:1024
v_cvt_pk_bf16_f32 v225, v242, v243
v_mfma_f32_16x16x32_bf16 v[220:223], a[224:227], a[108:111], v[220:223]
buffer_load_dwordx4 v252, s[8:11], s24 offen offset:2048 lds
v_mfma_f32_16x16x32_bf16 v[220:223], a[228:231], a[124:127], v[220:223]
s_waitcnt lgkmcnt(4)
v_mul_f32_e64 v244, -v196, v244
v_mul_f32_e64 v245, -v197, v245
v_mfma_f32_16x16x32_bf16 v[208:211], a[232:235], a[128:131], v[208:211]
ds_read_b128 a[224:227], v248 offset:49152
v_mul_f32_e64 v246, -v198, v246
v_mfma_f32_16x16x32_bf16 v[208:211], a[236:239], a[144:147], v[208:211]
ds_read_b128 a[200:203], v251 offset:2048
v_mul_f32_e64 v247, -v199, v247
v_mfma_f32_16x16x32_bf16 v[212:215], a[232:235], a[132:135], v[212:215]
ds_read_b128 a[228:231], v248 offset:50176
v_fma_f32 v240, v200, v200, s27
v_mfma_f32_16x16x32_bf16 v[212:215], a[236:239], a[148:151], v[212:215]
v_exp_f32 v244, v244
v_mfma_f32_16x16x32_bf16 v[216:219], a[232:235], a[136:139], v[216:219]
ds_read_b128 a[204:207], v251 offset:3072
v_fma_f32 v244, v244, s35, s35
v_mfma_f32_16x16x32_bf16 v[216:219], a[236:239], a[152:155], v[216:219]
ds_read_b128 a[208:211], v251 offset:4096
v_fma_f32 v241, v201, v201, s27
v_mfma_f32_16x16x32_bf16 v[220:223], a[232:235], a[140:143], v[220:223]
buffer_load_dwordx4 v252, s[8:11], s24 offen offset:3072 lds
v_mfma_f32_16x16x32_bf16 v[220:223], a[236:239], a[156:159], v[220:223]
s_waitcnt lgkmcnt(7)
v_exp_f32 v245, v245
v_mfma_f32_16x16x32_bf16 v[208:211], a[240:243], a[160:163], v[208:211]
ds_read_b128 a[232:235], v248 offset:51200
v_fma_f32 v245, v245, s35, s35
v_mfma_f32_16x16x32_bf16 v[208:211], a[244:247], a[176:179], v[208:211]
ds_read_b128 a[212:215], v251 offset:5120
v_fma_f32 v242, v202, v202, s27
v_mfma_f32_16x16x32_bf16 v[212:215], a[240:243], a[164:167], v[212:215]
s_add_u32 m0, s26, 0x1f000
ds_read_b128 a[236:239], v248 offset:52224
v_fma_f32 v243, v203, v203, s27
v_mfma_f32_16x16x32_bf16 v[212:215], a[244:247], a[180:183], v[212:215]
buffer_load_dwordx4 v252, s[8:11], s25 offen offset:0 lds
v_mfma_f32_16x16x32_bf16 v[216:219], a[240:243], a[168:171], v[216:219]
ds_read_b128 a[216:219], v251 offset:6144
v_mul_f32_e64 v240, -v200, v240
v_mfma_f32_16x16x32_bf16 v[216:219], a[244:247], a[184:187], v[216:219]
ds_read_b128 a[220:223], v251 offset:7168
v_mul_f32_e64 v241, -v201, v241
v_mfma_f32_16x16x32_bf16 v[220:223], a[240:243], a[172:175], v[220:223]
buffer_load_dwordx4 v252, s[8:11], s25 offen offset:1024 lds
v_mfma_f32_16x16x32_bf16 v[220:223], a[244:247], a[188:191], v[220:223]
s_waitcnt lgkmcnt(0)
v_exp_f32 v246, v246
v_mfma_f32_16x16x32_bf16 v[0:3], a[224:227], a[192:195], v[0:3]
ds_read_b128 a[240:243], v248 offset:53248
v_fma_f32 v246, v246, s35, s35
v_mfma_f32_16x16x32_bf16 v[0:3], a[228:231], a[208:211], v[0:3]
v_exp_f32 v247, v247
v_mfma_f32_16x16x32_bf16 v[4:7], a[224:227], a[196:199], v[4:7]
ds_read_b128 a[244:247], v248 offset:54272
v_fma_f32 v247, v247, s35, s35
v_mfma_f32_16x16x32_bf16 v[4:7], a[228:231], a[212:215], v[4:7]
v_rcp_f32 v244, v244
v_mfma_f32_16x16x32_bf16 v[8:11], a[224:227], a[200:203], v[8:11]
v_rcp_f32 v245, v245
v_mfma_f32_16x16x32_bf16 v[8:11], a[228:231], a[216:219], v[8:11]
v_rcp_f32 v246, v246
v_mfma_f32_16x16x32_bf16 v[12:15], a[224:227], a[204:207], v[12:15]
v_rcp_f32 v247, v247
v_mfma_f32_16x16x32_bf16 v[12:15], a[228:231], a[220:223], v[12:15]
v_mul_f32 v244, v196, v244
v_mul_f32 v245, v197, v245
v_mfma_f32_16x16x32_bf16 v[16:19], a[232:235], a[192:195], v[16:19]
ds_read_b128 a[224:227], v248 offset:55296
v_mul_f32 v246, v198, v246
v_mfma_f32_16x16x32_bf16 v[16:19], a[236:239], a[208:211], v[16:19]
v_mul_f32 v247, v199, v247
v_cvt_pk_bf16_f32 v228, v244, v245
v_mfma_f32_16x16x32_bf16 v[20:23], a[232:235], a[196:199], v[20:23]
ds_read_b128 a[228:231], v248 offset:56320
v_cvt_pk_bf16_f32 v229, v246, v247
v_mfma_f32_16x16x32_bf16 v[20:23], a[236:239], a[212:215], v[20:23]
v_mul_f32_e64 v242, -v202, v242
v_mul_f32_e64 v243, -v203, v243
v_mfma_f32_16x16x32_bf16 v[24:27], a[232:235], a[200:203], v[24:27]
v_exp_f32 v240, v240
v_mfma_f32_16x16x32_bf16 v[24:27], a[236:239], a[216:219], v[24:27]
v_exp_f32 v241, v241
v_mfma_f32_16x16x32_bf16 v[28:31], a[232:235], a[204:207], v[28:31]
v_exp_f32 v242, v242
v_mfma_f32_16x16x32_bf16 v[28:31], a[236:239], a[220:223], v[28:31]
s_waitcnt lgkmcnt(2)
v_exp_f32 v243, v243
v_mfma_f32_16x16x32_bf16 v[32:35], a[240:243], a[192:195], v[32:35]
ds_read_b128 a[232:235], v248 offset:57344
v_fma_f32 v240, v240, s35, s35
v_mfma_f32_16x16x32_bf16 v[32:35], a[244:247], a[208:211], v[32:35]
v_fma_f32 v241, v241, s35, s35
v_fma_f32 v242, v242, s35, s35
v_fma_f32 v243, v243, s35, s35
v_mfma_f32_16x16x32_bf16 v[36:39], a[240:243], a[196:199], v[36:39]
ds_read_b128 a[236:239], v248 offset:58368
v_fma_f32 v244, v204, v204, s27
v_rcp_f32 v240, v240
v_rcp_f32 v241, v241
v_rcp_f32 v242, v242
v_rcp_f32 v243, v243
v_mfma_f32_16x16x32_bf16 v[36:39], a[244:247], a[212:215], v[36:39]
v_mul_f32 v240, v200, v240
v_mul_f32 v241, v201, v241
v_mul_f32 v242, v202, v242
v_mul_f32 v243, v203, v243
v_mfma_f32_16x16x32_bf16 v[40:43], a[240:243], a[200:203], v[40:43]
v_cvt_pk_bf16_f32 v232, v240, v241
v_cvt_pk_bf16_f32 v233, v242, v243
v_fma_f32 v245, v205, v205, s27
v_fma_f32 v246, v206, v206, s27
v_fma_f32 v247, v207, v207, s27
v_mfma_f32_16x16x32_bf16 v[40:43], a[244:247], a[216:219], v[40:43]
v_mul_f32_e64 v244, -v204, v244
v_mul_f32_e64 v245, -v205, v245
v_mul_f32_e64 v246, -v206, v246
v_mul_f32_e64 v247, -v207, v247
v_mfma_f32_16x16x32_bf16 v[44:47], a[240:243], a[204:207], v[44:47]
v_exp_f32 v244, v244
v_exp_f32 v245, v245
v_exp_f32 v246, v246
v_exp_f32 v247, v247
v_mfma_f32_16x16x32_bf16 v[44:47], a[244:247], a[220:223], v[44:47]
s_waitcnt lgkmcnt(2)
v_fma_f32 v244, v244, s35, s35
v_fma_f32 v245, v245, s35, s35
v_fma_f32 v246, v246, s35, s35
v_fma_f32 v247, v247, s35, s35
v_mfma_f32_16x16x32_bf16 v[48:51], a[224:227], a[192:195], v[48:51]
ds_read_b128 a[240:243], v248 offset:59392
v_fma_f32 v240, v208, v208, s27
v_rcp_f32 v244, v244
v_rcp_f32 v245, v245
v_rcp_f32 v246, v246
v_rcp_f32 v247, v247
v_mfma_f32_16x16x32_bf16 v[48:51], a[228:231], a[208:211], v[48:51]
v_mul_f32 v244, v204, v244
v_mul_f32 v245, v205, v245
v_mul_f32 v246, v206, v246
v_mul_f32 v247, v207, v247
v_mfma_f32_16x16x32_bf16 v[52:55], a[224:227], a[196:199], v[52:55]
ds_read_b128 a[244:247], v248 offset:60416
v_cvt_pk_bf16_f32 v236, v244, v245
v_mfma_f32_16x16x32_bf16 v[52:55], a[228:231], a[212:215], v[52:55]
v_cvt_pk_bf16_f32 v237, v246, v247
v_fma_f32 v241, v209, v209, s27
v_mfma_f32_16x16x32_bf16 v[56:59], a[224:227], a[200:203], v[56:59]
v_fma_f32 v242, v210, v210, s27
v_fma_f32 v243, v211, v211, s27
v_mfma_f32_16x16x32_bf16 v[56:59], a[228:231], a[216:219], v[56:59]
v_mul_f32_e64 v240, -v208, v240
v_mul_f32_e64 v241, -v209, v241
v_mfma_f32_16x16x32_bf16 v[60:63], a[224:227], a[204:207], v[60:63]
v_mul_f32_e64 v242, -v210, v242
v_mul_f32_e64 v243, -v211, v243
v_mfma_f32_16x16x32_bf16 v[60:63], a[228:231], a[220:223], v[60:63]
s_waitcnt lgkmcnt(2)
v_exp_f32 v240, v240
v_mfma_f32_16x16x32_bf16 v[64:67], a[232:235], a[192:195], v[64:67]
ds_read_b128 a[224:227], v249 offset:0
v_fma_f32 v240, v240, s35, s35
v_mfma_f32_16x16x32_bf16 v[64:67], a[236:239], a[208:211], v[64:67]
v_exp_f32 v241, v241
v_mfma_f32_16x16x32_bf16 v[68:71], a[232:235], a[196:199], v[68:71]
ds_read_b128 a[228:231], v249 offset:1024
v_fma_f32 v241, v241, s35, s35
v_mfma_f32_16x16x32_bf16 v[68:71], a[236:239], a[212:215], v[68:71]
v_exp_f32 v242, v242
v_mfma_f32_16x16x32_bf16 v[72:75], a[232:235], a[200:203], v[72:75]
v_exp_f32 v243, v243
v_mfma_f32_16x16x32_bf16 v[72:75], a[236:239], a[216:219], v[72:75]
v_fma_f32 v242, v242, s35, s35
v_fma_f32 v243, v243, s35, s35
v_mfma_f32_16x16x32_bf16 v[76:79], a[232:235], a[204:207], v[76:79]
v_rcp_f32 v240, v240
v_mfma_f32_16x16x32_bf16 v[76:79], a[236:239], a[220:223], v[76:79]
s_waitcnt lgkmcnt(2)
v_rcp_f32 v241, v241
v_mfma_f32_16x16x32_bf16 v[80:83], a[240:243], a[192:195], v[80:83]
ds_read_b128 a[232:235], v249 offset:2048
v_mul_f32 v240, v208, v240
v_mfma_f32_16x16x32_bf16 v[80:83], a[244:247], a[208:211], v[80:83]
v_rcp_f32 v242, v242
v_mfma_f32_16x16x32_bf16 v[84:87], a[240:243], a[196:199], v[84:87]
ds_read_b128 a[236:239], v249 offset:3072
v_mul_f32 v241, v209, v241
v_mfma_f32_16x16x32_bf16 v[84:87], a[244:247], a[212:215], v[84:87]
v_rcp_f32 v243, v243
v_mfma_f32_16x16x32_bf16 v[88:91], a[240:243], a[200:203], v[88:91]
v_mul_f32 v242, v210, v242
v_mul_f32 v243, v211, v243
v_mfma_f32_16x16x32_bf16 v[88:91], a[244:247], a[216:219], v[88:91]
v_cvt_pk_bf16_f32 v226, v240, v241
v_cvt_pk_bf16_f32 v227, v242, v243
v_mfma_f32_16x16x32_bf16 v[92:95], a[240:243], a[204:207], v[92:95]
v_fma_f32 v244, v212, v212, s27
v_fma_f32 v245, v213, v213, s27
v_mfma_f32_16x16x32_bf16 v[92:95], a[244:247], a[220:223], v[92:95]
s_waitcnt lgkmcnt(2)
v_fma_f32 v246, v214, v214, s27
v_fma_f32 v247, v215, v215, s27
v_mfma_f32_16x16x32_bf16 v[96:99], a[224:227], a[192:195], v[96:99]
ds_read_b128 a[240:243], v249 offset:4096
v_mul_f32_e64 v244, -v212, v244
v_mfma_f32_16x16x32_bf16 v[96:99], a[228:231], a[208:211], v[96:99]
v_mul_f32_e64 v245, -v213, v245
v_mul_f32_e64 v246, -v214, v246
v_mfma_f32_16x16x32_bf16 v[100:103], a[224:227], a[196:199], v[100:103]
ds_read_b128 a[244:247], v249 offset:5120
v_mul_f32_e64 v247, -v215, v247
v_mfma_f32_16x16x32_bf16 v[100:103], a[228:231], a[212:215], v[100:103]
v_exp_f32 v244, v244
v_mfma_f32_16x16x32_bf16 v[104:107], a[224:227], a[200:203], v[104:107]
v_exp_f32 v245, v245
v_mfma_f32_16x16x32_bf16 v[104:107], a[228:231], a[216:219], v[104:107]
v_exp_f32 v246, v246
v_mfma_f32_16x16x32_bf16 v[108:111], a[224:227], a[204:207], v[108:111]
v_exp_f32 v247, v247
v_mfma_f32_16x16x32_bf16 v[108:111], a[228:231], a[220:223], v[108:111]
s_waitcnt lgkmcnt(2)
v_fma_f32 v244, v244, s35, s35
v_fma_f32 v245, v245, s35, s35
v_mfma_f32_16x16x32_bf16 v[112:115], a[232:235], a[192:195], v[112:115]
ds_read_b128 a[224:227], v249 offset:6144
v_fma_f32 v246, v246, s35, s35
v_mfma_f32_16x16x32_bf16 v[112:115], a[236:239], a[208:211], v[112:115]
v_fma_f32 v247, v247, s35, s35
v_fma_f32 v240, v216, v216, s27
v_mfma_f32_16x16x32_bf16 v[116:119], a[232:235], a[196:199], v[116:119]
ds_read_b128 a[228:231], v249 offset:7168
v_fma_f32 v241, v217, v217, s27
v_mfma_f32_16x16x32_bf16 v[116:119], a[236:239], a[212:215], v[116:119]
v_rcp_f32 v244, v244
v_rcp_f32 v245, v245
v_rcp_f32 v246, v246
v_rcp_f32 v247, v247
v_mfma_f32_16x16x32_bf16 v[120:123], a[232:235], a[200:203], v[120:123]
v_mul_f32 v244, v212, v244
v_mul_f32 v245, v213, v245
v_mul_f32 v246, v214, v246
v_mul_f32 v247, v215, v247
v_mfma_f32_16x16x32_bf16 v[120:123], a[236:239], a[216:219], v[120:123]
v_cvt_pk_bf16_f32 v230, v244, v245
v_cvt_pk_bf16_f32 v231, v246, v247
v_mfma_f32_16x16x32_bf16 v[124:127], a[232:235], a[204:207], v[124:127]
v_fma_f32 v242, v218, v218, s27
v_fma_f32 v243, v219, v219, s27
v_mfma_f32_16x16x32_bf16 v[124:127], a[236:239], a[220:223], v[124:127]
s_waitcnt vmcnt(0) lgkmcnt(2)
s_barrier
v_mul_f32_e64 v240, -v216, v240
v_mul_f32_e64 v241, -v217, v241
v_mul_f32_e64 v242, -v218, v242
v_mul_f32_e64 v243, -v219, v243
v_mfma_f32_16x16x32_bf16 v[128:131], a[240:243], a[192:195], v[128:131]
ds_read_b128 a[232:235], v249 offset:8192
v_fma_f32 v244, v220, v220, s27
v_exp_f32 v240, v240
v_exp_f32 v241, v241
v_exp_f32 v242, v242
v_exp_f32 v243, v243
v_mfma_f32_16x16x32_bf16 v[128:131], a[244:247], a[208:211], v[128:131]
ds_write_b128 v250, v[224:227] offset:0
v_fma_f32 v240, v240, s35, s35
v_fma_f32 v241, v241, s35, s35
v_fma_f32 v242, v242, s35, s35
v_fma_f32 v243, v243, s35, s35
v_mfma_f32_16x16x32_bf16 v[132:135], a[240:243], a[196:199], v[132:135]
ds_read_b128 a[236:239], v249 offset:9216
v_fma_f32 v245, v221, v221, s27
v_rcp_f32 v240, v240
v_rcp_f32 v241, v241
v_rcp_f32 v242, v242
v_rcp_f32 v243, v243
v_mfma_f32_16x16x32_bf16 v[132:135], a[244:247], a[212:215], v[132:135]
ds_write_b128 v250, v[228:231] offset:1024
v_mul_f32 v240, v216, v240
v_mul_f32 v241, v217, v241
v_mul_f32 v242, v218, v242
v_mul_f32 v243, v219, v243
v_mfma_f32_16x16x32_bf16 v[136:139], a[240:243], a[200:203], v[136:139]
v_cvt_pk_bf16_f32 v234, v240, v241
v_cvt_pk_bf16_f32 v235, v242, v243
v_mfma_f32_16x16x32_bf16 v[136:139], a[244:247], a[216:219], v[136:139]
ds_write_b128 v250, v[232:235] offset:2048
v_fma_f32 v246, v222, v222, s27
v_fma_f32 v247, v223, v223, s27
v_mfma_f32_16x16x32_bf16 v[140:143], a[240:243], a[204:207], v[140:143]
v_mul_f32_e64 v244, -v220, v244
v_mul_f32_e64 v245, -v221, v245
v_mul_f32_e64 v246, -v222, v246
v_mul_f32_e64 v247, -v223, v247
v_mfma_f32_16x16x32_bf16 v[140:143], a[244:247], a[220:223], v[140:143]
s_waitcnt lgkmcnt(5)
v_exp_f32 v244, v244
v_exp_f32 v245, v245
v_exp_f32 v246, v246
v_exp_f32 v247, v247
v_mfma_f32_16x16x32_bf16 v[144:147], a[224:227], a[192:195], v[144:147]
ds_read_b128 a[240:243], v249 offset:10240
v_fma_f32 v244, v244, s35, s35
v_fma_f32 v245, v245, s35, s35
v_fma_f32 v246, v246, s35, s35
v_fma_f32 v247, v247, s35, s35
v_mfma_f32_16x16x32_bf16 v[144:147], a[228:231], a[208:211], v[144:147]
v_rcp_f32 v244, v244
v_rcp_f32 v245, v245
v_rcp_f32 v246, v246
v_rcp_f32 v247, v247
v_mfma_f32_16x16x32_bf16 v[148:151], a[224:227], a[196:199], v[148:151]
ds_read_b128 a[244:247], v249 offset:11264
v_mul_f32 v244, v220, v244
v_mul_f32 v245, v221, v245
v_mul_f32 v246, v222, v246
v_mul_f32 v247, v223, v247
v_mfma_f32_16x16x32_bf16 v[148:151], a[228:231], a[212:215], v[148:151]
v_cvt_pk_bf16_f32 v238, v244, v245
v_cvt_pk_bf16_f32 v239, v246, v247
v_mfma_f32_16x16x32_bf16 v[152:155], a[224:227], a[200:203], v[152:155]
ds_write_b128 v250, v[236:239] offset:3072
v_mfma_f32_16x16x32_bf16 v[152:155], a[228:231], a[216:219], v[152:155]
v_mfma_f32_16x16x32_bf16 v[156:159], a[224:227], a[204:207], v[156:159]
v_mfma_f32_16x16x32_bf16 v[156:159], a[228:231], a[220:223], v[156:159]
s_waitcnt lgkmcnt(5)
v_mfma_f32_16x16x32_bf16 v[160:163], a[232:235], a[192:195], v[160:163]
ds_read_b128 a[224:227], v249 offset:24576
v_mfma_f32_16x16x32_bf16 v[160:163], a[236:239], a[208:211], v[160:163]
v_mfma_f32_16x16x32_bf16 v[164:167], a[232:235], a[196:199], v[164:167]
ds_read_b128 a[228:231], v249 offset:25600
v_mfma_f32_16x16x32_bf16 v[164:167], a[236:239], a[212:215], v[164:167]
buffer_load_dwordx4 v[244:247], v252, s[8:11], s96 offen offset:1024
v_mfma_f32_16x16x32_bf16 v[168:171], a[232:235], a[200:203], v[168:171]
buffer_load_dwordx4 v[236:239], v252, s[8:11], s96 offen offset:2048
v_mfma_f32_16x16x32_bf16 v[168:171], a[236:239], a[216:219], v[168:171]
buffer_load_dword v253, v252, s[8:11], s96 offen offset:3072
v_mfma_f32_16x16x32_bf16 v[172:175], a[232:235], a[204:207], v[172:175]
v_mfma_f32_16x16x32_bf16 v[172:175], a[236:239], a[220:223], v[172:175]
s_waitcnt lgkmcnt(2)
s_barrier
v_mfma_f32_16x16x32_bf16 v[176:179], a[240:243], a[192:195], v[176:179]
ds_read_b128 a[232:235], v249 offset:26624
ds_read_b128 a[160:163], v251 offset:0
v_mfma_f32_16x16x32_bf16 v[176:179], a[244:247], a[208:211], v[176:179]
ds_read_b128 a[164:167], v251 offset:1024
v_mfma_f32_16x16x32_bf16 v[180:183], a[240:243], a[196:199], v[180:183]
ds_read_b128 a[236:239], v249 offset:27648
ds_read_b128 a[168:171], v251 offset:2048
v_mfma_f32_16x16x32_bf16 v[180:183], a[244:247], a[212:215], v[180:183]
ds_read_b128 a[172:175], v251 offset:3072
v_mfma_f32_16x16x32_bf16 v[184:187], a[240:243], a[200:203], v[184:187]
ds_read_b128 a[176:179], v251 offset:4096
v_mfma_f32_16x16x32_bf16 v[184:187], a[244:247], a[216:219], v[184:187]
ds_read_b128 a[180:183], v251 offset:5120
ds_read_b128 a[184:187], v251 offset:6144
v_mfma_f32_16x16x32_bf16 v[188:191], a[240:243], a[204:207], v[188:191]
ds_read_b128 a[188:191], v251 offset:7168
v_mfma_f32_16x16x32_bf16 v[188:191], a[244:247], a[220:223], v[188:191]
s_waitcnt lgkmcnt(0)
v_mfma_f32_16x16x32_bf16 v[0:3], a[224:227], a[160:163], v[0:3]
ds_read_b128 a[240:243], v249 offset:28672
v_mfma_f32_16x16x32_bf16 v[0:3], a[228:231], a[176:179], v[0:3]
s_waitcnt vmcnt(0)
s_lshl_b32 s72, s29, 13
s_add_u32 s72, s72, 4294936064
v_add_u32 v236, s72, v236
v_add_u32 v237, s72, v237
v_mfma_f32_16x16x32_bf16 v[4:7], a[224:227], a[164:167], v[4:7]
ds_read_b128 a[244:247], v249 offset:29696
v_add_u32 v238, s72, v238
v_mfma_f32_16x16x32_bf16 v[4:7], a[228:231], a[180:183], v[4:7]
v_add_u32 v239, s72, v239
v_mfma_f32_16x16x32_bf16 v[8:11], a[224:227], a[168:171], v[8:11]
v_mfma_f32_16x16x32_bf16 v[8:11], a[228:231], a[184:187], v[8:11]
v_mfma_f32_16x16x32_bf16 v[12:15], a[224:227], a[172:175], v[12:15]
v_mfma_f32_16x16x32_bf16 v[12:15], a[228:231], a[188:191], v[12:15]
v_mfma_f32_16x16x32_bf16 v[16:19], a[232:235], a[160:163], v[16:19]
ds_read_b128 a[224:227], v249 offset:30720
v_mfma_f32_16x16x32_bf16 v[16:19], a[236:239], a[176:179], v[16:19]
v_mfma_f32_16x16x32_bf16 v[20:23], a[232:235], a[164:167], v[20:23]
ds_read_b128 a[228:231], v249 offset:31744
v_mfma_f32_16x16x32_bf16 v[20:23], a[236:239], a[180:183], v[20:23]
v_mfma_f32_16x16x32_bf16 v[24:27], a[232:235], a[168:171], v[24:27]
v_mfma_f32_16x16x32_bf16 v[24:27], a[236:239], a[184:187], v[24:27]
v_mfma_f32_16x16x32_bf16 v[28:31], a[232:235], a[172:175], v[28:31]
v_mfma_f32_16x16x32_bf16 v[28:31], a[236:239], a[188:191], v[28:31]
s_waitcnt lgkmcnt(2)
v_mfma_f32_16x16x32_bf16 v[32:35], a[240:243], a[160:163], v[32:35]
ds_read_b128 a[232:235], v249 offset:32768
v_mfma_f32_16x16x32_bf16 v[32:35], a[244:247], a[176:179], v[32:35]
v_mfma_f32_16x16x32_bf16 v[36:39], a[240:243], a[164:167], v[36:39]
ds_read_b128 a[236:239], v249 offset:33792
v_mfma_f32_16x16x32_bf16 v[36:39], a[244:247], a[180:183], v[36:39]
v_cvt_pk_bf16_f32 v0, v0, v1
v_cvt_pk_bf16_f32 v1, v2, v3
v_mfma_f32_16x16x32_bf16 v[40:43], a[240:243], a[168:171], v[40:43]
v_cvt_pk_bf16_f32 v2, v16, v17
v_cvt_pk_bf16_f32 v3, v18, v19
v_mfma_f32_16x16x32_bf16 v[40:43], a[244:247], a[184:187], v[40:43]
ds_write_b128 v236, v[0:3] offset:0
v_mfma_f32_16x16x32_bf16 v[44:47], a[240:243], a[172:175], v[44:47]
v_cvt_pk_bf16_f32 v4, v4, v5
v_cvt_pk_bf16_f32 v5, v6, v7
v_mfma_f32_16x16x32_bf16 v[44:47], a[244:247], a[188:191], v[44:47]
s_waitcnt lgkmcnt(3)
v_cvt_pk_bf16_f32 v6, v20, v21
v_cvt_pk_bf16_f32 v7, v22, v23
v_mfma_f32_16x16x32_bf16 v[48:51], a[224:227], a[160:163], v[48:51]
ds_read_b128 a[240:243], v249 offset:34816
v_cvt_pk_bf16_f32 v8, v8, v9
v_mfma_f32_16x16x32_bf16 v[48:51], a[228:231], a[176:179], v[48:51]
ds_write_b128 v236, v[4:7] offset:2048
v_mfma_f32_16x16x32_bf16 v[52:55], a[224:227], a[164:167], v[52:55]
ds_read_b128 a[244:247], v249 offset:35840
v_cvt_pk_bf16_f32 v9, v10, v11
v_mfma_f32_16x16x32_bf16 v[52:55], a[228:231], a[180:183], v[52:55]
v_cvt_pk_bf16_f32 v10, v24, v25
v_cvt_pk_bf16_f32 v11, v26, v27
v_mfma_f32_16x16x32_bf16 v[56:59], a[224:227], a[168:171], v[56:59]
ds_write_b128 v236, v[8:11] offset:4096
v_mfma_f32_16x16x32_bf16 v[56:59], a[228:231], a[184:187], v[56:59]
v_cvt_pk_bf16_f32 v12, v12, v13
v_cvt_pk_bf16_f32 v13, v14, v15
v_mfma_f32_16x16x32_bf16 v[60:63], a[224:227], a[172:175], v[60:63]
v_cvt_pk_bf16_f32 v14, v28, v29
v_cvt_pk_bf16_f32 v15, v30, v31
v_mfma_f32_16x16x32_bf16 v[60:63], a[228:231], a[188:191], v[60:63]
s_waitcnt lgkmcnt(5)
ds_write_b128 v236, v[12:15] offset:6144
v_mfma_f32_16x16x32_bf16 v[64:67], a[232:235], a[160:163], v[64:67]
ds_read_b128 a[224:227], v249 offset:49152
v_mfma_f32_16x16x32_bf16 v[64:67], a[236:239], a[176:179], v[64:67]
v_mfma_f32_16x16x32_bf16 v[68:71], a[232:235], a[164:167], v[68:71]
ds_read_b128 a[228:231], v249 offset:50176
v_mfma_f32_16x16x32_bf16 v[68:71], a[236:239], a[180:183], v[68:71]
v_cvt_pk_bf16_f32 v32, v32, v33
v_cvt_pk_bf16_f32 v33, v34, v35
v_mfma_f32_16x16x32_bf16 v[72:75], a[232:235], a[168:171], v[72:75]
v_cvt_pk_bf16_f32 v34, v48, v49
v_cvt_pk_bf16_f32 v35, v50, v51
v_mfma_f32_16x16x32_bf16 v[72:75], a[236:239], a[184:187], v[72:75]
ds_write_b128 v237, v[32:35] offset:1024
v_mfma_f32_16x16x32_bf16 v[76:79], a[232:235], a[172:175], v[76:79]
ds_read_b128 v[0:3], v238 offset:0
ds_read_b128 v[32:35], v239 offset:0
v_mfma_f32_16x16x32_bf16 v[76:79], a[236:239], a[188:191], v[76:79]
s_waitcnt lgkmcnt(7)
v_cvt_pk_bf16_f32 v36, v36, v37
v_cvt_pk_bf16_f32 v37, v38, v39
v_mfma_f32_16x16x32_bf16 v[80:83], a[240:243], a[160:163], v[80:83]
ds_read_b128 a[232:235], v249 offset:51200
v_cvt_pk_bf16_f32 v38, v52, v53
v_mfma_f32_16x16x32_bf16 v[80:83], a[244:247], a[176:179], v[80:83]
v_cvt_pk_bf16_f32 v39, v54, v55
v_cvt_pk_bf16_f32 v40, v40, v41
v_mfma_f32_16x16x32_bf16 v[84:87], a[240:243], a[164:167], v[84:87]
ds_read_b128 a[236:239], v249 offset:52224
v_cvt_pk_bf16_f32 v41, v42, v43
v_mfma_f32_16x16x32_bf16 v[84:87], a[244:247], a[180:183], v[84:87]
ds_write_b128 v237, v[36:39] offset:3072
v_mfma_f32_16x16x32_bf16 v[88:91], a[240:243], a[168:171], v[88:91]
ds_read_b128 v[4:7], v238 offset:2048
ds_read_b128 v[36:39], v239 offset:2048
v_mfma_f32_16x16x32_bf16 v[88:91], a[244:247], a[184:187], v[88:91]
s_waitcnt lgkmcnt(5)
buffer_store_dwordx4 v[0:3], v253, s[20:23], s34 offen offset:0 sc1
v_mfma_f32_16x16x32_bf16 v[92:95], a[240:243], a[172:175], v[92:95]
buffer_store_dwordx4 v[32:35], v247, s[20:23], s34 offen offset:0 sc1
v_mfma_f32_16x16x32_bf16 v[92:95], a[244:247], a[188:191], v[92:95]
v_cvt_pk_bf16_f32 v42, v56, v57
v_cvt_pk_bf16_f32 v43, v58, v59
v_mfma_f32_16x16x32_bf16 v[96:99], a[224:227], a[160:163], v[96:99]
ds_read_b128 a[240:243], v249 offset:53248
v_cvt_pk_bf16_f32 v44, v44, v45
v_mfma_f32_16x16x32_bf16 v[96:99], a[228:231], a[176:179], v[96:99]
ds_write_b128 v237, v[40:43] offset:5120
v_mfma_f32_16x16x32_bf16 v[100:103], a[224:227], a[164:167], v[100:103]
ds_read_b128 a[244:247], v249 offset:54272
ds_read_b128 v[8:11], v238 offset:4096
v_mfma_f32_16x16x32_bf16 v[100:103], a[228:231], a[180:183], v[100:103]
ds_read_b128 v[40:43], v239 offset:4096
v_cvt_pk_bf16_f32 v45, v46, v47
v_mfma_f32_16x16x32_bf16 v[104:107], a[224:227], a[168:171], v[104:107]
s_waitcnt lgkmcnt(5)
buffer_store_dwordx4 v[4:7], v253, s[20:23], s34 offen offset:768 sc1
v_mfma_f32_16x16x32_bf16 v[104:107], a[228:231], a[184:187], v[104:107]
buffer_store_dwordx4 v[36:39], v247, s[20:23], s34 offen offset:768 sc1
v_mfma_f32_16x16x32_bf16 v[108:111], a[224:227], a[172:175], v[108:111]
v_cvt_pk_bf16_f32 v46, v60, v61
v_cvt_pk_bf16_f32 v47, v62, v63
v_mfma_f32_16x16x32_bf16 v[108:111], a[228:231], a[188:191], v[108:111]
ds_write_b128 v237, v[44:47] offset:7168
v_mfma_f32_16x16x32_bf16 v[112:115], a[232:235], a[160:163], v[112:115]
ds_read_b128 a[224:227], v249 offset:55296
ds_read_b128 v[12:15], v238 offset:6144
v_mfma_f32_16x16x32_bf16 v[112:115], a[236:239], a[176:179], v[112:115]
ds_read_b128 v[44:47], v239 offset:6144
v_cvt_pk_bf16_f32 v64, v64, v65
v_mfma_f32_16x16x32_bf16 v[116:119], a[232:235], a[164:167], v[116:119]
ds_read_b128 a[228:231], v249 offset:56320
v_cvt_pk_bf16_f32 v65, v66, v67
v_mfma_f32_16x16x32_bf16 v[116:119], a[236:239], a[180:183], v[116:119]
s_waitcnt lgkmcnt(5)
buffer_store_dwordx4 v[8:11], v253, s[20:23], s34 offen offset:1536 sc1
v_mfma_f32_16x16x32_bf16 v[120:123], a[232:235], a[168:171], v[120:123]
buffer_store_dwordx4 v[40:43], v247, s[20:23], s34 offen offset:1536 sc1
v_mfma_f32_16x16x32_bf16 v[120:123], a[236:239], a[184:187], v[120:123]
v_cvt_pk_bf16_f32 v66, v80, v81
v_cvt_pk_bf16_f32 v67, v82, v83
v_mfma_f32_16x16x32_bf16 v[124:127], a[232:235], a[172:175], v[124:127]
ds_write_b128 v236, v[64:67] offset:8192
v_mfma_f32_16x16x32_bf16 v[124:127], a[236:239], a[188:191], v[124:127]
s_barrier
s_waitcnt lgkmcnt(2)
buffer_store_dwordx4 v[12:15], v253, s[20:23], s34 offen offset:2304 sc1
v_mfma_f32_16x16x32_bf16 v[128:131], a[240:243], a[160:163], v[128:131]
ds_read_b128 a[232:235], v249 offset:57344
v_cvt_pk_bf16_f32 v68, v68, v69
v_mfma_f32_16x16x32_bf16 v[128:131], a[244:247], a[176:179], v[128:131]
buffer_store_dwordx4 v[44:47], v247, s[20:23], s34 offen offset:2304 sc1
v_mfma_f32_16x16x32_bf16 v[132:135], a[240:243], a[164:167], v[132:135]
ds_read_b128 a[236:239], v249 offset:58368
v_cvt_pk_bf16_f32 v69, v70, v71
v_mfma_f32_16x16x32_bf16 v[132:135], a[244:247], a[180:183], v[132:135]
v_cvt_pk_bf16_f32 v96, v96, v97
v_cvt_pk_bf16_f32 v97, v98, v99
v_mfma_f32_16x16x32_bf16 v[136:139], a[240:243], a[168:171], v[136:139]
v_cvt_pk_bf16_f32 v98, v112, v113
v_cvt_pk_bf16_f32 v99, v114, v115
v_mfma_f32_16x16x32_bf16 v[136:139], a[244:247], a[184:187], v[136:139]
ds_write_b128 v237, v[96:99] offset:9216
v_mfma_f32_16x16x32_bf16 v[140:143], a[240:243], a[172:175], v[140:143]
ds_read_b128 v[64:67], v238 offset:8192
ds_read_b128 v[96:99], v239 offset:8192
v_mfma_f32_16x16x32_bf16 v[140:143], a[244:247], a[188:191], v[140:143]
s_waitcnt lgkmcnt(6)
v_cvt_pk_bf16_f32 v70, v84, v85
v_cvt_pk_bf16_f32 v71, v86, v87
v_mfma_f32_16x16x32_bf16 v[144:147], a[224:227], a[160:163], v[144:147]
ds_read_b128 a[240:243], v249 offset:59392
v_cvt_pk_bf16_f32 v100, v100, v101
v_mfma_f32_16x16x32_bf16 v[144:147], a[228:231], a[176:179], v[144:147]
ds_write_b128 v236, v[68:71] offset:10240
v_mfma_f32_16x16x32_bf16 v[148:151], a[224:227], a[164:167], v[148:151]
ds_read_b128 a[244:247], v249 offset:60416
v_cvt_pk_bf16_f32 v101, v102, v103
v_mfma_f32_16x16x32_bf16 v[148:151], a[228:231], a[180:183], v[148:151]
v_cvt_pk_bf16_f32 v102, v116, v117
v_cvt_pk_bf16_f32 v103, v118, v119
v_mfma_f32_16x16x32_bf16 v[152:155], a[224:227], a[168:171], v[152:155]
ds_write_b128 v237, v[100:103] offset:11264
v_mfma_f32_16x16x32_bf16 v[152:155], a[228:231], a[184:187], v[152:155]
ds_read_b128 v[68:71], v238 offset:10240
ds_read_b128 v[100:103], v239 offset:10240
v_mfma_f32_16x16x32_bf16 v[156:159], a[224:227], a[172:175], v[156:159]
s_waitcnt lgkmcnt(6)
buffer_store_dwordx4 v[64:67], v253, s[20:23], s34 offen offset:128 sc1
v_mfma_f32_16x16x32_bf16 v[156:159], a[228:231], a[188:191], v[156:159]
buffer_store_dwordx4 v[96:99], v247, s[20:23], s34 offen offset:128 sc1
v_mfma_f32_16x16x32_bf16 v[160:163], a[232:235], a[160:163], v[160:163]
v_cvt_pk_bf16_f32 v72, v72, v73
v_cvt_pk_bf16_f32 v73, v74, v75
v_mfma_f32_16x16x32_bf16 v[160:163], a[236:239], a[176:179], v[160:163]
v_cvt_pk_bf16_f32 v74, v88, v89
v_cvt_pk_bf16_f32 v75, v90, v91
v_mfma_f32_16x16x32_bf16 v[164:167], a[232:235], a[164:167], v[164:167]
ds_write_b128 v236, v[72:75] offset:0
v_mfma_f32_16x16x32_bf16 v[164:167], a[236:239], a[180:183], v[164:167]
s_waitcnt lgkmcnt(1)
buffer_store_dwordx4 v[68:71], v253, s[20:23], s34 offen offset:896 sc1
v_mfma_f32_16x16x32_bf16 v[168:171], a[232:235], a[168:171], v[168:171]
buffer_store_dwordx4 v[100:103], v247, s[20:23], s34 offen offset:896 sc1
v_mfma_f32_16x16x32_bf16 v[168:171], a[236:239], a[184:187], v[168:171]
v_cvt_pk_bf16_f32 v104, v104, v105
v_cvt_pk_bf16_f32 v105, v106, v107
v_mfma_f32_16x16x32_bf16 v[172:175], a[232:235], a[172:175], v[172:175]
v_cvt_pk_bf16_f32 v106, v120, v121
v_cvt_pk_bf16_f32 v107, v122, v123
v_mfma_f32_16x16x32_bf16 v[172:175], a[236:239], a[188:191], v[172:175]
ds_write_b128 v237, v[104:107] offset:1024
v_mfma_f32_16x16x32_bf16 v[176:179], a[240:243], a[160:163], v[176:179]
ds_read_b128 v[72:75], v238 offset:0
ds_read_b128 v[104:107], v239 offset:0
v_mfma_f32_16x16x32_bf16 v[176:179], a[244:247], a[176:179], v[176:179]
v_cvt_pk_bf16_f32 v76, v76, v77
v_cvt_pk_bf16_f32 v77, v78, v79
v_mfma_f32_16x16x32_bf16 v[180:183], a[240:243], a[164:167], v[180:183]
v_cvt_pk_bf16_f32 v78, v92, v93
v_cvt_pk_bf16_f32 v79, v94, v95
v_mfma_f32_16x16x32_bf16 v[180:183], a[244:247], a[180:183], v[180:183]
ds_write_b128 v236, v[76:79] offset:2048
v_mfma_f32_16x16x32_bf16 v[184:187], a[240:243], a[168:171], v[184:187]
v_cvt_pk_bf16_f32 v108, v108, v109
v_cvt_pk_bf16_f32 v109, v110, v111
v_mfma_f32_16x16x32_bf16 v[184:187], a[244:247], a[184:187], v[184:187]
v_cvt_pk_bf16_f32 v110, v124, v125
v_cvt_pk_bf16_f32 v111, v126, v127
v_mfma_f32_16x16x32_bf16 v[188:191], a[240:243], a[172:175], v[188:191]
ds_write_b128 v237, v[108:111] offset:3072
v_mfma_f32_16x16x32_bf16 v[188:191], a[244:247], a[188:191], v[188:191]
ds_read_b128 v[76:79], v238 offset:2048
ds_read_b128 v[108:111], v239 offset:2048
s_nop 4
s_waitcnt lgkmcnt(4)
buffer_store_dwordx4 v[72:75], v253, s[20:23], s34 offen offset:1664 sc1
buffer_store_dwordx4 v[104:107], v247, s[20:23], s34 offen offset:1664 sc1
v_cvt_pk_bf16_f32 v128, v128, v129
v_cvt_pk_bf16_f32 v129, v130, v131
v_cvt_pk_bf16_f32 v130, v144, v145
v_cvt_pk_bf16_f32 v131, v146, v147
v_cvt_pk_bf16_f32 v160, v160, v161
v_cvt_pk_bf16_f32 v161, v162, v163
v_cvt_pk_bf16_f32 v162, v176, v177
v_cvt_pk_bf16_f32 v163, v178, v179
ds_write_b128 v236, v[128:131] offset:4096
ds_write_b128 v237, v[160:163] offset:5120
ds_read_b128 v[128:131], v238 offset:4096
ds_read_b128 v[160:163], v239 offset:4096
s_waitcnt lgkmcnt(4)
buffer_store_dwordx4 v[76:79], v253, s[20:23], s34 offen offset:2432 sc1
buffer_store_dwordx4 v[108:111], v247, s[20:23], s34 offen offset:2432 sc1
v_cvt_pk_bf16_f32 v132, v132, v133
v_cvt_pk_bf16_f32 v133, v134, v135
v_cvt_pk_bf16_f32 v134, v148, v149
v_cvt_pk_bf16_f32 v135, v150, v151
v_cvt_pk_bf16_f32 v164, v164, v165
v_cvt_pk_bf16_f32 v165, v166, v167
v_cvt_pk_bf16_f32 v166, v180, v181
v_cvt_pk_bf16_f32 v167, v182, v183
ds_write_b128 v236, v[132:135] offset:6144
ds_write_b128 v237, v[164:167] offset:7168
ds_read_b128 v[132:135], v238 offset:6144
ds_read_b128 v[164:167], v239 offset:6144
s_waitcnt lgkmcnt(4)
buffer_store_dwordx4 v[128:131], v253, s[20:23], s34 offen offset:256 sc1
buffer_store_dwordx4 v[160:163], v247, s[20:23], s34 offen offset:256 sc1
v_cvt_pk_bf16_f32 v136, v136, v137
v_cvt_pk_bf16_f32 v137, v138, v139
v_cvt_pk_bf16_f32 v138, v152, v153
v_cvt_pk_bf16_f32 v139, v154, v155
v_cvt_pk_bf16_f32 v168, v168, v169
v_cvt_pk_bf16_f32 v169, v170, v171
v_cvt_pk_bf16_f32 v170, v184, v185
v_cvt_pk_bf16_f32 v171, v186, v187
ds_write_b128 v236, v[136:139] offset:8192
ds_write_b128 v237, v[168:171] offset:9216
ds_read_b128 v[136:139], v238 offset:8192
ds_read_b128 v[168:171], v239 offset:8192
s_waitcnt lgkmcnt(4)
buffer_store_dwordx4 v[132:135], v253, s[20:23], s34 offen offset:1024 sc1
buffer_store_dwordx4 v[164:167], v247, s[20:23], s34 offen offset:1024 sc1
v_cvt_pk_bf16_f32 v140, v140, v141
v_cvt_pk_bf16_f32 v141, v142, v143
v_cvt_pk_bf16_f32 v142, v156, v157
v_cvt_pk_bf16_f32 v143, v158, v159
v_cvt_pk_bf16_f32 v172, v172, v173
v_cvt_pk_bf16_f32 v173, v174, v175
v_cvt_pk_bf16_f32 v174, v188, v189
v_cvt_pk_bf16_f32 v175, v190, v191
ds_write_b128 v236, v[140:143] offset:10240
ds_write_b128 v237, v[172:175] offset:11264
ds_read_b128 v[140:143], v238 offset:10240
ds_read_b128 v[172:175], v239 offset:10240
s_waitcnt lgkmcnt(4)
buffer_store_dwordx4 v[136:139], v253, s[20:23], s34 offen offset:1792 sc1
buffer_store_dwordx4 v[168:171], v247, s[20:23], s34 offen offset:1792 sc1
s_waitcnt lgkmcnt(0)
buffer_store_dwordx4 v[140:143], v253, s[20:23], s34 offen offset:2560 sc1
buffer_store_dwordx4 v[172:175], v247, s[20:23], s34 offen offset:2560 sc1
L_final:
s_branch L_end
L_spinW:
s_mov_b32 s92, 400
L_spinW_loop:
s_sleep 4
buffer_load_dword v217, v219, s[68:71], 0 offen sc1
s_waitcnt vmcnt(0)
v_cmp_ne_u32 vcc, 0x01010101, v217
s_nop 3
s_cmp_eq_u64 vcc, 0
s_cbranch_scc1 L_gotW
s_sub_u32 s92, s92, 1
s_cmp_lg_u32 s92, 0
s_cbranch_scc1 L_spinW_loop
L_slowW:
v_mbcnt_lo_u32_b32 v219, -1, 0
v_mbcnt_hi_u32_b32 v219, -1, v219
v_and_b32 v220, 15, v219
v_lshrrev_b32 v221, 4, v219
v_mul_u32_u24 v228, 24576, v221
v_lshl_add_u32 v228, v220, 1, v228
v_mul_u32_u24 v229, 3072, v221
v_lshrrev_b32 v221, 2, v220
v_lshlrev_b32 v221, 4, v221
v_add_u32 v229, v229, v221
v_and_b32 v221, 3, v220
v_lshl_add_u32 v229, v221, 1, v229
v_lshlrev_b32 v231, 4, v219
s_mov_b32 s92, 3072
s_mov_b32 s93, 768
s_mov_b32 s94, 9984
s_mul_i32 s86, s29, 6
L_slowW_slot:
s_mov_b32 s87, 0
L_slowW_frag:
s_add_u32 s91, s86, s87
s_mul_i32 s52, s91, 43691
s_lshr_b32 s52, s52, 20
s_mul_i32 s53, s52, 24
s_sub_u32 s53, s91, s53
s_lshl_b32 s88, s91, 10
s_sub_u32 s57, s52, 2
s_and_b32 s58, s57, 3
s_lshr_b32 s54, s58, 1
s_and_b32 s56, s58, 1
s_lshr_b32 s55, s57, 2
s_xor_b32 s58, s54, 1
s_add_u32 s55, s55, s58
s_cmp_lt_u32 s52, 2
s_cselect_b32 s54, 0, s54
s_cselect_b32 s55, 0, s55
s_cselect_b32 s56, s52, s56
s_and_b32 s58, s52, 1
s_cmp_ge_u32 s52, 94
s_cselect_b32 s54, 1, s54
s_cselect_b32 s55, 23, s55
s_cselect_b32 s56, s58, s56
s_cmp_ge_u32 s53, 12
s_cselect_b32 s57, 1, 0
s_mul_i32 s58, s57, 12
s_sub_u32 s53, s53, s58
s_mul_i32 s59, s53, 98304
s_lshl_b32 s58, s55, 7
s_add_u32 s59, s59, s58
s_lshl_b32 s58, s57, 6
s_add_u32 s59, s59, s58
s_lshl_b32 s58, s56, 5
s_add_u32 s59, s59, s58
s_lshl_b32 s72, s55, 6
s_and_b32 s58, s53, 1
s_lshl_b32 s58, s58, 5
s_add_u32 s72, s72, s58
s_mul_i32 s72, s72, 768
s_mul_i32 s58, s57, 384
s_add_u32 s72, s72, s58
s_lshr_b32 s73, s53, 1
s_mul_i32 s58, s56, 6
s_add_u32 s73, s73, s58
s_lshr_b32 s58, s73, 1
s_lshl_b32 s58, s58, 6
s_add_u32 s72, s72, s58
s_and_b32 s58, s73, 1
s_lshl_b32 s58, s58, 3
s_add_u32 s72, s72, s58
s_cmp_eq_u32 s54, 0
s_cselect_b32 s59, s59, s72
s_cselect_b32 s12, s4, s84
s_cselect_b32 s13, s5, s85
s_cselect_b64 s[72:73], -1, 0
s_cselect_b32 s74, s92, s93
s_cselect_b32 s75, s92, s94
v_cndmask_b32 v230, v229, v228, s[72:73]
buffer_load_ushort v220, v230, s[12:15], s59 offen
s_add_u32 s59, s59, s74
buffer_load_ushort v221, v230, s[12:15], s59 offen
s_add_u32 s59, s59, s74
buffer_load_ushort v222, v230, s[12:15], s59 offen
s_add_u32 s59, s59, s74
buffer_load_ushort v223, v230, s[12:15], s59 offen
s_add_u32 s59, s59, s75
buffer_load_ushort v224, v230, s[12:15], s59 offen
s_add_u32 s59, s59, s74
buffer_load_ushort v225, v230, s[12:15], s59 offen
s_add_u32 s59, s59, s74
buffer_load_ushort v226, v230, s[12:15], s59 offen
s_add_u32 s59, s59, s74
buffer_load_ushort v227, v230, s[12:15], s59 offen
s_waitcnt vmcnt(0)
v_lshl_or_b32 v220, v221, 16, v220
v_lshl_or_b32 v221, v223, 16, v222
v_lshl_or_b32 v222, v225, 16, v224
v_lshl_or_b32 v223, v227, 16, v226
buffer_store_dwordx4 v[220:223], v231, s[8:11], s88 offen sc1
s_add_u32 s87, s87, 1
s_cmp_lt_u32 s87, 6
s_cbranch_scc1 L_slowW_frag
s_add_u32 s86, s86, 24
s_cmp_lt_u32 s86, 2304
s_cbranch_scc1 L_slowW_slot
s_waitcnt vmcnt(0)
s_branch L_gotW
L_end:
s_endpgm

.section .rodata,"a"
.p2align 6
.amdhsa_kernel standalone__modern_conv_block_replknet__vision_kernel
  .amdhsa_next_free_vgpr 512
  .amdhsa_next_free_sgpr 102
  .amdhsa_accum_offset 256
  .amdhsa_group_segment_fixed_size 0
  .amdhsa_kernarg_size 64
  .amdhsa_user_sgpr_count 2
  .amdhsa_user_sgpr_kernarg_segment_ptr 1
  .amdhsa_system_sgpr_workgroup_id_x 1
.end_amdhsa_kernel
.text
```
